```python
import torch

def _softmax(x, axis=-1):
    return torch.softmax(x, dim=axis)
def _gelu(x):
    return torch.nn.functional.gelu(x, approximate="tanh")
def _silu(x):
    return torch.nn.functional.silu(x)
def _sigmoid(x):
    return torch.sigmoid(x)
def _layernorm(x, axis=-1, eps=1e-5):
    m = x.mean(dim=axis, keepdim=True)
    v = x.var(dim=axis, keepdim=True, unbiased=False)
    return (x - m) / torch.sqrt(v + eps)
def _scatter_add(tgt, idx, src, axis=0):
    return tgt.clone().index_add_(axis, idx, src)
def _segment_sum(src, seg, n):
    out = torch.zeros((n,) + src.shape[1:], dtype=src.dtype)
    return out.index_add_(0, seg, src)
def _pad(x, pw):
    flat = tuple(v for pair in reversed(pw) for v in pair)
    return torch.nn.functional.pad(x, flat)

kernel_name = 'sequential_preLN__softmax_full_mha__dense_activation_silu__prompt'

def setup_inputs():

    _w = (lambda a: (lambda t: t.to(torch.bfloat16) if t.is_floating_point() else t)(torch.as_tensor(a)))
    def _A_setup():
        B, S, D = 1, 2048, 640
        return {
            "x": _w((lambda *s: torch.randn(*s, dtype=torch.bfloat16) * 0.05)(B, S, D)),
            "wqkv": _w((lambda *s: torch.randn(*s, dtype=torch.bfloat16) * 0.05)(D, 3 * D)),
            "wo": _w((lambda *s: torch.randn(*s, dtype=torch.bfloat16) * 0.05)(D, D)),
        }
    _A_in = _A_setup()

    def _B_setup():
        B, S, D, F = 1, 2048, 640, 1728
        return {
            "x": _w((lambda *s: torch.randn(*s, dtype=torch.bfloat16) * 0.05)(B, S, D)),
            "w1": _w((lambda *s: torch.randn(*s, dtype=torch.bfloat16) * 1.6)(D, F) * (D ** -0.5)),
            "w2": _w((lambda *s: torch.randn(*s, dtype=torch.bfloat16) * 0.2)(F, D) * (F ** -0.5)),
        }
    _B_in = _B_setup()

    return {
        "A_x": _A_in["x"],
        "A_wqkv": _A_in["wqkv"],
        "A_wo": _A_in["wo"],
        "B_x": _B_in["x"],
        "B_w1": _B_in["w1"],
        "B_w2": _B_in["w2"],
    }

def reference(A_x, A_wqkv, A_wo, B_x, B_w1, B_w2):
    def _A_ref(x, wqkv, wo):
        B, S, D = x.shape
        H = 32; Dh = D // H
        qkv = (lambda x, *d: x.permute(*d))((x @ wqkv).reshape(B, S, 3, H, Dh), 2, 0, 3, 1, 4)
        q, k, v = qkv[0], qkv[1], qkv[2]
        scale = Dh ** -0.5
        scores = torch.einsum("bhqd,bhkd->bhqk", q, k) * scale
        p = _softmax(scores, axis=-1)
        o = torch.einsum("bhqk,bhkd->bhqd", p, v)
        return (lambda x, *d: x.permute(*d))(o, 0, 2, 1, 3).reshape(B, S, D) @ wo

    def _B_ref(x, w1, w2):
        h = torch.einsum("bsd,df->bsf", x, w1)
        h = _silu(h)
        out = torch.einsum("bsf,fd->bsd", h, w2)
        return out

    x = A_x
    h = x + _A_ref(_layernorm(x, axis=-1), A_wqkv, A_wo)
    h2 = h + _B_ref(_layernorm(h, axis=-1), B_w1, B_w2)
    return h2
```

```asm
; @launch grid=(256,1,1) block=(512,1,1) lds=163840
.amdgcn_target "amdgcn-amd-amdhsa--gfx950"
.text
.globl sequential_preLN__softmax_full_mha__dense_activation_silu__prompt_kernel
.p2align 12
.p2align 8
.type sequential_preLN__softmax_full_mha__dense_activation_silu__prompt_kernel,@function
sequential_preLN__softmax_full_mha__dense_activation_silu__prompt_kernel:
    s_cmp_ge_u32 s2, 256
    s_cbranch_scc1 Lend
    s_load_dwordx16 s[4:19], s[0:1], 0
    s_load_dwordx2 s[20:21], s[0:1], 64
    v_lshrrev_b32 v5, 6, v0
    v_and_b32 v1, 63, v0
    v_readfirstlane_b32 s32, v5
    v_and_b32 v2, 31, v0
    v_bfe_u32 v3, v0, 5, 1
    v_lshlrev_b32 v4, 4, v1
    s_mov_b32 s22, 25698304
    s_mov_b32 s23, 0x20000
    s_getreg_b32 s3, hwreg(HW_REG_XCC_ID, 0, 4)
    s_and_b32 s33, s32, 3
    s_cmp_ge_u32 s2, 248
    s_cbranch_scc1 Lclr
Lclr_done:
    s_and_b32 s34, s2, 7
    s_lshr_b32 s35, s2, 3
    s_and_b32 s41, s34, 1
    s_mul_i32 s41, s41, 30
    s_add_u32 s35, s35, s41
    s_lshr_b32 s41, s35, 2
    s_and_b32 s35, s35, 3
    s_lshr_b32 s40, s34, 1
    s_lshl_b32 s40, s40, 2
    s_add_u32 s40, s40, s35
    s_cmp_lt_u32 s32, 4
    s_cbranch_scc1 Lp1_first
    s_cmp_ge_u32 s2, 240
    s_cbranch_scc1 Lp1_idle
    s_lshl_b32 s34, s40, 2
    s_add_u32 s34, s34, s33
    s_mul_i32 s34, s34, 40960
    v_bfe_u32 v5, v0, 2, 3
    v_mul_u32_u24 v5, 1280, v5
    v_lshl_add_u32 v5, v3, 6, v5
    v_add_u32 v5, s34, v5
    v_and_b32 v7, 3, v0
    v_lshl_add_u32 v20, v7, 4, v5
    v_xor_b32 v21, 32, v20
    v_add_u32 v21, 10240, v21
    v_add_u32 v22, 20480, v20
    v_add_u32 v23, 20480, v21
    s_mul_i32 s34, s33, 61440
    s_lshl_b32 s35, s41, 8
    s_add_u32 s34, s34, s35
    v_bfe_u32 v5, v0, 2, 2
    v_mul_u32_u24 v5, 3840, v5
    v_bfe_u32 v6, v0, 4, 2
    v_lshl_add_u32 v5, v6, 6, v5
    v_lshl_add_u32 v5, v7, 4, v5
    v_add_u32 v24, s34, v5
    v_add_u32 v25, 15360, v24
    v_xor_b32 v26, 32, v24
    v_add_u32 v26, 30720, v26
    v_add_u32 v27, 15360, v26
    s_and_b32 s42, s2, 7
    s_mul_i32 s43, s42, 245760
    s_lshl_b32 s42, s42, 7
    s_lshl_b32 s44, s33, 12
    s_mov_b32 s37, 0
    s_waitcnt lgkmcnt(0)
    s_mov_b32 s24, s4
    s_mov_b32 s25, s5
    s_mov_b32 s26, 2621440
    s_mov_b32 s27, 0x20000
    s_mov_b32 s28, s6
    s_mov_b32 s29, s7
    s_mov_b32 s30, 2457600
    s_mov_b32 s31, 0x20000
Lp1_pro:
    s_add_u32 m0, s44, 0
    s_nop 0
    buffer_load_dwordx4 v20, s[24:27], s42 offen lds
    s_add_u32 m0, s44, 16384
    s_nop 0
    buffer_load_dwordx4 v24, s[28:31], s43 offen lds
    s_add_u32 m0, s44, 1024
    s_nop 0
    buffer_load_dwordx4 v21, s[24:27], s42 offen lds
    s_add_u32 m0, s44, 17408
    s_nop 0
    buffer_load_dwordx4 v25, s[28:31], s43 offen lds
    s_add_u32 m0, s44, 2048
    s_nop 0
    buffer_load_dwordx4 v22, s[24:27], s42 offen lds
    s_add_u32 m0, s44, 18432
    s_nop 0
    buffer_load_dwordx4 v26, s[28:31], s43 offen lds
    s_add_u32 m0, s44, 3072
    s_nop 0
    buffer_load_dwordx4 v23, s[24:27], s42 offen lds
    s_add_u32 m0, s44, 19456
    s_nop 0
    buffer_load_dwordx4 v27, s[28:31], s43 offen lds
    s_add_u32 s42, s42, 128
    s_add_u32 s43, s43, 245760
    s_cmp_eq_u32 s42, 1280
    s_cselect_b32 s42, 0, s42
    s_cselect_b32 s43, 0, s43
    s_add_u32 s44, s44, 32768
    s_cmp_ge_u32 s44, 163840
    s_cselect_b32 s34, 163840, 0
    s_sub_u32 s44, s44, s34
    s_add_u32 s37, s37, 1
    s_cmp_lt_u32 s37, 2
    s_cbranch_scc1 Lp1_pro
    s_mov_b32 s37, 0
    s_waitcnt vmcnt(8)
Lp1_lloop:
    s_cmp_ge_u32 s37, 8
    s_barrier
    s_cbranch_scc1 Lp1_noissue
    s_add_u32 m0, s44, 0
    s_nop 0
    buffer_load_dwordx4 v20, s[24:27], s42 offen lds
    s_add_u32 m0, s44, 16384
    s_nop 0
    buffer_load_dwordx4 v24, s[28:31], s43 offen lds
    s_add_u32 m0, s44, 1024
    s_nop 0
    buffer_load_dwordx4 v21, s[24:27], s42 offen lds
    s_add_u32 m0, s44, 17408
    s_nop 0
    buffer_load_dwordx4 v25, s[28:31], s43 offen lds
    s_add_u32 m0, s44, 2048
    s_nop 0
    buffer_load_dwordx4 v22, s[24:27], s42 offen lds
    s_add_u32 m0, s44, 18432
    s_nop 0
    buffer_load_dwordx4 v26, s[28:31], s43 offen lds
    s_add_u32 m0, s44, 3072
    s_nop 0
    buffer_load_dwordx4 v23, s[24:27], s42 offen lds
    s_add_u32 m0, s44, 19456
    s_nop 0
    buffer_load_dwordx4 v27, s[28:31], s43 offen lds
    s_add_u32 s42, s42, 128
    s_add_u32 s43, s43, 245760
    s_cmp_eq_u32 s42, 1280
    s_cselect_b32 s42, 0, s42
    s_cselect_b32 s43, 0, s43
    s_add_u32 s44, s44, 32768
    s_cmp_ge_u32 s44, 163840
    s_cselect_b32 s34, 163840, 0
    s_sub_u32 s44, s44, s34
Lp1_noissue:
    s_add_u32 s37, s37, 1
    s_waitcnt vmcnt(8)
    s_cmp_le_u32 s37, 8
    s_cbranch_scc1 Lp1_lloop
    s_cmp_lg_u32 s33, 0
    s_cbranch_scc1 Ltch_2
    s_call_b64 s[38:39], Lpg5
    s_branch Ltch_1
Ltch_2:
    s_cmp_lg_u32 s33, 1
    s_cbranch_scc1 Ltch_3
    s_call_b64 s[38:39], Lpg6
    s_branch Ltch_1
Ltch_3:
    s_cmp_lg_u32 s33, 2
    s_cbranch_scc1 Ltch_4
    s_call_b64 s[38:39], Lpg7
    s_branch Ltch_1
Ltch_4:
    s_call_b64 s[38:39], Lpg8
Ltch_1:
    s_waitcnt vmcnt(0)
    s_barrier
    s_cmp_lg_u32 s33, 0
    s_cbranch_scc1 Ltch_7
    s_call_b64 s[38:39], Lpg9
    s_branch Ltch_6
Ltch_7:
    s_cmp_lg_u32 s33, 1
    s_cbranch_scc1 Ltch_8
    s_call_b64 s[38:39], LpgL
    s_branch Ltch_6
Ltch_8:
    s_cmp_lg_u32 s33, 2
    s_cbranch_scc1 Ltch_9
    s_call_b64 s[38:39], Lpg10
    s_branch Ltch_6
Ltch_9:
Ltch_6:
    v_mov_b32 v5, 0
    ds_write_b32 v5, v5 offset:0
    ds_write_b32 v5, v5 offset:4
    s_waitcnt lgkmcnt(0)
    s_barrier
    s_branch Lp2_setup
Lp1_idle:
    s_sub_u32 s34, s2, 240
    s_lshl_b32 s42, s34, 3
    s_add_u32 s42, s42, s32
    s_waitcnt lgkmcnt(0)
    s_cmp_ge_u32 s42, 80
    s_cbranch_scc1 Li_nz
    s_mul_i32 s34, s42, 7168
    s_add_u32 s34, s34, 22861824
    v_mov_b32 v64, 0
    v_mov_b32 v65, 0
    v_mov_b32 v66, 0
    v_mov_b32 v67, 0
    buffer_store_dwordx4 v[64:67], v4, s[20:23], s34 offen sc1
Li_nz:
    s_lshl_b32 s42, s42, 3
    s_call_b64 s[38:39], Ljob
    v_bfe_u32 v5, v0, 2, 2
    v_mul_u32_u24 v5, 1280, v5
    v_bfe_u32 v6, v0, 4, 2
    v_lshl_add_u32 v5, v6, 6, v5
    v_and_b32 v7, 3, v0
    v_lshl_add_u32 v5, v7, 4, v5
    s_lshl_b32 s58, s32, 13
    s_add_u32 s58, s58, 65536
    s_add_u32 s52, s52, s44
    s_mov_b32 s34, s52
    s_add_u32 m0, s58, 0
    s_nop 0
    buffer_load_dwordx4 v5, s[24:27], s34 offen lds
    s_mov_b32 s34, s52
    s_add_u32 s34, s34, s55
    s_add_u32 m0, s58, 1024
    s_nop 0
    buffer_load_dwordx4 v5, s[24:27], s34 offen lds
    s_mov_b32 s34, s52
    s_add_u32 s34, s34, s54
    s_add_u32 m0, s58, 2048
    s_nop 0
    buffer_load_dwordx4 v5, s[24:27], s34 offen lds
    s_mov_b32 s34, s52
    s_add_u32 s34, s34, s54
    s_add_u32 s34, s34, s55
    s_add_u32 m0, s58, 3072
    s_nop 0
    buffer_load_dwordx4 v5, s[24:27], s34 offen lds
    s_mov_b32 s34, s52
    s_add_u32 s34, s34, s53
    s_add_u32 m0, s58, 4096
    s_nop 0
    buffer_load_dwordx4 v5, s[24:27], s34 offen lds
    s_mov_b32 s34, s52
    s_add_u32 s34, s34, s53
    s_add_u32 s34, s34, s55
    s_add_u32 m0, s58, 5120
    s_nop 0
    buffer_load_dwordx4 v5, s[24:27], s34 offen lds
    s_mov_b32 s34, s52
    s_add_u32 s34, s34, s53
    s_add_u32 s34, s34, s54
    s_add_u32 m0, s58, 6144
    s_nop 0
    buffer_load_dwordx4 v5, s[24:27], s34 offen lds
    s_mov_b32 s34, s52
    s_add_u32 s34, s34, s53
    s_add_u32 s34, s34, s54
    s_add_u32 s34, s34, s55
    s_add_u32 m0, s58, 7168
    s_nop 0
    buffer_load_dwordx4 v5, s[24:27], s34 offen lds
    v_lshlrev_b32 v6, 11, v6
    v_lshl_add_u32 v6, v7, 3, v6
    v_bfe_u32 v5, v0, 2, 2
    v_lshl_add_u32 v6, v5, 6, v6
    v_add_u32 v20, s58, v6
    s_cmp_ge_u32 s32, 4
    s_cbranch_scc1 Li_noxs
    s_mov_b32 s37, 0
Lrst_11:
    v_and_b32 v5, 7, v0
    v_lshlrev_b32 v5, 2, v5
    global_load_dword v8, v5, s[18:19] sc1
    s_add_u32 s37, s37, 1
    s_cmp_gt_u32 s37, 0x200000
    s_cbranch_scc1 Lrste_12
    s_waitcnt vmcnt(0)
Lrstc_13:
    v_cmp_ne_u32 vcc, 0, v8
    s_cmp_eq_u64 vcc, -1
    s_cbranch_scc0 Lrst_11
Lrste_12:
    s_lshl_b32 s34, s2, 2
    s_add_u32 s34, s34, s32
    s_lshl_b32 s34, s34, 4
    s_add_u32 s34, s34, 25673728
    v_lshlrev_b32 v6, 3, v3
    s_mov_b32 exec_lo, 1
    s_mov_b32 exec_hi, 1
    buffer_store_dwordx2 v[12:13], v6, s[20:23], s34 offen sc1
    s_mov_b64 exec, -1
Li_noxs:
    s_waitcnt vmcnt(0)
    ds_read_b64_tr_b16 v[32:33], v20 offset:0
    ds_read_b64_tr_b16 v[34:35], v20 offset:1024
    ds_read_b64_tr_b16 v[36:37], v20 offset:32
    ds_read_b64_tr_b16 v[38:39], v20 offset:1056
    ds_read_b64_tr_b16 v[40:41], v20 offset:256
    ds_read_b64_tr_b16 v[42:43], v20 offset:1280
    ds_read_b64_tr_b16 v[44:45], v20 offset:288
    ds_read_b64_tr_b16 v[46:47], v20 offset:1312
    s_waitcnt lgkmcnt(0)
    ds_read_b64_tr_b16 v[48:49], v20 offset:512
    ds_read_b64_tr_b16 v[50:51], v20 offset:1536
    ds_read_b64_tr_b16 v[52:53], v20 offset:544
    ds_read_b64_tr_b16 v[54:55], v20 offset:1568
    ds_read_b64_tr_b16 v[56:57], v20 offset:768
    ds_read_b64_tr_b16 v[58:59], v20 offset:1792
    ds_read_b64_tr_b16 v[60:61], v20 offset:800
    ds_read_b64_tr_b16 v[62:63], v20 offset:1824
    s_mul_i32 s35, s49, 13108
    s_lshr_b32 s35, s35, 16
    s_sub_u32 s57, s57, 1
    s_mul_i32 s57, s57, 5120
    s_waitcnt lgkmcnt(0)
    s_add_u32 s34, s49, 0
    s_mul_i32 s34, s34, 13108
    s_lshr_b32 s34, s34, 16
    s_sub_u32 s34, s34, s35
    s_mul_i32 s34, s34, s57
    s_add_u32 s34, s34, s43
    s_add_u32 s43, s43, 1024
    buffer_store_dwordx4 v[32:35], v4, s[20:23], s34 offen sc1
    s_add_u32 s34, s49, 1
    s_mul_i32 s34, s34, 13108
    s_lshr_b32 s34, s34, 16
    s_sub_u32 s34, s34, s35
    s_mul_i32 s34, s34, s57
    s_add_u32 s34, s34, s43
    s_add_u32 s43, s43, 1024
    buffer_store_dwordx4 v[36:39], v4, s[20:23], s34 offen sc1
    s_add_u32 s34, s49, 2
    s_mul_i32 s34, s34, 13108
    s_lshr_b32 s34, s34, 16
    s_sub_u32 s34, s34, s35
    s_mul_i32 s34, s34, s57
    s_add_u32 s34, s34, s43
    s_add_u32 s43, s43, 1024
    buffer_store_dwordx4 v[40:43], v4, s[20:23], s34 offen sc1
    s_add_u32 s34, s49, 3
    s_mul_i32 s34, s34, 13108
    s_lshr_b32 s34, s34, 16
    s_sub_u32 s34, s34, s35
    s_mul_i32 s34, s34, s57
    s_add_u32 s34, s34, s43
    s_add_u32 s43, s43, 1024
    buffer_store_dwordx4 v[44:47], v4, s[20:23], s34 offen sc1
    s_add_u32 s34, s49, 4
    s_mul_i32 s34, s34, 13108
    s_lshr_b32 s34, s34, 16
    s_sub_u32 s34, s34, s35
    s_mul_i32 s34, s34, s57
    s_add_u32 s34, s34, s43
    s_add_u32 s43, s43, 1024
    buffer_store_dwordx4 v[48:51], v4, s[20:23], s34 offen sc1
    s_add_u32 s34, s49, 5
    s_mul_i32 s34, s34, 13108
    s_lshr_b32 s34, s34, 16
    s_sub_u32 s34, s34, s35
    s_mul_i32 s34, s34, s57
    s_add_u32 s34, s34, s43
    s_add_u32 s43, s43, 1024
    buffer_store_dwordx4 v[52:55], v4, s[20:23], s34 offen sc1
    s_add_u32 s34, s49, 6
    s_mul_i32 s34, s34, 13108
    s_lshr_b32 s34, s34, 16
    s_sub_u32 s34, s34, s35
    s_mul_i32 s34, s34, s57
    s_add_u32 s34, s34, s43
    s_add_u32 s43, s43, 1024
    buffer_store_dwordx4 v[56:59], v4, s[20:23], s34 offen sc1
    s_add_u32 s34, s49, 7
    s_mul_i32 s34, s34, 13108
    s_lshr_b32 s34, s34, 16
    s_sub_u32 s34, s34, s35
    s_mul_i32 s34, s34, s57
    s_add_u32 s34, s34, s43
    s_add_u32 s43, s43, 1024
    buffer_store_dwordx4 v[60:63], v4, s[20:23], s34 offen sc1
    v_mov_b32 v7, 0
    ds_write_b32 v7, v7 offset:0
    ds_write_b32 v7, v7 offset:4
    s_waitcnt vmcnt(0) lgkmcnt(0)
    s_barrier
    s_cmp_lt_u32 s32, 4
    s_cbranch_scc1 Lp1_cdone
    s_branch Lp2_touch
Ljob:
    s_cmp_ge_u32 s42, 2960
    s_cbranch_scc1 Ljob_w1
    s_cmp_ge_u32 s42, 800
    s_cselect_b32 s24, s14, s8
    s_cselect_b32 s25, s15, s9
    s_cselect_b32 s57, 54, 20
    s_cselect_b32 s35, 40, 0
    s_cselect_b32 s34, 800, 0
    s_cselect_b32 s43, 3040, 0
    s_mul_i32 s26, s57, 40960
    s_sub_u32 s34, s42, s34
    s_mul_i32 s48, s34, 52429
    s_lshr_b32 s48, s48, 21
    s_mul_i32 s36, s48, 40
    s_sub_u32 s49, s34, s36
    s_mul_i32 s34, s49, 13108
    s_lshr_b32 s34, s34, 16
    s_sub_u32 s36, s57, 1
    s_mul_i32 s34, s34, s36
    s_add_u32 s34, s34, s48
    s_mul_i32 s34, s34, 5
    s_add_u32 s34, s34, s49
    s_add_u32 s43, s43, s34
    s_movk_i32 s56, 1280
    s_branch Ljob_c
Ljob_w1:
    s_mov_b32 s24, s12
    s_mov_b32 s25, s13
    s_mov_b32 s26, 2211840
    s_sub_u32 s34, s42, 2960
    s_mul_i32 s48, s34, 38837
    s_lshr_b32 s48, s48, 22
    s_mul_i32 s36, s48, 108
    s_sub_u32 s49, s34, s36
    s_sub_u32 s34, s49, 84
    s_mul_i32 s34, s34, 10923
    s_lshr_b32 s34, s34, 16
    s_cmp_ge_u32 s49, 84
    s_cselect_b32 s34, s34, 0
    s_add_u32 s36, s49, s34
    s_mul_i32 s34, s36, 9363
    s_lshr_b32 s34, s34, 16
    s_mul_i32 s34, s34, 19
    s_add_u32 s34, s34, s48
    s_mul_i32 s34, s34, 7
    s_add_u32 s34, s34, s36
    s_add_u32 s43, s34, 800
    s_movk_i32 s56, 3456
    s_mov_b32 s35, 20
Ljob_c:
    s_add_u32 s48, s48, s35
    s_lshl_b32 s48, s48, 4
    s_getpc_b64 s[52:53]
Ljob_pc:
    s_add_u32 s52, s52, Ltable-Ljob_pc
    s_addc_u32 s53, s53, 0
    s_load_dwordx4 s[52:55], s[52:53], s48
    s_mov_b32 s27, 0x20000
    s_lshl_b32 s43, s43, 10
    s_add_u32 s43, s43, 20316160
    s_andn2_b32 s44, s49, 3
    s_lshl_b32 s44, s44, 5
    v_bfe_u32 v6, v0, 3, 2
    v_mul_u32_u24 v6, s56, v6
    v_and_b32 v7, 7, v0
    v_lshl_add_u32 v6, v7, 4, v6
    s_lshr_b32 s34, s33, 1
    s_and_b32 s35, s33, 1
    s_waitcnt lgkmcnt(0)
    s_mul_i32 s34, s34, s53
    s_mul_i32 s35, s35, s54
    s_add_u32 s34, s34, s35
    s_add_u32 s34, s34, s52
    s_add_u32 s34, s34, s44
    v_mul_u32_u24 v5, s55, v3
    v_add3_u32 v20, v5, v6, s34
    s_setpc_b64 s[38:39]
Lp1_first:
    s_cmp_lt_u32 s2, 240
    s_cbranch_scc1 Lp1_act
    s_cmp_ge_u32 s2, 248
    s_cbranch_scc1 Lpf_no
    s_getpc_b64 s[38:39]
Lpf_pc:
    v_lshlrev_b32 v5, 7, v0
    v_min_u32 v6, Lcode_end-Lpf_pc-4, v5
    global_load_dword v10, v6, s[38:39]
    v_add_u32 v5, 0x8000, v5
    v_min_u32 v6, Lcode_end-Lpf_pc-4, v5
    global_load_dword v10, v6, s[38:39]
Lpf_no:
    s_lshl_b32 s34, s2, 2
    s_add_u32 s36, s34, s32
    s_mul_i32 s34, s36, 2560
    v_mul_u32_u24 v5, 1280, v3
    v_lshl_add_u32 v5, v2, 3, v5
    s_mov_b32 s42, 0xffff0000
    s_waitcnt lgkmcnt(0)
    s_mov_b32 s24, s4
    s_mov_b32 s25, s5
    s_mov_b32 s26, 2621440
    s_mov_b32 s27, 0x20000
    buffer_load_dwordx2 v[20:21], v5, s[24:27], s34 offen offset:0
    buffer_load_dwordx2 v[22:23], v5, s[24:27], s34 offen offset:256
    buffer_load_dwordx2 v[24:25], v5, s[24:27], s34 offen offset:512
    buffer_load_dwordx2 v[26:27], v5, s[24:27], s34 offen offset:768
    buffer_load_dwordx2 v[28:29], v5, s[24:27], s34 offen offset:1024
    s_waitcnt vmcnt(0)
    v_lshlrev_b32 v36, 16, v20
    v_and_b32 v37, s42, v20
    v_add_f32 v32, v36, v37
    v_mul_f32 v34, v36, v36
    v_fmac_f32 v34, v37, v37
    v_lshlrev_b32 v36, 16, v21
    v_and_b32 v37, s42, v21
    v_add_f32 v32, v32, v36
    v_fmac_f32 v34, v36, v36
    v_add_f32 v32, v32, v37
    v_fmac_f32 v34, v37, v37
    v_lshlrev_b32 v36, 16, v22
    v_and_b32 v37, s42, v22
    v_add_f32 v32, v32, v36
    v_fmac_f32 v34, v36, v36
    v_add_f32 v32, v32, v37
    v_fmac_f32 v34, v37, v37
    v_lshlrev_b32 v36, 16, v23
    v_and_b32 v37, s42, v23
    v_add_f32 v32, v32, v36
    v_fmac_f32 v34, v36, v36
    v_add_f32 v32, v32, v37
    v_fmac_f32 v34, v37, v37
    v_lshlrev_b32 v36, 16, v24
    v_and_b32 v37, s42, v24
    v_add_f32 v32, v32, v36
    v_fmac_f32 v34, v36, v36
    v_add_f32 v32, v32, v37
    v_fmac_f32 v34, v37, v37
    v_lshlrev_b32 v36, 16, v25
    v_and_b32 v37, s42, v25
    v_add_f32 v32, v32, v36
    v_fmac_f32 v34, v36, v36
    v_add_f32 v32, v32, v37
    v_fmac_f32 v34, v37, v37
    v_lshlrev_b32 v36, 16, v26
    v_and_b32 v37, s42, v26
    v_add_f32 v32, v32, v36
    v_fmac_f32 v34, v36, v36
    v_add_f32 v32, v32, v37
    v_fmac_f32 v34, v37, v37
    v_lshlrev_b32 v36, 16, v27
    v_and_b32 v37, s42, v27
    v_add_f32 v32, v32, v36
    v_fmac_f32 v34, v36, v36
    v_add_f32 v32, v32, v37
    v_fmac_f32 v34, v37, v37
    v_lshlrev_b32 v36, 16, v28
    v_and_b32 v37, s42, v28
    v_add_f32 v32, v32, v36
    v_fmac_f32 v34, v36, v36
    v_add_f32 v32, v32, v37
    v_fmac_f32 v34, v37, v37
    v_lshlrev_b32 v36, 16, v29
    v_and_b32 v37, s42, v29
    v_add_f32 v32, v32, v36
    v_fmac_f32 v34, v36, v36
    v_add_f32 v32, v32, v37
    v_fmac_f32 v34, v37, v37
    s_nop 0
    v_add_f32_dpp v32, v32, v32 quad_perm:[1,0,3,2] row_mask:0xf bank_mask:0xf
    v_add_f32_dpp v34, v34, v34 quad_perm:[1,0,3,2] row_mask:0xf bank_mask:0xf
    s_nop 0
    v_add_f32_dpp v32, v32, v32 quad_perm:[2,3,0,1] row_mask:0xf bank_mask:0xf
    v_add_f32_dpp v34, v34, v34 quad_perm:[2,3,0,1] row_mask:0xf bank_mask:0xf
    s_nop 0
    v_add_f32_dpp v32, v32, v32 row_half_mirror row_mask:0xf bank_mask:0xf
    v_add_f32_dpp v34, v34, v34 row_half_mirror row_mask:0xf bank_mask:0xf
    s_nop 0
    v_add_f32_dpp v32, v32, v32 row_mirror row_mask:0xf bank_mask:0xf
    v_add_f32_dpp v34, v34, v34 row_mirror row_mask:0xf bank_mask:0xf
    v_mov_b32 v33, v32
    v_mov_b32 v35, v34
    s_nop 0
    v_permlane16_swap_b32 v32, v33
    v_permlane16_swap_b32 v34, v35
    v_add_f32 v32, v32, v33
    v_add_f32 v34, v34, v35
    v_mul_f32 v32, 0x3acccccd, v32
    v_mul_f32 v34, 0x3acccccd, v34
    v_fma_f32 v34, -v32, v32, v34
    v_max_f32 v34, 0, v34
    v_add_f32 v34, 0x3727c5ac, v34
    v_rsq_f32 v33, v34
    s_nop 0
    v_or_b32 v13, 1, v33
    v_mul_f32 v12, v32, v13
    s_branch Lp1_idle
Lclr:
    s_cmp_lg_u32 s32, 0
    s_cbranch_scc1 Lclr_w
    s_and_b32 s34, s2, 7
    s_mul_i32 s35, s34, 7168
    s_add_u32 s35, s35, 25640960
    s_add_u32 s36, s35, 4096
    s_lshl_b32 s34, s34, 2
    v_mov_b32 v6, s34
    v_mov_b32 v7, 1
    v_mov_b32 v10, 0
    v_mov_b32 v11, 0
    v_mov_b32 v12, 0
    v_mov_b32 v13, 0
    s_waitcnt lgkmcnt(0)
    buffer_store_dwordx4 v[10:13], v4, s[20:23], s35 offen offset:0 sc1
    buffer_store_dwordx4 v[10:13], v4, s[20:23], s35 offen offset:1024 sc1
    buffer_store_dwordx4 v[10:13], v4, s[20:23], s35 offen offset:2048 sc1
    buffer_store_dwordx4 v[10:13], v4, s[20:23], s35 offen offset:3072 sc1
    buffer_store_dwordx4 v[10:13], v4, s[20:23], s36 offen offset:0 sc1
    buffer_store_dwordx4 v[10:13], v4, s[20:23], s36 offen offset:1024 sc1
    buffer_store_dwordx4 v[10:13], v4, s[20:23], s36 offen offset:2048 sc1
    s_mov_b64 exec, 1
    s_waitcnt vmcnt(0)
    global_store_dword v6, v7, s[18:19] sc1
    s_mov_b64 exec, -1
Lclr_w:
    s_barrier
    s_branch Lclr_done
.p2align 12
Lp1_act:
    s_cmp_lg_u32 s33, 0
    s_cbranch_scc1 Ltch_15
    s_call_b64 s[38:39], Lpg1
    s_branch Ltch_14
Ltch_15:
    s_cmp_lg_u32 s33, 1
    s_cbranch_scc1 Ltch_16
    s_call_b64 s[38:39], Lpg2
    s_branch Ltch_14
Ltch_16:
    s_cmp_lg_u32 s33, 2
    s_cbranch_scc1 Ltch_17
    s_call_b64 s[38:39], Lpg3
    s_branch Ltch_14
Ltch_17:
    s_call_b64 s[38:39], Lpg4
Ltch_14:
    s_lshr_b32 s43, s32, 1
    s_and_b32 s44, s32, 1
    v_bfe_u32 v49, v0, 4, 2
    v_and_b32 v50, 15, v0
    s_lshl_b32 s34, s43, 13
    v_bfe_u32 v5, v0, 3, 1
    v_lshlrev_b32 v6, 1, v5
    v_xor_b32 v6, v6, v49
    v_lshlrev_b32 v6, 4, v6
    v_lshl_add_u32 v6, v5, 10, v6
    v_and_b32 v5, 7, v0
    v_lshl_add_u32 v6, v5, 6, v6
    v_add_u32 v38, s34, v6
    s_lshl_b32 s34, s44, 9
    s_add_u32 s34, s34, 16384
    v_xor_b32 v5, s43, v49
    v_and_b32 v5, 1, v5
    v_lshlrev_b32 v5, 5, v5
    v_lshl_add_u32 v5, v49, 11, v5
    v_bfe_u32 v6, v0, 2, 2
    v_lshl_add_u32 v5, v6, 6, v5
    v_and_b32 v6, 3, v0
    v_lshl_add_u32 v5, v6, 3, v5
    v_add_u32 v39, s34, v5
    v_xor_b32 v40, 32, v39
    s_lshl_b32 s34, s32, 11
    s_add_u32 s34, s34, 65536
    v_add_u32 v52, s34, v4
    v_cmp_eq_u32 vcc, 0, v50
    v_mov_b32 v5, 0x3f803f80
    s_cmp_ge_u32 s41, 10
    s_cselect_b32 s35, 0xf0, 0
    s_cselect_b32 s36, 0, 0x300
    s_or_b32 s35, s35, s36
    v_and_b32 v6, s35, v4
    v_add_u32 v53, s34, v6
    v_xor_b32 v54, 0x1000, v53
    v_cndmask_b32 v188, 0, v5, vcc
    v_cndmask_b32 v189, 0, v5, vcc
    v_cndmask_b32 v190, 0, v5, vcc
    v_cndmask_b32 v191, 0, v5, vcc
    s_lshl_b32 s34, s40, 2
    s_lshl_b32 s36, s43, 1
    s_add_u32 s36, s36, s34
    s_cmp_ge_u32 s41, 10
    s_cbranch_scc1 Lp1_V
    s_lshl_b32 s34, s36, 8
    s_add_u32 s34, s34, 25673728
    v_lshl_add_u32 v51, v50, 3, s34
    s_lshl_b32 s34, s2, 2
    s_add_u32 s36, s34, s32
    s_mul_i32 s34, s36, 2560
    v_mul_u32_u24 v5, 1280, v3
    v_lshl_add_u32 v5, v2, 3, v5
    s_mov_b32 s42, 0xffff0000
    s_waitcnt lgkmcnt(0)
    s_mov_b32 s24, s4
    s_mov_b32 s25, s5
    s_mov_b32 s26, 2621440
    s_mov_b32 s27, 0x20000
    buffer_load_dwordx2 v[20:21], v5, s[24:27], s34 offen offset:0
    buffer_load_dwordx2 v[22:23], v5, s[24:27], s34 offen offset:256
    buffer_load_dwordx2 v[24:25], v5, s[24:27], s34 offen offset:512
    buffer_load_dwordx2 v[26:27], v5, s[24:27], s34 offen offset:768
    buffer_load_dwordx2 v[28:29], v5, s[24:27], s34 offen offset:1024
    s_barrier
    ds_read_b64_tr_b16 v[92:93], v39 offset:0
    ds_read_b64_tr_b16 v[94:95], v39 offset:1024
    ds_read_b128 v[60:63], v38 offset:0
    ds_read_b64_tr_b16 v[96:97], v40 offset:0
    ds_read_b64_tr_b16 v[98:99], v40 offset:1024
    ds_read_b128 v[64:67], v38 offset:2048
    ds_read_b64_tr_b16 v[100:101], v39 offset:256
    ds_read_b64_tr_b16 v[102:103], v39 offset:1280
    ds_read_b128 v[68:71], v38 offset:4096
    ds_read_b64_tr_b16 v[104:105], v40 offset:256
    ds_read_b64_tr_b16 v[106:107], v40 offset:1280
    ds_read_b128 v[72:75], v38 offset:6144
    s_waitcnt lgkmcnt(0)
    v_mfma_f32_16x16x32_bf16 v[192:195], v[92:95], v[188:191], 0
    v_mfma_f32_16x16x32_bf16 v[200:203], v[100:103], v[188:191], 0
    v_mfma_f32_16x16x32_bf16 v[124:127], v[92:95], v[60:63], 0
    v_mfma_f32_16x16x32_bf16 v[140:143], v[92:95], v[64:67], 0
    v_mfma_f32_16x16x32_bf16 v[156:159], v[92:95], v[68:71], 0
    v_mfma_f32_16x16x32_bf16 v[172:175], v[92:95], v[72:75], 0
    v_mfma_f32_16x16x32_bf16 v[128:131], v[96:99], v[60:63], 0
    v_mfma_f32_16x16x32_bf16 v[144:147], v[96:99], v[64:67], 0
    v_mfma_f32_16x16x32_bf16 v[160:163], v[96:99], v[68:71], 0
    v_mfma_f32_16x16x32_bf16 v[176:179], v[96:99], v[72:75], 0
    v_mfma_f32_16x16x32_bf16 v[132:135], v[100:103], v[60:63], 0
    v_mfma_f32_16x16x32_bf16 v[148:151], v[100:103], v[64:67], 0
    v_mfma_f32_16x16x32_bf16 v[164:167], v[100:103], v[68:71], 0
    v_mfma_f32_16x16x32_bf16 v[180:183], v[100:103], v[72:75], 0
    v_mfma_f32_16x16x32_bf16 v[136:139], v[104:107], v[60:63], 0
    ds_read_b64_tr_b16 v[108:109], v39 offset:8192
    v_mfma_f32_16x16x32_bf16 v[152:155], v[104:107], v[64:67], 0
    ds_read_b64_tr_b16 v[110:111], v39 offset:9216
    v_mfma_f32_16x16x32_bf16 v[168:171], v[104:107], v[68:71], 0
    ds_read_b128 v[76:79], v38 offset:512
    v_mfma_f32_16x16x32_bf16 v[184:187], v[104:107], v[72:75], 0
    ds_read_b64_tr_b16 v[112:113], v40 offset:8192
    ds_read_b64_tr_b16 v[114:115], v40 offset:9216
    ds_read_b128 v[80:83], v38 offset:2560
    ds_read_b64_tr_b16 v[116:117], v39 offset:8448
    ds_read_b64_tr_b16 v[118:119], v39 offset:9472
    ds_read_b128 v[84:87], v38 offset:4608
    ds_read_b64_tr_b16 v[120:121], v40 offset:8448
    ds_read_b64_tr_b16 v[122:123], v40 offset:9472
    ds_read_b128 v[88:91], v38 offset:6656
    s_waitcnt lgkmcnt(0)
    s_barrier
    v_mfma_f32_16x16x32_bf16 v[192:195], v[108:111], v[188:191], v[192:195]
    v_mfma_f32_16x16x32_bf16 v[200:203], v[116:119], v[188:191], v[200:203]
    v_mfma_f32_16x16x32_bf16 v[124:127], v[108:111], v[76:79], v[124:127]
    v_mfma_f32_16x16x32_bf16 v[140:143], v[108:111], v[80:83], v[140:143]
    v_mfma_f32_16x16x32_bf16 v[156:159], v[108:111], v[84:87], v[156:159]
    v_mfma_f32_16x16x32_bf16 v[172:175], v[108:111], v[88:91], v[172:175]
    v_mfma_f32_16x16x32_bf16 v[128:131], v[112:115], v[76:79], v[128:131]
    v_mfma_f32_16x16x32_bf16 v[144:147], v[112:115], v[80:83], v[144:147]
    v_mfma_f32_16x16x32_bf16 v[160:163], v[112:115], v[84:87], v[160:163]
    v_mfma_f32_16x16x32_bf16 v[176:179], v[112:115], v[88:91], v[176:179]
    v_mfma_f32_16x16x32_bf16 v[132:135], v[116:119], v[76:79], v[132:135]
    v_mfma_f32_16x16x32_bf16 v[148:151], v[116:119], v[80:83], v[148:151]
    v_mfma_f32_16x16x32_bf16 v[164:167], v[116:119], v[84:87], v[164:167]
    v_mfma_f32_16x16x32_bf16 v[180:183], v[116:119], v[88:91], v[180:183]
    v_mfma_f32_16x16x32_bf16 v[136:139], v[120:123], v[76:79], v[136:139]
    ds_read_b64_tr_b16 v[92:93], v39 offset:32768
    v_mfma_f32_16x16x32_bf16 v[152:155], v[120:123], v[80:83], v[152:155]
    ds_read_b64_tr_b16 v[94:95], v39 offset:33792
    v_mfma_f32_16x16x32_bf16 v[168:171], v[120:123], v[84:87], v[168:171]
    ds_read_b128 v[60:63], v38 offset:32768
    v_mfma_f32_16x16x32_bf16 v[184:187], v[120:123], v[88:91], v[184:187]
    ds_read_b64_tr_b16 v[96:97], v40 offset:32768
    ds_read_b64_tr_b16 v[98:99], v40 offset:33792
    ds_read_b128 v[64:67], v38 offset:34816
    ds_read_b64_tr_b16 v[100:101], v39 offset:33024
    ds_read_b64_tr_b16 v[102:103], v39 offset:34048
    ds_read_b128 v[68:71], v38 offset:36864
    ds_read_b64_tr_b16 v[104:105], v40 offset:33024
    ds_read_b64_tr_b16 v[106:107], v40 offset:34048
    ds_read_b128 v[72:75], v38 offset:38912
    s_waitcnt lgkmcnt(0)
    v_mfma_f32_16x16x32_bf16 v[192:195], v[92:95], v[188:191], v[192:195]
    s_waitcnt vmcnt(0)
    v_lshlrev_b32 v36, 16, v20
    v_mfma_f32_16x16x32_bf16 v[200:203], v[100:103], v[188:191], v[200:203]
    v_and_b32 v37, s42, v20
    v_add_f32 v32, v36, v37
    v_mfma_f32_16x16x32_bf16 v[124:127], v[92:95], v[60:63], v[124:127]
    v_mul_f32 v34, v36, v36
    v_fmac_f32 v34, v37, v37
    v_mfma_f32_16x16x32_bf16 v[140:143], v[92:95], v[64:67], v[140:143]
    v_lshlrev_b32 v36, 16, v21
    v_and_b32 v37, s42, v21
    v_mfma_f32_16x16x32_bf16 v[156:159], v[92:95], v[68:71], v[156:159]
    v_add_f32 v32, v32, v36
    v_fmac_f32 v34, v36, v36
    v_mfma_f32_16x16x32_bf16 v[172:175], v[92:95], v[72:75], v[172:175]
    v_add_f32 v32, v32, v37
    v_fmac_f32 v34, v37, v37
    v_mfma_f32_16x16x32_bf16 v[128:131], v[96:99], v[60:63], v[128:131]
    v_lshlrev_b32 v36, 16, v22
    v_and_b32 v37, s42, v22
    v_mfma_f32_16x16x32_bf16 v[144:147], v[96:99], v[64:67], v[144:147]
    v_add_f32 v32, v32, v36
    v_fmac_f32 v34, v36, v36
    v_mfma_f32_16x16x32_bf16 v[160:163], v[96:99], v[68:71], v[160:163]
    v_add_f32 v32, v32, v37
    v_fmac_f32 v34, v37, v37
    v_mfma_f32_16x16x32_bf16 v[176:179], v[96:99], v[72:75], v[176:179]
    v_lshlrev_b32 v36, 16, v23
    v_and_b32 v37, s42, v23
    v_mfma_f32_16x16x32_bf16 v[132:135], v[100:103], v[60:63], v[132:135]
    v_add_f32 v32, v32, v36
    v_fmac_f32 v34, v36, v36
    v_mfma_f32_16x16x32_bf16 v[148:151], v[100:103], v[64:67], v[148:151]
    v_add_f32 v32, v32, v37
    v_fmac_f32 v34, v37, v37
    v_mfma_f32_16x16x32_bf16 v[164:167], v[100:103], v[68:71], v[164:167]
    v_lshlrev_b32 v36, 16, v24
    v_and_b32 v37, s42, v24
    v_mfma_f32_16x16x32_bf16 v[180:183], v[100:103], v[72:75], v[180:183]
    ds_read_b64_tr_b16 v[108:109], v39 offset:40960
    v_add_f32 v32, v32, v36
    v_mfma_f32_16x16x32_bf16 v[136:139], v[104:107], v[60:63], v[136:139]
    ds_read_b64_tr_b16 v[110:111], v39 offset:41984
    v_fmac_f32 v34, v36, v36
    v_mfma_f32_16x16x32_bf16 v[152:155], v[104:107], v[64:67], v[152:155]
    ds_read_b128 v[76:79], v38 offset:33280
    v_add_f32 v32, v32, v37
    v_mfma_f32_16x16x32_bf16 v[168:171], v[104:107], v[68:71], v[168:171]
    ds_read_b64_tr_b16 v[112:113], v40 offset:40960
    v_fmac_f32 v34, v37, v37
    v_mfma_f32_16x16x32_bf16 v[184:187], v[104:107], v[72:75], v[184:187]
    ds_read_b64_tr_b16 v[114:115], v40 offset:41984
    ds_read_b128 v[80:83], v38 offset:35328
    ds_read_b64_tr_b16 v[116:117], v39 offset:41216
    ds_read_b64_tr_b16 v[118:119], v39 offset:42240
    ds_read_b128 v[84:87], v38 offset:37376
    ds_read_b64_tr_b16 v[120:121], v40 offset:41216
    ds_read_b64_tr_b16 v[122:123], v40 offset:42240
    ds_read_b128 v[88:91], v38 offset:39424
    v_lshlrev_b32 v36, 16, v25
    v_add_u32 v38, 65536, v38
    v_add_u32 v39, 65536, v39
    v_add_u32 v40, 65536, v40
    s_waitcnt lgkmcnt(0)
    s_barrier
    v_mfma_f32_16x16x32_bf16 v[192:195], v[108:111], v[188:191], v[192:195]
    v_and_b32 v37, s42, v25
    v_add_f32 v32, v32, v36
    v_mfma_f32_16x16x32_bf16 v[200:203], v[116:119], v[188:191], v[200:203]
    v_fmac_f32 v34, v36, v36
    v_add_f32 v32, v32, v37
    v_mfma_f32_16x16x32_bf16 v[124:127], v[108:111], v[76:79], v[124:127]
    v_fmac_f32 v34, v37, v37
    v_lshlrev_b32 v36, 16, v26
    v_mfma_f32_16x16x32_bf16 v[140:143], v[108:111], v[80:83], v[140:143]
    v_and_b32 v37, s42, v26
    v_add_f32 v32, v32, v36
    v_mfma_f32_16x16x32_bf16 v[156:159], v[108:111], v[84:87], v[156:159]
    v_fmac_f32 v34, v36, v36
    v_add_f32 v32, v32, v37
    v_mfma_f32_16x16x32_bf16 v[172:175], v[108:111], v[88:91], v[172:175]
    v_fmac_f32 v34, v37, v37
    v_lshlrev_b32 v36, 16, v27
    v_mfma_f32_16x16x32_bf16 v[128:131], v[112:115], v[76:79], v[128:131]
    v_and_b32 v37, s42, v27
    v_add_f32 v32, v32, v36
    v_mfma_f32_16x16x32_bf16 v[144:147], v[112:115], v[80:83], v[144:147]
    v_fmac_f32 v34, v36, v36
    v_add_f32 v32, v32, v37
    v_mfma_f32_16x16x32_bf16 v[160:163], v[112:115], v[84:87], v[160:163]
    v_fmac_f32 v34, v37, v37
    v_lshlrev_b32 v36, 16, v28
    v_mfma_f32_16x16x32_bf16 v[176:179], v[112:115], v[88:91], v[176:179]
    v_and_b32 v37, s42, v28
    v_add_f32 v32, v32, v36
    v_mfma_f32_16x16x32_bf16 v[132:135], v[116:119], v[76:79], v[132:135]
    v_fmac_f32 v34, v36, v36
    v_add_f32 v32, v32, v37
    v_mfma_f32_16x16x32_bf16 v[148:151], v[116:119], v[80:83], v[148:151]
    v_fmac_f32 v34, v37, v37
    v_lshlrev_b32 v36, 16, v29
    v_mfma_f32_16x16x32_bf16 v[164:167], v[116:119], v[84:87], v[164:167]
    v_and_b32 v37, s42, v29
    v_add_f32 v32, v32, v36
    v_mfma_f32_16x16x32_bf16 v[180:183], v[116:119], v[88:91], v[180:183]
    ds_read_b64_tr_b16 v[92:93], v39 offset:0
    v_fmac_f32 v34, v36, v36
    v_mfma_f32_16x16x32_bf16 v[136:139], v[120:123], v[76:79], v[136:139]
    ds_read_b64_tr_b16 v[94:95], v39 offset:1024
    v_add_f32 v32, v32, v37
    v_mfma_f32_16x16x32_bf16 v[152:155], v[120:123], v[80:83], v[152:155]
    ds_read_b128 v[60:63], v38 offset:0
    v_fmac_f32 v34, v37, v37
    v_mfma_f32_16x16x32_bf16 v[168:171], v[120:123], v[84:87], v[168:171]
    ds_read_b64_tr_b16 v[96:97], v40 offset:0
    s_nop 0
    v_mfma_f32_16x16x32_bf16 v[184:187], v[120:123], v[88:91], v[184:187]
    ds_read_b64_tr_b16 v[98:99], v40 offset:1024
    ds_read_b128 v[64:67], v38 offset:2048
    ds_read_b64_tr_b16 v[100:101], v39 offset:256
    ds_read_b64_tr_b16 v[102:103], v39 offset:1280
    ds_read_b128 v[68:71], v38 offset:4096
    ds_read_b64_tr_b16 v[104:105], v40 offset:256
    ds_read_b64_tr_b16 v[106:107], v40 offset:1280
    ds_read_b128 v[72:75], v38 offset:6144
    v_add_f32_dpp v32, v32, v32 quad_perm:[1,0,3,2] row_mask:0xf bank_mask:0xf
    s_waitcnt lgkmcnt(0)
    v_mfma_f32_16x16x32_bf16 v[192:195], v[92:95], v[188:191], v[192:195]
    v_add_f32_dpp v34, v34, v34 quad_perm:[1,0,3,2] row_mask:0xf bank_mask:0xf
    s_nop 0
    v_mfma_f32_16x16x32_bf16 v[200:203], v[100:103], v[188:191], v[200:203]
    v_add_f32_dpp v32, v32, v32 quad_perm:[2,3,0,1] row_mask:0xf bank_mask:0xf
    v_add_f32_dpp v34, v34, v34 quad_perm:[2,3,0,1] row_mask:0xf bank_mask:0xf
    v_mfma_f32_16x16x32_bf16 v[124:127], v[92:95], v[60:63], v[124:127]
    s_nop 0
    v_add_f32_dpp v32, v32, v32 row_half_mirror row_mask:0xf bank_mask:0xf
    v_mfma_f32_16x16x32_bf16 v[140:143], v[92:95], v[64:67], v[140:143]
    v_add_f32_dpp v34, v34, v34 row_half_mirror row_mask:0xf bank_mask:0xf
    s_nop 0
    v_mfma_f32_16x16x32_bf16 v[156:159], v[92:95], v[68:71], v[156:159]
    v_add_f32_dpp v32, v32, v32 row_mirror row_mask:0xf bank_mask:0xf
    v_add_f32_dpp v34, v34, v34 row_mirror row_mask:0xf bank_mask:0xf
    v_mfma_f32_16x16x32_bf16 v[172:175], v[92:95], v[72:75], v[172:175]
    v_mov_b32 v33, v32
    v_mov_b32 v35, v34
    v_mfma_f32_16x16x32_bf16 v[128:131], v[96:99], v[60:63], v[128:131]
    s_nop 0
    v_permlane16_swap_b32 v32, v33
    v_mfma_f32_16x16x32_bf16 v[144:147], v[96:99], v[64:67], v[144:147]
    v_permlane16_swap_b32 v34, v35
    v_add_f32 v32, v32, v33
    v_mfma_f32_16x16x32_bf16 v[160:163], v[96:99], v[68:71], v[160:163]
    v_add_f32 v34, v34, v35
    v_mul_f32 v32, 0x3acccccd, v32
    v_mfma_f32_16x16x32_bf16 v[176:179], v[96:99], v[72:75], v[176:179]
    v_mul_f32 v34, 0x3acccccd, v34
    v_fma_f32 v34, -v32, v32, v34
    v_mfma_f32_16x16x32_bf16 v[132:135], v[100:103], v[60:63], v[132:135]
    v_max_f32 v34, 0, v34
    v_add_f32 v34, 0x3727c5ac, v34
    v_mfma_f32_16x16x32_bf16 v[148:151], v[100:103], v[64:67], v[148:151]
    v_rsq_f32 v33, v34
    s_nop 0
    v_mfma_f32_16x16x32_bf16 v[164:167], v[100:103], v[68:71], v[164:167]
    ds_read_b64_tr_b16 v[108:109], v39 offset:8192
    v_or_b32 v13, 1, v33
    v_and_b32 v5, 7, v0
    v_lshlrev_b32 v5, 2, v5
    global_load_dword v8, v5, s[18:19] sc1
    v_mfma_f32_16x16x32_bf16 v[180:183], v[100:103], v[72:75], v[180:183]
    ds_read_b64_tr_b16 v[110:111], v39 offset:9216
    v_mul_f32 v12, v32, v13
    v_mfma_f32_16x16x32_bf16 v[136:139], v[104:107], v[60:63], v[136:139]
    ds_read_b128 v[76:79], v38 offset:512
    v_mfma_f32_16x16x32_bf16 v[152:155], v[104:107], v[64:67], v[152:155]
    ds_read_b64_tr_b16 v[112:113], v40 offset:8192
    v_mfma_f32_16x16x32_bf16 v[168:171], v[104:107], v[68:71], v[168:171]
    ds_read_b64_tr_b16 v[114:115], v40 offset:9216
    v_mfma_f32_16x16x32_bf16 v[184:187], v[104:107], v[72:75], v[184:187]
    ds_read_b128 v[80:83], v38 offset:2560
    ds_read_b64_tr_b16 v[116:117], v39 offset:8448
    ds_read_b64_tr_b16 v[118:119], v39 offset:9472
    ds_read_b128 v[84:87], v38 offset:4608
    ds_read_b64_tr_b16 v[120:121], v40 offset:8448
    ds_read_b64_tr_b16 v[122:123], v40 offset:9472
    ds_read_b128 v[88:91], v38 offset:6656
    s_waitcnt lgkmcnt(0)
    s_barrier
    v_mfma_f32_16x16x32_bf16 v[192:195], v[108:111], v[188:191], v[192:195]
    v_mfma_f32_16x16x32_bf16 v[200:203], v[116:119], v[188:191], v[200:203]
    v_mfma_f32_16x16x32_bf16 v[124:127], v[108:111], v[76:79], v[124:127]
    v_mfma_f32_16x16x32_bf16 v[140:143], v[108:111], v[80:83], v[140:143]
    v_mfma_f32_16x16x32_bf16 v[156:159], v[108:111], v[84:87], v[156:159]
    v_mfma_f32_16x16x32_bf16 v[172:175], v[108:111], v[88:91], v[172:175]
    v_mfma_f32_16x16x32_bf16 v[128:131], v[112:115], v[76:79], v[128:131]
    v_mfma_f32_16x16x32_bf16 v[144:147], v[112:115], v[80:83], v[144:147]
    v_mfma_f32_16x16x32_bf16 v[160:163], v[112:115], v[84:87], v[160:163]
    v_mfma_f32_16x16x32_bf16 v[176:179], v[112:115], v[88:91], v[176:179]
    v_mfma_f32_16x16x32_bf16 v[132:135], v[116:119], v[76:79], v[132:135]
    v_mfma_f32_16x16x32_bf16 v[148:151], v[116:119], v[80:83], v[148:151]
    v_mfma_f32_16x16x32_bf16 v[164:167], v[116:119], v[84:87], v[164:167]
    ds_read_b64_tr_b16 v[92:93], v39 offset:32768
    v_mfma_f32_16x16x32_bf16 v[180:183], v[116:119], v[88:91], v[180:183]
    ds_read_b64_tr_b16 v[94:95], v39 offset:33792
    v_mfma_f32_16x16x32_bf16 v[136:139], v[120:123], v[76:79], v[136:139]
    ds_read_b128 v[60:63], v38 offset:32768
    v_mfma_f32_16x16x32_bf16 v[152:155], v[120:123], v[80:83], v[152:155]
    ds_read_b64_tr_b16 v[96:97], v40 offset:32768
    v_mfma_f32_16x16x32_bf16 v[168:171], v[120:123], v[84:87], v[168:171]
    ds_read_b64_tr_b16 v[98:99], v40 offset:33792
    v_mfma_f32_16x16x32_bf16 v[184:187], v[120:123], v[88:91], v[184:187]
    ds_read_b128 v[64:67], v38 offset:34816
    ds_read_b64_tr_b16 v[100:101], v39 offset:33024
    ds_read_b64_tr_b16 v[102:103], v39 offset:34048
    ds_read_b128 v[68:71], v38 offset:36864
    ds_read_b64_tr_b16 v[104:105], v40 offset:33024
    ds_read_b64_tr_b16 v[106:107], v40 offset:34048
    ds_read_b128 v[72:75], v38 offset:38912
    s_waitcnt lgkmcnt(0)
    v_mfma_f32_16x16x32_bf16 v[192:195], v[92:95], v[188:191], v[192:195]
    v_mfma_f32_16x16x32_bf16 v[200:203], v[100:103], v[188:191], v[200:203]
    v_mfma_f32_16x16x32_bf16 v[124:127], v[92:95], v[60:63], v[124:127]
    v_mfma_f32_16x16x32_bf16 v[140:143], v[92:95], v[64:67], v[140:143]
    v_mfma_f32_16x16x32_bf16 v[156:159], v[92:95], v[68:71], v[156:159]
    v_mfma_f32_16x16x32_bf16 v[172:175], v[92:95], v[72:75], v[172:175]
    v_mfma_f32_16x16x32_bf16 v[128:131], v[96:99], v[60:63], v[128:131]
    v_mfma_f32_16x16x32_bf16 v[144:147], v[96:99], v[64:67], v[144:147]
    v_mfma_f32_16x16x32_bf16 v[160:163], v[96:99], v[68:71], v[160:163]
    v_mfma_f32_16x16x32_bf16 v[176:179], v[96:99], v[72:75], v[176:179]
    v_mfma_f32_16x16x32_bf16 v[132:135], v[100:103], v[60:63], v[132:135]
    v_mfma_f32_16x16x32_bf16 v[148:151], v[100:103], v[64:67], v[148:151]
    ds_read_b64_tr_b16 v[108:109], v39 offset:40960
    v_mfma_f32_16x16x32_bf16 v[164:167], v[100:103], v[68:71], v[164:167]
    ds_read_b64_tr_b16 v[110:111], v39 offset:41984
    v_mfma_f32_16x16x32_bf16 v[180:183], v[100:103], v[72:75], v[180:183]
    ds_read_b128 v[76:79], v38 offset:33280
    v_mfma_f32_16x16x32_bf16 v[136:139], v[104:107], v[60:63], v[136:139]
    ds_read_b64_tr_b16 v[112:113], v40 offset:40960
    v_mfma_f32_16x16x32_bf16 v[152:155], v[104:107], v[64:67], v[152:155]
    ds_read_b64_tr_b16 v[114:115], v40 offset:41984
    v_mfma_f32_16x16x32_bf16 v[168:171], v[104:107], v[68:71], v[168:171]
    ds_read_b128 v[80:83], v38 offset:35328
    v_mfma_f32_16x16x32_bf16 v[184:187], v[104:107], v[72:75], v[184:187]
    ds_read_b64_tr_b16 v[116:117], v39 offset:41216
    ds_read_b64_tr_b16 v[118:119], v39 offset:42240
    ds_read_b128 v[84:87], v38 offset:37376
    ds_read_b64_tr_b16 v[120:121], v40 offset:41216
    ds_read_b64_tr_b16 v[122:123], v40 offset:42240
    ds_read_b128 v[88:91], v38 offset:39424
    v_add_u32 v38, 65536, v38
    v_add_u32 v39, 65536, v39
    v_add_u32 v40, 65536, v40
    s_waitcnt lgkmcnt(0)
    s_barrier
    v_mfma_f32_16x16x32_bf16 v[192:195], v[108:111], v[188:191], v[192:195]
    v_mfma_f32_16x16x32_bf16 v[200:203], v[116:119], v[188:191], v[200:203]
    v_mfma_f32_16x16x32_bf16 v[124:127], v[108:111], v[76:79], v[124:127]
    v_mfma_f32_16x16x32_bf16 v[140:143], v[108:111], v[80:83], v[140:143]
    v_mfma_f32_16x16x32_bf16 v[156:159], v[108:111], v[84:87], v[156:159]
    v_mfma_f32_16x16x32_bf16 v[172:175], v[108:111], v[88:91], v[172:175]
    v_mfma_f32_16x16x32_bf16 v[128:131], v[112:115], v[76:79], v[128:131]
    v_mfma_f32_16x16x32_bf16 v[144:147], v[112:115], v[80:83], v[144:147]
    v_mfma_f32_16x16x32_bf16 v[160:163], v[112:115], v[84:87], v[160:163]
    v_mfma_f32_16x16x32_bf16 v[176:179], v[112:115], v[88:91], v[176:179]
    v_mfma_f32_16x16x32_bf16 v[132:135], v[116:119], v[76:79], v[132:135]
    ds_read_b64_tr_b16 v[92:93], v39 offset:0
    v_mfma_f32_16x16x32_bf16 v[148:151], v[116:119], v[80:83], v[148:151]
    ds_read_b64_tr_b16 v[94:95], v39 offset:1024
    v_mfma_f32_16x16x32_bf16 v[164:167], v[116:119], v[84:87], v[164:167]
    ds_read_b128 v[60:63], v38 offset:0
    s_waitcnt vmcnt(0)
    v_cmp_ne_u32 vcc, 0, v8
    s_cmp_eq_u64 vcc, -1
    s_cbranch_scc0 Lp1_rwT
Lp1_rokT:
    s_lshl_b32 s34, s2, 2
    s_add_u32 s34, s34, s32
    s_lshl_b32 s34, s34, 4
    s_add_u32 s34, s34, 25673728
    v_lshlrev_b32 v6, 3, v3
    s_mov_b32 exec_lo, 1
    s_mov_b32 exec_hi, 1
    buffer_store_dwordx2 v[12:13], v6, s[20:23], s34 offen sc1
    s_mov_b64 exec, -1
    v_mfma_f32_16x16x32_bf16 v[180:183], v[116:119], v[88:91], v[180:183]
    ds_read_b64_tr_b16 v[96:97], v40 offset:0
    v_mfma_f32_16x16x32_bf16 v[136:139], v[120:123], v[76:79], v[136:139]
    ds_read_b64_tr_b16 v[98:99], v40 offset:1024
    v_mfma_f32_16x16x32_bf16 v[152:155], v[120:123], v[80:83], v[152:155]
    ds_read_b128 v[64:67], v38 offset:2048
    v_mfma_f32_16x16x32_bf16 v[168:171], v[120:123], v[84:87], v[168:171]
    ds_read_b64_tr_b16 v[100:101], v39 offset:256
    v_mfma_f32_16x16x32_bf16 v[184:187], v[120:123], v[88:91], v[184:187]
    ds_read_b64_tr_b16 v[102:103], v39 offset:1280
    ds_read_b128 v[68:71], v38 offset:4096
    ds_read_b64_tr_b16 v[104:105], v40 offset:256
    ds_read_b64_tr_b16 v[106:107], v40 offset:1280
    ds_read_b128 v[72:75], v38 offset:6144
    s_waitcnt lgkmcnt(0)
    v_mfma_f32_16x16x32_bf16 v[192:195], v[92:95], v[188:191], v[192:195]
    s_lshl_b32 s34, s40, 2
    s_lshl_b32 s36, s43, 1
    v_mfma_f32_16x16x32_bf16 v[200:203], v[100:103], v[188:191], v[200:203]
    s_add_u32 s36, s36, s34
    s_cmp_ge_u32 s41, 5
    v_mfma_f32_16x16x32_bf16 v[124:127], v[92:95], v[60:63], v[124:127]
    s_cselect_b32 s45, 1, 0
    s_cselect_b32 s34, 5, 0
    v_mfma_f32_16x16x32_bf16 v[140:143], v[92:95], v[64:67], v[140:143]
    s_cselect_b32 s48, 1.0, 0x3ea52b5c
    s_cselect_b64 vcc, -1, 0
    v_mfma_f32_16x16x32_bf16 v[156:159], v[92:95], v[68:71], v[156:159]
    s_sub_u32 s41, s41, s34
    s_lshl_b32 s46, 81920, s45
    v_mfma_f32_16x16x32_bf16 v[172:175], v[92:95], v[72:75], v[172:175]
    s_mov_b32 s47, 0
    v_mfma_f32_16x16x32_bf16 v[128:131], v[96:99], v[60:63], v[128:131]
    s_xor_b32 s37, s43, 0
    s_lshl_b32 s35, s41, 1
    v_mfma_f32_16x16x32_bf16 v[144:147], v[96:99], v[64:67], v[144:147]
    s_add_u32 s35, s35, s44
    s_lshl_b32 s35, s35, 2
    v_mfma_f32_16x16x32_bf16 v[160:163], v[96:99], v[68:71], v[160:163]
    v_mfma_f32_16x16x32_bf16 v[176:179], v[96:99], v[72:75], v[176:179]
    ds_read_b64_tr_b16 v[108:109], v39 offset:8192
    v_mfma_f32_16x16x32_bf16 v[132:135], v[100:103], v[60:63], v[132:135]
    ds_read_b64_tr_b16 v[110:111], v39 offset:9216
    v_mfma_f32_16x16x32_bf16 v[148:151], v[100:103], v[64:67], v[148:151]
    ds_read_b128 v[76:79], v38 offset:512
    v_mfma_f32_16x16x32_bf16 v[164:167], v[100:103], v[68:71], v[164:167]
    ds_read_b64_tr_b16 v[112:113], v40 offset:8192
    v_mfma_f32_16x16x32_bf16 v[180:183], v[100:103], v[72:75], v[180:183]
    ds_read_b64_tr_b16 v[114:115], v40 offset:9216
    v_mfma_f32_16x16x32_bf16 v[136:139], v[104:107], v[60:63], v[136:139]
    ds_read_b128 v[80:83], v38 offset:2560
    v_mfma_f32_16x16x32_bf16 v[152:155], v[104:107], v[64:67], v[152:155]
    ds_read_b64_tr_b16 v[116:117], v39 offset:8448
    v_mfma_f32_16x16x32_bf16 v[168:171], v[104:107], v[68:71], v[168:171]
    ds_read_b64_tr_b16 v[118:119], v39 offset:9472
    v_mfma_f32_16x16x32_bf16 v[184:187], v[104:107], v[72:75], v[184:187]
    ds_read_b128 v[84:87], v38 offset:4608
    ds_read_b64_tr_b16 v[120:121], v40 offset:8448
    ds_read_b64_tr_b16 v[122:123], v40 offset:9472
    ds_read_b128 v[88:91], v38 offset:6656
    v_add_u32 v38, -131072, v38
    v_add_u32 v39, -131072, v39
    v_add_u32 v40, -131072, v40
    s_waitcnt lgkmcnt(0)
    s_barrier
    v_mfma_f32_16x16x32_bf16 v[192:195], v[108:111], v[188:191], v[192:195]
    s_add_u32 s37, s37, s35
    s_lshl_b32 s37, s37, 1
    v_mfma_f32_16x16x32_bf16 v[200:203], v[116:119], v[188:191], v[200:203]
    s_mul_i32 s35, s37, 13108
    s_lshr_b32 s35, s35, 16
    v_mfma_f32_16x16x32_bf16 v[124:127], v[108:111], v[76:79], v[124:127]
    s_mul_i32 s34, s35, 5
    s_sub_u32 s34, s37, s34
    v_mfma_f32_16x16x32_bf16 v[140:143], v[108:111], v[80:83], v[140:143]
    s_lshl_b32 s35, s35, 1
    s_cmp_eq_u32 s34, 2
    v_mfma_f32_16x16x32_bf16 v[156:159], v[108:111], v[84:87], v[156:159]
    s_cselect_b32 s49, 1, 0
    s_or_b32 s47, s47, s49
    v_mfma_f32_16x16x32_bf16 v[172:175], v[108:111], v[88:91], v[172:175]
    s_cmp_ge_u32 s34, 3
    s_cselect_b32 s49, 3, 0
    v_mfma_f32_16x16x32_bf16 v[128:131], v[112:115], v[76:79], v[128:131]
    s_addc_u32 s35, s35, 0
    s_sub_u32 s34, s34, s49
    v_mfma_f32_16x16x32_bf16 v[144:147], v[112:115], v[80:83], v[144:147]
    s_mul_i32 s49, s35, s46
    s_lshl_b32 s34, s34, 9
    v_mfma_f32_16x16x32_bf16 v[160:163], v[112:115], v[84:87], v[160:163]
    ds_read_b64_tr_b16 v[92:93], v39 offset:0
    v_mfma_f32_16x16x32_bf16 v[176:179], v[112:115], v[88:91], v[176:179]
    ds_read_b64_tr_b16 v[94:95], v39 offset:1024
    v_mfma_f32_16x16x32_bf16 v[132:135], v[116:119], v[76:79], v[132:135]
    ds_read_b128 v[60:63], v38 offset:0
    v_mfma_f32_16x16x32_bf16 v[148:151], v[116:119], v[80:83], v[148:151]
    ds_read_b64_tr_b16 v[96:97], v40 offset:0
    v_mfma_f32_16x16x32_bf16 v[164:167], v[116:119], v[84:87], v[164:167]
    ds_read_b64_tr_b16 v[98:99], v40 offset:1024
    v_mfma_f32_16x16x32_bf16 v[180:183], v[116:119], v[88:91], v[180:183]
    ds_read_b128 v[64:67], v38 offset:2048
    v_mfma_f32_16x16x32_bf16 v[136:139], v[120:123], v[76:79], v[136:139]
    ds_read_b64_tr_b16 v[100:101], v39 offset:256
    v_mfma_f32_16x16x32_bf16 v[152:155], v[120:123], v[80:83], v[152:155]
    ds_read_b64_tr_b16 v[102:103], v39 offset:1280
    v_mfma_f32_16x16x32_bf16 v[168:171], v[120:123], v[84:87], v[168:171]
    ds_read_b128 v[68:71], v38 offset:4096
    v_mfma_f32_16x16x32_bf16 v[184:187], v[120:123], v[88:91], v[184:187]
    ds_read_b64_tr_b16 v[104:105], v40 offset:256
    ds_read_b64_tr_b16 v[106:107], v40 offset:1280
    ds_read_b128 v[72:75], v38 offset:6144
    s_waitcnt lgkmcnt(0)
    v_mfma_f32_16x16x32_bf16 v[192:195], v[92:95], v[188:191], v[192:195]
    s_add_u32 s49, s49, s34
    s_add_u32 s37, s37, 1
    v_mfma_f32_16x16x32_bf16 v[200:203], v[100:103], v[188:191], v[200:203]
    s_mul_i32 s35, s37, 13108
    s_lshr_b32 s35, s35, 16
    v_mfma_f32_16x16x32_bf16 v[124:127], v[92:95], v[60:63], v[124:127]
    s_mul_i32 s34, s35, 5
    s_sub_u32 s34, s37, s34
    v_mfma_f32_16x16x32_bf16 v[140:143], v[92:95], v[64:67], v[140:143]
    s_lshl_b32 s35, s35, 1
    s_cmp_eq_u32 s34, 2
    v_mfma_f32_16x16x32_bf16 v[156:159], v[92:95], v[68:71], v[156:159]
    s_cselect_b32 s50, 2, 0
    s_or_b32 s47, s47, s50
    v_mfma_f32_16x16x32_bf16 v[172:175], v[92:95], v[72:75], v[172:175]
    s_cmp_ge_u32 s34, 3
    s_cselect_b32 s50, 3, 0
    v_mfma_f32_16x16x32_bf16 v[128:131], v[96:99], v[60:63], v[128:131]
    s_addc_u32 s35, s35, 0
    s_sub_u32 s34, s34, s50
    v_mfma_f32_16x16x32_bf16 v[144:147], v[96:99], v[64:67], v[144:147]
    ds_read_b64_tr_b16 v[108:109], v39 offset:8192
    s_mul_i32 s50, s35, s46
    v_mfma_f32_16x16x32_bf16 v[160:163], v[96:99], v[68:71], v[160:163]
    ds_read_b64_tr_b16 v[110:111], v39 offset:9216
    s_lshl_b32 s34, s34, 9
    v_mfma_f32_16x16x32_bf16 v[176:179], v[96:99], v[72:75], v[176:179]
    ds_read_b128 v[76:79], v38 offset:512
    v_mfma_f32_16x16x32_bf16 v[132:135], v[100:103], v[60:63], v[132:135]
    ds_read_b64_tr_b16 v[112:113], v40 offset:8192
    v_mfma_f32_16x16x32_bf16 v[148:151], v[100:103], v[64:67], v[148:151]
    ds_read_b64_tr_b16 v[114:115], v40 offset:9216
    v_mfma_f32_16x16x32_bf16 v[164:167], v[100:103], v[68:71], v[164:167]
    ds_read_b128 v[80:83], v38 offset:2560
    v_mfma_f32_16x16x32_bf16 v[180:183], v[100:103], v[72:75], v[180:183]
    ds_read_b64_tr_b16 v[116:117], v39 offset:8448
    v_mfma_f32_16x16x32_bf16 v[136:139], v[104:107], v[60:63], v[136:139]
    ds_read_b64_tr_b16 v[118:119], v39 offset:9472
    v_mfma_f32_16x16x32_bf16 v[152:155], v[104:107], v[64:67], v[152:155]
    ds_read_b128 v[84:87], v38 offset:4608
    v_mfma_f32_16x16x32_bf16 v[168:171], v[104:107], v[68:71], v[168:171]
    ds_read_b64_tr_b16 v[120:121], v40 offset:8448
    v_mfma_f32_16x16x32_bf16 v[184:187], v[104:107], v[72:75], v[184:187]
    ds_read_b64_tr_b16 v[122:123], v40 offset:9472
    ds_read_b128 v[88:91], v38 offset:6656
    s_waitcnt lgkmcnt(0)
    s_barrier
    v_mfma_f32_16x16x32_bf16 v[192:195], v[108:111], v[188:191], v[192:195]
    s_add_u32 s50, s50, s34
    s_xor_b32 s37, s43, 1
    v_mfma_f32_16x16x32_bf16 v[200:203], v[116:119], v[188:191], v[200:203]
    s_lshl_b32 s35, s41, 1
    s_add_u32 s35, s35, s44
    v_mfma_f32_16x16x32_bf16 v[124:127], v[108:111], v[76:79], v[124:127]
    s_lshl_b32 s35, s35, 2
    s_add_u32 s37, s37, s35
    v_mfma_f32_16x16x32_bf16 v[140:143], v[108:111], v[80:83], v[140:143]
    s_lshl_b32 s37, s37, 1
    s_mul_i32 s35, s37, 13108
    v_mfma_f32_16x16x32_bf16 v[156:159], v[108:111], v[84:87], v[156:159]
    s_lshr_b32 s35, s35, 16
    s_mul_i32 s34, s35, 5
    v_mfma_f32_16x16x32_bf16 v[172:175], v[108:111], v[88:91], v[172:175]
    s_sub_u32 s34, s37, s34
    s_lshl_b32 s35, s35, 1
    v_mfma_f32_16x16x32_bf16 v[128:131], v[112:115], v[76:79], v[128:131]
    s_branch Lpg1s
Lpg1:
    s_setpc_b64 s[38:39]
Lpg1s:
    ds_read_b64_tr_b16 v[92:93], v39 offset:32768
    s_cmp_eq_u32 s34, 2
    v_mfma_f32_16x16x32_bf16 v[144:147], v[112:115], v[80:83], v[144:147]
    ds_read_b64_tr_b16 v[94:95], v39 offset:33792
    s_cselect_b32 s51, 4, 0
    v_mfma_f32_16x16x32_bf16 v[160:163], v[112:115], v[84:87], v[160:163]
    ds_read_b128 v[60:63], v38 offset:32768
    s_or_b32 s47, s47, s51
    v_mfma_f32_16x16x32_bf16 v[176:179], v[112:115], v[88:91], v[176:179]
    ds_read_b64_tr_b16 v[96:97], v40 offset:32768
    s_cmp_ge_u32 s34, 3
    v_mfma_f32_16x16x32_bf16 v[132:135], v[116:119], v[76:79], v[132:135]
    ds_read_b64_tr_b16 v[98:99], v40 offset:33792
    v_mfma_f32_16x16x32_bf16 v[148:151], v[116:119], v[80:83], v[148:151]
    ds_read_b128 v[64:67], v38 offset:34816
    v_mfma_f32_16x16x32_bf16 v[164:167], v[116:119], v[84:87], v[164:167]
    ds_read_b64_tr_b16 v[100:101], v39 offset:33024
    v_mfma_f32_16x16x32_bf16 v[180:183], v[116:119], v[88:91], v[180:183]
    ds_read_b64_tr_b16 v[102:103], v39 offset:34048
    v_mfma_f32_16x16x32_bf16 v[136:139], v[120:123], v[76:79], v[136:139]
    ds_read_b128 v[68:71], v38 offset:36864
    v_mfma_f32_16x16x32_bf16 v[152:155], v[120:123], v[80:83], v[152:155]
    ds_read_b64_tr_b16 v[104:105], v40 offset:33024
    v_mfma_f32_16x16x32_bf16 v[168:171], v[120:123], v[84:87], v[168:171]
    ds_read_b64_tr_b16 v[106:107], v40 offset:34048
    v_mfma_f32_16x16x32_bf16 v[184:187], v[120:123], v[88:91], v[184:187]
    ds_read_b128 v[72:75], v38 offset:38912
    s_waitcnt lgkmcnt(0)
    v_mfma_f32_16x16x32_bf16 v[192:195], v[92:95], v[188:191], v[192:195]
    s_cselect_b32 s51, 3, 0
    s_addc_u32 s35, s35, 0
    v_mfma_f32_16x16x32_bf16 v[200:203], v[100:103], v[188:191], v[200:203]
    s_sub_u32 s34, s34, s51
    s_mul_i32 s51, s35, s46
    v_mfma_f32_16x16x32_bf16 v[124:127], v[92:95], v[60:63], v[124:127]
    s_lshl_b32 s34, s34, 9
    s_add_u32 s51, s51, s34
    v_mfma_f32_16x16x32_bf16 v[140:143], v[92:95], v[64:67], v[140:143]
    s_add_u32 s37, s37, 1
    s_mul_i32 s35, s37, 13108
    v_mfma_f32_16x16x32_bf16 v[156:159], v[92:95], v[68:71], v[156:159]
    s_lshr_b32 s35, s35, 16
    s_mul_i32 s34, s35, 5
    v_mfma_f32_16x16x32_bf16 v[172:175], v[92:95], v[72:75], v[172:175]
    ds_read_b64_tr_b16 v[108:109], v39 offset:40960
    s_sub_u32 s34, s37, s34
    v_mfma_f32_16x16x32_bf16 v[128:131], v[96:99], v[60:63], v[128:131]
    ds_read_b64_tr_b16 v[110:111], v39 offset:41984
    s_lshl_b32 s35, s35, 1
    v_mfma_f32_16x16x32_bf16 v[144:147], v[96:99], v[64:67], v[144:147]
    ds_read_b128 v[76:79], v38 offset:33280
    s_cmp_eq_u32 s34, 2
    v_mfma_f32_16x16x32_bf16 v[160:163], v[96:99], v[68:71], v[160:163]
    ds_read_b64_tr_b16 v[112:113], v40 offset:40960
    s_cselect_b32 s52, 8, 0
    v_mfma_f32_16x16x32_bf16 v[176:179], v[96:99], v[72:75], v[176:179]
    ds_read_b64_tr_b16 v[114:115], v40 offset:41984
    s_or_b32 s47, s47, s52
    v_mfma_f32_16x16x32_bf16 v[132:135], v[100:103], v[60:63], v[132:135]
    ds_read_b128 v[80:83], v38 offset:35328
    s_cmp_ge_u32 s34, 3
    v_mfma_f32_16x16x32_bf16 v[148:151], v[100:103], v[64:67], v[148:151]
    ds_read_b64_tr_b16 v[116:117], v39 offset:41216
    v_mfma_f32_16x16x32_bf16 v[164:167], v[100:103], v[68:71], v[164:167]
    ds_read_b64_tr_b16 v[118:119], v39 offset:42240
    v_mfma_f32_16x16x32_bf16 v[180:183], v[100:103], v[72:75], v[180:183]
    ds_read_b128 v[84:87], v38 offset:37376
    v_mfma_f32_16x16x32_bf16 v[136:139], v[104:107], v[60:63], v[136:139]
    ds_read_b64_tr_b16 v[120:121], v40 offset:41216
    v_mfma_f32_16x16x32_bf16 v[152:155], v[104:107], v[64:67], v[152:155]
    ds_read_b64_tr_b16 v[122:123], v40 offset:42240
    v_mfma_f32_16x16x32_bf16 v[168:171], v[104:107], v[68:71], v[168:171]
    ds_read_b128 v[88:91], v38 offset:39424
    v_mfma_f32_16x16x32_bf16 v[184:187], v[104:107], v[72:75], v[184:187]
    v_add_u32 v38, 65536, v38
    v_add_u32 v39, 65536, v39
    v_add_u32 v40, 65536, v40
    s_waitcnt lgkmcnt(0)
    s_barrier
    v_mfma_f32_16x16x32_bf16 v[192:195], v[108:111], v[188:191], v[192:195]
    s_cselect_b32 s52, 3, 0
    s_addc_u32 s35, s35, 0
    v_mfma_f32_16x16x32_bf16 v[200:203], v[116:119], v[188:191], v[200:203]
    s_sub_u32 s34, s34, s52
    s_mul_i32 s52, s35, s46
    v_mfma_f32_16x16x32_bf16 v[124:127], v[108:111], v[76:79], v[124:127]
    s_lshl_b32 s34, s34, 9
    s_add_u32 s52, s52, s34
    v_mfma_f32_16x16x32_bf16 v[140:143], v[108:111], v[80:83], v[140:143]
    s_xor_b32 s37, s43, 2
    s_lshl_b32 s35, s41, 1
    v_mfma_f32_16x16x32_bf16 v[156:159], v[108:111], v[84:87], v[156:159]
    ds_read_b64_tr_b16 v[92:93], v39 offset:0
    s_add_u32 s35, s35, s44
    v_mfma_f32_16x16x32_bf16 v[172:175], v[108:111], v[88:91], v[172:175]
    ds_read_b64_tr_b16 v[94:95], v39 offset:1024
    s_lshl_b32 s35, s35, 2
    v_mfma_f32_16x16x32_bf16 v[128:131], v[112:115], v[76:79], v[128:131]
    ds_read_b128 v[60:63], v38 offset:0
    s_add_u32 s37, s37, s35
    v_mfma_f32_16x16x32_bf16 v[144:147], v[112:115], v[80:83], v[144:147]
    ds_read_b64_tr_b16 v[96:97], v40 offset:0
    s_lshl_b32 s37, s37, 1
    v_mfma_f32_16x16x32_bf16 v[160:163], v[112:115], v[84:87], v[160:163]
    ds_read_b64_tr_b16 v[98:99], v40 offset:1024
    s_mul_i32 s35, s37, 13108
    v_mfma_f32_16x16x32_bf16 v[176:179], v[112:115], v[88:91], v[176:179]
    ds_read_b128 v[64:67], v38 offset:2048
    s_lshr_b32 s35, s35, 16
    v_mfma_f32_16x16x32_bf16 v[132:135], v[116:119], v[76:79], v[132:135]
    ds_read_b64_tr_b16 v[100:101], v39 offset:256
    s_mul_i32 s34, s35, 5
    v_mfma_f32_16x16x32_bf16 v[148:151], v[116:119], v[80:83], v[148:151]
    ds_read_b64_tr_b16 v[102:103], v39 offset:1280
    s_sub_u32 s34, s37, s34
    v_mfma_f32_16x16x32_bf16 v[164:167], v[116:119], v[84:87], v[164:167]
    ds_read_b128 v[68:71], v38 offset:4096
    v_mfma_f32_16x16x32_bf16 v[180:183], v[116:119], v[88:91], v[180:183]
    ds_read_b64_tr_b16 v[104:105], v40 offset:256
    v_mfma_f32_16x16x32_bf16 v[136:139], v[120:123], v[76:79], v[136:139]
    ds_read_b64_tr_b16 v[106:107], v40 offset:1280
    v_mfma_f32_16x16x32_bf16 v[152:155], v[120:123], v[80:83], v[152:155]
    ds_read_b128 v[72:75], v38 offset:6144
    v_mfma_f32_16x16x32_bf16 v[168:171], v[120:123], v[84:87], v[168:171]
    v_mfma_f32_16x16x32_bf16 v[184:187], v[120:123], v[88:91], v[184:187]
    s_waitcnt lgkmcnt(0)
    v_mfma_f32_16x16x32_bf16 v[192:195], v[92:95], v[188:191], v[192:195]
    s_lshl_b32 s35, s35, 1
    s_cmp_eq_u32 s34, 2
    v_mfma_f32_16x16x32_bf16 v[200:203], v[100:103], v[188:191], v[200:203]
    s_cselect_b32 s53, 16, 0
    s_or_b32 s47, s47, s53
    v_mfma_f32_16x16x32_bf16 v[124:127], v[92:95], v[60:63], v[124:127]
    s_cmp_ge_u32 s34, 3
    s_cselect_b32 s53, 3, 0
    v_mfma_f32_16x16x32_bf16 v[140:143], v[92:95], v[64:67], v[140:143]
    ds_read_b64_tr_b16 v[108:109], v39 offset:8192
    s_addc_u32 s35, s35, 0
    v_mfma_f32_16x16x32_bf16 v[156:159], v[92:95], v[68:71], v[156:159]
    ds_read_b64_tr_b16 v[110:111], v39 offset:9216
    s_sub_u32 s34, s34, s53
    v_mfma_f32_16x16x32_bf16 v[172:175], v[92:95], v[72:75], v[172:175]
    ds_read_b128 v[76:79], v38 offset:512
    s_mul_i32 s53, s35, s46
    v_mfma_f32_16x16x32_bf16 v[128:131], v[96:99], v[60:63], v[128:131]
    ds_read_b64_tr_b16 v[112:113], v40 offset:8192
    s_lshl_b32 s34, s34, 9
    v_mfma_f32_16x16x32_bf16 v[144:147], v[96:99], v[64:67], v[144:147]
    ds_read_b64_tr_b16 v[114:115], v40 offset:9216
    s_add_u32 s53, s53, s34
    v_mfma_f32_16x16x32_bf16 v[160:163], v[96:99], v[68:71], v[160:163]
    ds_read_b128 v[80:83], v38 offset:2560
    s_add_u32 s37, s37, 1
    v_mfma_f32_16x16x32_bf16 v[176:179], v[96:99], v[72:75], v[176:179]
    ds_read_b64_tr_b16 v[116:117], v39 offset:8448
    s_mul_i32 s35, s37, 13108
    v_mfma_f32_16x16x32_bf16 v[132:135], v[100:103], v[60:63], v[132:135]
    ds_read_b64_tr_b16 v[118:119], v39 offset:9472
    s_lshr_b32 s35, s35, 16
    v_mfma_f32_16x16x32_bf16 v[148:151], v[100:103], v[64:67], v[148:151]
    ds_read_b128 v[84:87], v38 offset:4608
    s_mul_i32 s34, s35, 5
    v_mfma_f32_16x16x32_bf16 v[164:167], v[100:103], v[68:71], v[164:167]
    ds_read_b64_tr_b16 v[120:121], v40 offset:8448
    s_sub_u32 s34, s37, s34
    v_mfma_f32_16x16x32_bf16 v[180:183], v[100:103], v[72:75], v[180:183]
    ds_read_b64_tr_b16 v[122:123], v40 offset:9472
    v_mfma_f32_16x16x32_bf16 v[136:139], v[104:107], v[60:63], v[136:139]
    ds_read_b128 v[88:91], v38 offset:6656
    v_mfma_f32_16x16x32_bf16 v[152:155], v[104:107], v[64:67], v[152:155]
    v_mfma_f32_16x16x32_bf16 v[168:171], v[104:107], v[68:71], v[168:171]
    v_mfma_f32_16x16x32_bf16 v[184:187], v[104:107], v[72:75], v[184:187]
    s_waitcnt lgkmcnt(0)
    s_barrier
    v_mfma_f32_16x16x32_bf16 v[192:195], v[108:111], v[188:191], v[192:195]
    ds_read_b64_tr_b16 v[92:93], v39 offset:32768
    s_lshl_b32 s35, s35, 1
    v_mfma_f32_16x16x32_bf16 v[200:203], v[116:119], v[188:191], v[200:203]
    ds_read_b64_tr_b16 v[94:95], v39 offset:33792
    s_cmp_eq_u32 s34, 2
    v_mfma_f32_16x16x32_bf16 v[124:127], v[108:111], v[76:79], v[124:127]
    ds_read_b128 v[60:63], v38 offset:32768
    s_cselect_b32 s54, 32, 0
    v_mfma_f32_16x16x32_bf16 v[140:143], v[108:111], v[80:83], v[140:143]
    ds_read_b64_tr_b16 v[96:97], v40 offset:32768
    s_or_b32 s47, s47, s54
    v_mfma_f32_16x16x32_bf16 v[156:159], v[108:111], v[84:87], v[156:159]
    ds_read_b64_tr_b16 v[98:99], v40 offset:33792
    s_cmp_ge_u32 s34, 3
    v_mfma_f32_16x16x32_bf16 v[172:175], v[108:111], v[88:91], v[172:175]
    ds_read_b128 v[64:67], v38 offset:34816
    s_cselect_b32 s54, 3, 0
    v_mfma_f32_16x16x32_bf16 v[128:131], v[112:115], v[76:79], v[128:131]
    ds_read_b64_tr_b16 v[100:101], v39 offset:33024
    s_addc_u32 s35, s35, 0
    v_mfma_f32_16x16x32_bf16 v[144:147], v[112:115], v[80:83], v[144:147]
    ds_read_b64_tr_b16 v[102:103], v39 offset:34048
    s_sub_u32 s34, s34, s54
    v_mfma_f32_16x16x32_bf16 v[160:163], v[112:115], v[84:87], v[160:163]
    ds_read_b128 v[68:71], v38 offset:36864
    s_mul_i32 s54, s35, s46
    v_mfma_f32_16x16x32_bf16 v[176:179], v[112:115], v[88:91], v[176:179]
    ds_read_b64_tr_b16 v[104:105], v40 offset:33024
    s_lshl_b32 s34, s34, 9
    v_mfma_f32_16x16x32_bf16 v[132:135], v[116:119], v[76:79], v[132:135]
    ds_read_b64_tr_b16 v[106:107], v40 offset:34048
    s_add_u32 s54, s54, s34
    v_mfma_f32_16x16x32_bf16 v[148:151], v[116:119], v[80:83], v[148:151]
    ds_read_b128 v[72:75], v38 offset:38912
    s_xor_b32 s37, s43, 3
    v_mfma_f32_16x16x32_bf16 v[164:167], v[116:119], v[84:87], v[164:167]
    s_lshl_b32 s35, s41, 1
    s_add_u32 s35, s35, s44
    v_mfma_f32_16x16x32_bf16 v[180:183], v[116:119], v[88:91], v[180:183]
    s_lshl_b32 s35, s35, 2
    s_add_u32 s37, s37, s35
    v_mfma_f32_16x16x32_bf16 v[136:139], v[120:123], v[76:79], v[136:139]
    v_mfma_f32_16x16x32_bf16 v[152:155], v[120:123], v[80:83], v[152:155]
    v_mfma_f32_16x16x32_bf16 v[168:171], v[120:123], v[84:87], v[168:171]
    v_mfma_f32_16x16x32_bf16 v[184:187], v[120:123], v[88:91], v[184:187]
    s_waitcnt lgkmcnt(0)
    v_mfma_f32_16x16x32_bf16 v[192:195], v[92:95], v[188:191], v[192:195]
    ds_read_b64_tr_b16 v[108:109], v39 offset:40960
    s_lshl_b32 s37, s37, 1
    v_mfma_f32_16x16x32_bf16 v[200:203], v[100:103], v[188:191], v[200:203]
    ds_read_b64_tr_b16 v[110:111], v39 offset:41984
    s_mul_i32 s35, s37, 13108
    v_mfma_f32_16x16x32_bf16 v[124:127], v[92:95], v[60:63], v[124:127]
    ds_read_b128 v[76:79], v38 offset:33280
    s_lshr_b32 s35, s35, 16
    v_mfma_f32_16x16x32_bf16 v[140:143], v[92:95], v[64:67], v[140:143]
    ds_read_b64_tr_b16 v[112:113], v40 offset:40960
    s_mul_i32 s34, s35, 5
    v_mfma_f32_16x16x32_bf16 v[156:159], v[92:95], v[68:71], v[156:159]
    ds_read_b64_tr_b16 v[114:115], v40 offset:41984
    s_sub_u32 s34, s37, s34
    v_mfma_f32_16x16x32_bf16 v[172:175], v[92:95], v[72:75], v[172:175]
    ds_read_b128 v[80:83], v38 offset:35328
    s_lshl_b32 s35, s35, 1
    v_mfma_f32_16x16x32_bf16 v[128:131], v[96:99], v[60:63], v[128:131]
    ds_read_b64_tr_b16 v[116:117], v39 offset:41216
    s_cmp_eq_u32 s34, 2
    v_mfma_f32_16x16x32_bf16 v[144:147], v[96:99], v[64:67], v[144:147]
    ds_read_b64_tr_b16 v[118:119], v39 offset:42240
    s_cselect_b32 s55, 64, 0
    v_mfma_f32_16x16x32_bf16 v[160:163], v[96:99], v[68:71], v[160:163]
    ds_read_b128 v[84:87], v38 offset:37376
    s_or_b32 s47, s47, s55
    v_mfma_f32_16x16x32_bf16 v[176:179], v[96:99], v[72:75], v[176:179]
    ds_read_b64_tr_b16 v[120:121], v40 offset:41216
    s_cmp_ge_u32 s34, 3
    v_mfma_f32_16x16x32_bf16 v[132:135], v[100:103], v[60:63], v[132:135]
    ds_read_b64_tr_b16 v[122:123], v40 offset:42240
    s_cselect_b32 s55, 3, 0
    v_mfma_f32_16x16x32_bf16 v[148:151], v[100:103], v[64:67], v[148:151]
    ds_read_b128 v[88:91], v38 offset:39424
    s_addc_u32 s35, s35, 0
    v_mfma_f32_16x16x32_bf16 v[164:167], v[100:103], v[68:71], v[164:167]
    s_sub_u32 s34, s34, s55
    s_mul_i32 s55, s35, s46
    buffer_load_dwordx2 v[208:209], v51, s[20:23], 0 offen offset:0 sc1
    v_mfma_f32_16x16x32_bf16 v[180:183], v[100:103], v[72:75], v[180:183]
    s_lshl_b32 s34, s34, 9
    s_add_u32 s55, s55, s34
    buffer_load_dwordx2 v[210:211], v51, s[20:23], 0 offen offset:128 sc1
    v_mfma_f32_16x16x32_bf16 v[136:139], v[104:107], v[60:63], v[136:139]
    buffer_load_dwordx2 v[212:213], v51, s[20:23], 0 offen offset:256 sc1
    v_mfma_f32_16x16x32_bf16 v[152:155], v[104:107], v[64:67], v[152:155]
    buffer_load_dwordx2 v[214:215], v51, s[20:23], 0 offen offset:384 sc1
    v_mfma_f32_16x16x32_bf16 v[168:171], v[104:107], v[68:71], v[168:171]
    v_mfma_f32_16x16x32_bf16 v[184:187], v[104:107], v[72:75], v[184:187]
    v_add_u32 v38, 65536, v38
    v_add_u32 v39, 65536, v39
    v_add_u32 v40, 65536, v40
    s_waitcnt lgkmcnt(0)
    s_barrier
    v_mfma_f32_16x16x32_bf16 v[192:195], v[108:111], v[188:191], v[192:195]
    ds_read_b64_tr_b16 v[92:93], v39 offset:0
    s_add_u32 s37, s37, 1
    v_mfma_f32_16x16x32_bf16 v[200:203], v[116:119], v[188:191], v[200:203]
    ds_read_b64_tr_b16 v[94:95], v39 offset:1024
    s_mul_i32 s35, s37, 13108
    v_mfma_f32_16x16x32_bf16 v[124:127], v[108:111], v[76:79], v[124:127]
    ds_read_b128 v[60:63], v38 offset:0
    s_lshr_b32 s35, s35, 16
    v_mfma_f32_16x16x32_bf16 v[140:143], v[108:111], v[80:83], v[140:143]
    ds_read_b64_tr_b16 v[96:97], v40 offset:0
    s_mul_i32 s34, s35, 5
    v_mfma_f32_16x16x32_bf16 v[156:159], v[108:111], v[84:87], v[156:159]
    ds_read_b64_tr_b16 v[98:99], v40 offset:1024
    s_sub_u32 s34, s37, s34
    v_mfma_f32_16x16x32_bf16 v[172:175], v[108:111], v[88:91], v[172:175]
    ds_read_b128 v[64:67], v38 offset:2048
    s_lshl_b32 s35, s35, 1
    v_mfma_f32_16x16x32_bf16 v[128:131], v[112:115], v[76:79], v[128:131]
    ds_read_b64_tr_b16 v[100:101], v39 offset:256
    s_cmp_eq_u32 s34, 2
    v_mfma_f32_16x16x32_bf16 v[144:147], v[112:115], v[80:83], v[144:147]
    ds_read_b64_tr_b16 v[102:103], v39 offset:1280
    s_cselect_b32 s56, 128, 0
    v_mfma_f32_16x16x32_bf16 v[160:163], v[112:115], v[84:87], v[160:163]
    ds_read_b128 v[68:71], v38 offset:4096
    s_or_b32 s47, s47, s56
    v_mfma_f32_16x16x32_bf16 v[176:179], v[112:115], v[88:91], v[176:179]
    ds_read_b64_tr_b16 v[104:105], v40 offset:256
    s_cmp_ge_u32 s34, 3
    v_mfma_f32_16x16x32_bf16 v[132:135], v[116:119], v[76:79], v[132:135]
    ds_read_b64_tr_b16 v[106:107], v40 offset:1280
    s_cselect_b32 s56, 3, 0
    v_mfma_f32_16x16x32_bf16 v[148:151], v[116:119], v[80:83], v[148:151]
    ds_read_b128 v[72:75], v38 offset:6144
    s_addc_u32 s35, s35, 0
    v_mfma_f32_16x16x32_bf16 v[164:167], v[116:119], v[84:87], v[164:167]
    s_sub_u32 s34, s34, s56
    s_mul_i32 s56, s35, s46
    v_mfma_f32_16x16x32_bf16 v[180:183], v[116:119], v[88:91], v[180:183]
    s_lshl_b32 s34, s34, 9
    s_add_u32 s56, s56, s34
    v_mfma_f32_16x16x32_bf16 v[136:139], v[120:123], v[76:79], v[136:139]
    v_mfma_f32_16x16x32_bf16 v[152:155], v[120:123], v[80:83], v[152:155]
    v_mfma_f32_16x16x32_bf16 v[168:171], v[120:123], v[84:87], v[168:171]
    v_mfma_f32_16x16x32_bf16 v[184:187], v[120:123], v[88:91], v[184:187]
    s_waitcnt lgkmcnt(0)
    v_mfma_f32_16x16x32_bf16 v[192:195], v[92:95], v[188:191], v[192:195]
    ds_read_b64_tr_b16 v[108:109], v39 offset:8192
    v_mfma_f32_16x16x32_bf16 v[200:203], v[100:103], v[188:191], v[200:203]
    ds_read_b64_tr_b16 v[110:111], v39 offset:9216
    s_sub_u32 s36, s36, s45
    v_mfma_f32_16x16x32_bf16 v[124:127], v[92:95], v[60:63], v[124:127]
    ds_read_b128 v[76:79], v38 offset:512
    v_add_u32 v7, s36, v3
    v_mfma_f32_16x16x32_bf16 v[140:143], v[92:95], v[64:67], v[140:143]
    ds_read_b64_tr_b16 v[112:113], v40 offset:8192
    v_and_b32 v7, 63, v7
    v_mfma_f32_16x16x32_bf16 v[156:159], v[92:95], v[68:71], v[156:159]
    ds_read_b64_tr_b16 v[114:115], v40 offset:9216
    s_lshl_b32 s34, 1280, s45
    v_mfma_f32_16x16x32_bf16 v[172:175], v[92:95], v[72:75], v[172:175]
    ds_read_b128 v[80:83], v38 offset:2560
    v_mul_u32_u24 v7, s34, v7
    v_mfma_f32_16x16x32_bf16 v[128:131], v[96:99], v[60:63], v[128:131]
    ds_read_b64_tr_b16 v[116:117], v39 offset:8448
    s_mul_i32 s34, s45, 2621440
    v_mfma_f32_16x16x32_bf16 v[144:147], v[96:99], v[64:67], v[144:147]
    ds_read_b64_tr_b16 v[118:119], v39 offset:9472
    v_add_u32 v7, s34, v7
    v_mfma_f32_16x16x32_bf16 v[160:163], v[96:99], v[68:71], v[160:163]
    ds_read_b128 v[84:87], v38 offset:4608
    v_bfe_u32 v5, v0, 2, 2
    v_mfma_f32_16x16x32_bf16 v[176:179], v[96:99], v[72:75], v[176:179]
    ds_read_b64_tr_b16 v[120:121], v40 offset:8448
    v_bfe_u32 v6, v0, 4, 1
    v_mfma_f32_16x16x32_bf16 v[132:135], v[100:103], v[60:63], v[132:135]
    ds_read_b64_tr_b16 v[122:123], v40 offset:9472
    v_lshl_add_u32 v5, v5, 1, v6
    v_mfma_f32_16x16x32_bf16 v[148:151], v[100:103], v[64:67], v[148:151]
    ds_read_b128 v[88:91], v38 offset:6656
    v_and_b32 v6, 3, v0
    v_mfma_f32_16x16x32_bf16 v[164:167], v[100:103], v[68:71], v[164:167]
    v_lshl_add_u32 v5, v5, 2, v6
    v_cndmask_b32 v5, v2, v5, vcc
    v_mfma_f32_16x16x32_bf16 v[180:183], v[100:103], v[72:75], v[180:183]
    v_lshl_add_u32 v41, v5, 4, v7
    v_lshl_add_u32 v42, v5, 3, v7
    v_mfma_f32_16x16x32_bf16 v[136:139], v[104:107], v[60:63], v[136:139]
    v_mfma_f32_16x16x32_bf16 v[152:155], v[104:107], v[64:67], v[152:155]
    v_mfma_f32_16x16x32_bf16 v[168:171], v[104:107], v[68:71], v[168:171]
    v_mfma_f32_16x16x32_bf16 v[184:187], v[104:107], v[72:75], v[184:187]
    s_waitcnt lgkmcnt(0)
    v_mfma_f32_16x16x32_bf16 v[192:195], v[108:111], v[188:191], v[192:195]
    v_mfma_f32_16x16x32_bf16 v[200:203], v[116:119], v[188:191], v[200:203]
    v_mfma_f32_16x16x32_bf16 v[124:127], v[108:111], v[76:79], v[124:127]
    s_waitcnt vmcnt(0)
Lp1_xsT:
    v_min_u32 v5, v209, v211
    v_min3_u32 v5, v5, v213, v215
    v_cmp_ne_u32 vcc, 0, v5
    s_cmp_eq_u64 vcc, -1
    s_cbranch_scc0 Lp1_xrT
Lp1_xsokT:
    v_mfma_f32_16x16x32_bf16 v[140:143], v[108:111], v[80:83], v[140:143]
    v_mfma_f32_16x16x32_bf16 v[156:159], v[108:111], v[84:87], v[156:159]
    v_mfma_f32_16x16x32_bf16 v[172:175], v[108:111], v[88:91], v[172:175]
    v_mfma_f32_16x16x32_bf16 v[128:131], v[112:115], v[76:79], v[128:131]
    ds_write_b128 v52, v[192:195] offset:0
    v_mfma_f32_16x16x32_bf16 v[144:147], v[112:115], v[80:83], v[144:147]
    ds_write_b128 v52, v[200:203] offset:1024
    v_mfma_f32_16x16x32_bf16 v[160:163], v[112:115], v[84:87], v[160:163]
    v_mul_f32 v208, s48, v208
    v_mfma_f32_16x16x32_bf16 v[176:179], v[112:115], v[88:91], v[176:179]
    v_mul_f32 v209, s48, v209
    v_mfma_f32_16x16x32_bf16 v[132:135], v[116:119], v[76:79], v[132:135]
    v_mul_f32 v210, s48, v210
    v_mfma_f32_16x16x32_bf16 v[148:151], v[116:119], v[80:83], v[148:151]
    v_mul_f32 v211, s48, v211
    v_mfma_f32_16x16x32_bf16 v[164:167], v[116:119], v[84:87], v[164:167]
    v_mul_f32 v212, s48, v212
    v_mfma_f32_16x16x32_bf16 v[180:183], v[116:119], v[88:91], v[180:183]
    v_mul_f32 v213, s48, v213
    s_waitcnt lgkmcnt(0)
    s_barrier
    v_mfma_f32_16x16x32_bf16 v[136:139], v[120:123], v[76:79], v[136:139]
    v_mul_f32 v214, s48, v214
    ds_read_b128 v[192:195], v53 offset:0
    v_mfma_f32_16x16x32_bf16 v[152:155], v[120:123], v[80:83], v[152:155]
    v_mul_f32 v215, s48, v215
    ds_read_b128 v[196:199], v54 offset:0
    v_mfma_f32_16x16x32_bf16 v[168:171], v[120:123], v[84:87], v[168:171]
    ds_read_b128 v[200:203], v53 offset:1024
    v_mfma_f32_16x16x32_bf16 v[184:187], v[120:123], v[88:91], v[184:187]
    ds_read_b128 v[204:207], v54 offset:1024
    v_pk_mul_f32 v[124:125], v[208:209], v[124:125] op_sel:[1,0] op_sel_hi:[1,1]
    v_pk_mul_f32 v[126:127], v[208:209], v[126:127] op_sel:[1,0] op_sel_hi:[1,1]
    v_pk_mul_f32 v[140:141], v[210:211], v[140:141] op_sel:[1,0] op_sel_hi:[1,1]
    v_pk_mul_f32 v[142:143], v[210:211], v[142:143] op_sel:[1,0] op_sel_hi:[1,1]
    v_pk_mul_f32 v[156:157], v[212:213], v[156:157] op_sel:[1,0] op_sel_hi:[1,1]
    v_pk_mul_f32 v[158:159], v[212:213], v[158:159] op_sel:[1,0] op_sel_hi:[1,1]
    v_pk_mul_f32 v[172:173], v[214:215], v[172:173] op_sel:[1,0] op_sel_hi:[1,1]
    v_pk_mul_f32 v[174:175], v[214:215], v[174:175] op_sel:[1,0] op_sel_hi:[1,1]
    s_waitcnt lgkmcnt(3)
    v_pk_fma_f32 v[124:125], v[208:209], v[192:193], v[124:125] op_sel:[0,0,0] op_sel_hi:[0,1,1] neg_lo:[1,0,0] neg_hi:[1,0,0]
    v_pk_fma_f32 v[126:127], v[208:209], v[194:195], v[126:127] op_sel:[0,0,0] op_sel_hi:[0,1,1] neg_lo:[1,0,0] neg_hi:[1,0,0]
    v_pk_fma_f32 v[140:141], v[210:211], v[192:193], v[140:141] op_sel:[0,0,0] op_sel_hi:[0,1,1] neg_lo:[1,0,0] neg_hi:[1,0,0]
    v_pk_fma_f32 v[142:143], v[210:211], v[194:195], v[142:143] op_sel:[0,0,0] op_sel_hi:[0,1,1] neg_lo:[1,0,0] neg_hi:[1,0,0]
    v_pk_fma_f32 v[156:157], v[212:213], v[192:193], v[156:157] op_sel:[0,0,0] op_sel_hi:[0,1,1] neg_lo:[1,0,0] neg_hi:[1,0,0]
    v_pk_fma_f32 v[158:159], v[212:213], v[194:195], v[158:159] op_sel:[0,0,0] op_sel_hi:[0,1,1] neg_lo:[1,0,0] neg_hi:[1,0,0]
    v_pk_fma_f32 v[172:173], v[214:215], v[192:193], v[172:173] op_sel:[0,0,0] op_sel_hi:[0,1,1] neg_lo:[1,0,0] neg_hi:[1,0,0]
    v_pk_fma_f32 v[174:175], v[214:215], v[194:195], v[174:175] op_sel:[0,0,0] op_sel_hi:[0,1,1] neg_lo:[1,0,0] neg_hi:[1,0,0]
    v_cvt_pk_bf16_f32 v60, v124, v125
    v_cvt_pk_bf16_f32 v61, v126, v127
    v_cvt_pk_bf16_f32 v62, v140, v141
    v_cvt_pk_bf16_f32 v63, v142, v143
    v_cvt_pk_bf16_f32 v64, v156, v157
    v_cvt_pk_bf16_f32 v65, v158, v159
    v_cvt_pk_bf16_f32 v66, v172, v173
    v_cvt_pk_bf16_f32 v67, v174, v175
    v_permlane16_swap_b32 v60, v62
    v_permlane16_swap_b32 v61, v63
    v_permlane16_swap_b32 v64, v66
    v_permlane16_swap_b32 v65, v67
    s_nop 0
    v_permlane32_swap_b32 v60, v64
    v_permlane32_swap_b32 v62, v66
    v_permlane32_swap_b32 v61, v65
    v_permlane32_swap_b32 v63, v67
    s_bitcmp1_b32 s47, 0
    s_cbranch_scc1 Lt_19
    buffer_store_dwordx4 v[60:63], v41, s[20:23], s49 offen sc1
Lt_19b:
    s_bitcmp1_b32 s47, 1
    s_cbranch_scc1 Lt_20
    buffer_store_dwordx4 v[64:67], v41, s[20:23], s50 offen sc1
Lt_20b:
    v_pk_mul_f32 v[128:129], v[208:209], v[128:129] op_sel:[1,0] op_sel_hi:[1,1]
    v_pk_mul_f32 v[130:131], v[208:209], v[130:131] op_sel:[1,0] op_sel_hi:[1,1]
    v_pk_mul_f32 v[144:145], v[210:211], v[144:145] op_sel:[1,0] op_sel_hi:[1,1]
    v_pk_mul_f32 v[146:147], v[210:211], v[146:147] op_sel:[1,0] op_sel_hi:[1,1]
    v_pk_mul_f32 v[160:161], v[212:213], v[160:161] op_sel:[1,0] op_sel_hi:[1,1]
    v_pk_mul_f32 v[162:163], v[212:213], v[162:163] op_sel:[1,0] op_sel_hi:[1,1]
    v_pk_mul_f32 v[176:177], v[214:215], v[176:177] op_sel:[1,0] op_sel_hi:[1,1]
    v_pk_mul_f32 v[178:179], v[214:215], v[178:179] op_sel:[1,0] op_sel_hi:[1,1]
    s_waitcnt lgkmcnt(0)
    v_pk_fma_f32 v[128:129], v[208:209], v[196:197], v[128:129] op_sel:[0,0,0] op_sel_hi:[0,1,1] neg_lo:[1,0,0] neg_hi:[1,0,0]
    v_pk_fma_f32 v[130:131], v[208:209], v[198:199], v[130:131] op_sel:[0,0,0] op_sel_hi:[0,1,1] neg_lo:[1,0,0] neg_hi:[1,0,0]
    v_pk_fma_f32 v[144:145], v[210:211], v[196:197], v[144:145] op_sel:[0,0,0] op_sel_hi:[0,1,1] neg_lo:[1,0,0] neg_hi:[1,0,0]
    v_pk_fma_f32 v[146:147], v[210:211], v[198:199], v[146:147] op_sel:[0,0,0] op_sel_hi:[0,1,1] neg_lo:[1,0,0] neg_hi:[1,0,0]
    v_pk_fma_f32 v[160:161], v[212:213], v[196:197], v[160:161] op_sel:[0,0,0] op_sel_hi:[0,1,1] neg_lo:[1,0,0] neg_hi:[1,0,0]
    v_pk_fma_f32 v[162:163], v[212:213], v[198:199], v[162:163] op_sel:[0,0,0] op_sel_hi:[0,1,1] neg_lo:[1,0,0] neg_hi:[1,0,0]
    v_pk_fma_f32 v[176:177], v[214:215], v[196:197], v[176:177] op_sel:[0,0,0] op_sel_hi:[0,1,1] neg_lo:[1,0,0] neg_hi:[1,0,0]
    v_pk_fma_f32 v[178:179], v[214:215], v[198:199], v[178:179] op_sel:[0,0,0] op_sel_hi:[0,1,1] neg_lo:[1,0,0] neg_hi:[1,0,0]
    v_cvt_pk_bf16_f32 v68, v128, v129
    v_cvt_pk_bf16_f32 v69, v130, v131
    v_cvt_pk_bf16_f32 v70, v144, v145
    v_cvt_pk_bf16_f32 v71, v146, v147
    v_cvt_pk_bf16_f32 v72, v160, v161
    v_cvt_pk_bf16_f32 v73, v162, v163
    v_cvt_pk_bf16_f32 v74, v176, v177
    v_cvt_pk_bf16_f32 v75, v178, v179
    v_permlane16_swap_b32 v68, v70
    v_permlane16_swap_b32 v69, v71
    v_permlane16_swap_b32 v72, v74
    v_permlane16_swap_b32 v73, v75
    s_nop 0
    v_permlane32_swap_b32 v68, v72
    v_permlane32_swap_b32 v70, v74
    v_permlane32_swap_b32 v69, v73
    v_permlane32_swap_b32 v71, v75
    s_bitcmp1_b32 s47, 2
    s_cbranch_scc1 Lt_21
    buffer_store_dwordx4 v[68:71], v41, s[20:23], s51 offen sc1
Lt_21b:
    s_bitcmp1_b32 s47, 3
    s_cbranch_scc1 Lt_22
    buffer_store_dwordx4 v[72:75], v41, s[20:23], s52 offen sc1
Lt_22b:
    v_pk_mul_f32 v[132:133], v[208:209], v[132:133] op_sel:[1,0] op_sel_hi:[1,1]
    v_pk_mul_f32 v[134:135], v[208:209], v[134:135] op_sel:[1,0] op_sel_hi:[1,1]
    v_pk_mul_f32 v[148:149], v[210:211], v[148:149] op_sel:[1,0] op_sel_hi:[1,1]
    v_pk_mul_f32 v[150:151], v[210:211], v[150:151] op_sel:[1,0] op_sel_hi:[1,1]
    v_pk_mul_f32 v[164:165], v[212:213], v[164:165] op_sel:[1,0] op_sel_hi:[1,1]
    v_pk_mul_f32 v[166:167], v[212:213], v[166:167] op_sel:[1,0] op_sel_hi:[1,1]
    v_pk_mul_f32 v[180:181], v[214:215], v[180:181] op_sel:[1,0] op_sel_hi:[1,1]
    v_pk_mul_f32 v[182:183], v[214:215], v[182:183] op_sel:[1,0] op_sel_hi:[1,1]
    v_pk_fma_f32 v[132:133], v[208:209], v[200:201], v[132:133] op_sel:[0,0,0] op_sel_hi:[0,1,1] neg_lo:[1,0,0] neg_hi:[1,0,0]
    v_pk_fma_f32 v[134:135], v[208:209], v[202:203], v[134:135] op_sel:[0,0,0] op_sel_hi:[0,1,1] neg_lo:[1,0,0] neg_hi:[1,0,0]
    v_pk_fma_f32 v[148:149], v[210:211], v[200:201], v[148:149] op_sel:[0,0,0] op_sel_hi:[0,1,1] neg_lo:[1,0,0] neg_hi:[1,0,0]
    v_pk_fma_f32 v[150:151], v[210:211], v[202:203], v[150:151] op_sel:[0,0,0] op_sel_hi:[0,1,1] neg_lo:[1,0,0] neg_hi:[1,0,0]
    v_pk_fma_f32 v[164:165], v[212:213], v[200:201], v[164:165] op_sel:[0,0,0] op_sel_hi:[0,1,1] neg_lo:[1,0,0] neg_hi:[1,0,0]
    v_pk_fma_f32 v[166:167], v[212:213], v[202:203], v[166:167] op_sel:[0,0,0] op_sel_hi:[0,1,1] neg_lo:[1,0,0] neg_hi:[1,0,0]
    v_pk_fma_f32 v[180:181], v[214:215], v[200:201], v[180:181] op_sel:[0,0,0] op_sel_hi:[0,1,1] neg_lo:[1,0,0] neg_hi:[1,0,0]
    v_pk_fma_f32 v[182:183], v[214:215], v[202:203], v[182:183] op_sel:[0,0,0] op_sel_hi:[0,1,1] neg_lo:[1,0,0] neg_hi:[1,0,0]
    v_cvt_pk_bf16_f32 v76, v132, v133
    v_cvt_pk_bf16_f32 v77, v134, v135
    v_cvt_pk_bf16_f32 v78, v148, v149
    v_cvt_pk_bf16_f32 v79, v150, v151
    v_cvt_pk_bf16_f32 v80, v164, v165
    v_cvt_pk_bf16_f32 v81, v166, v167
    v_cvt_pk_bf16_f32 v82, v180, v181
    v_cvt_pk_bf16_f32 v83, v182, v183
    v_permlane16_swap_b32 v76, v78
    v_permlane16_swap_b32 v77, v79
    v_permlane16_swap_b32 v80, v82
    v_permlane16_swap_b32 v81, v83
    s_nop 0
    v_permlane32_swap_b32 v76, v80
    v_permlane32_swap_b32 v78, v82
    v_permlane32_swap_b32 v77, v81
    v_permlane32_swap_b32 v79, v83
    s_bitcmp1_b32 s47, 4
    s_cbranch_scc1 Lt_23
    buffer_store_dwordx4 v[76:79], v41, s[20:23], s53 offen sc1
Lt_23b:
    s_bitcmp1_b32 s47, 5
    s_cbranch_scc1 Lt_24
    buffer_store_dwordx4 v[80:83], v41, s[20:23], s54 offen sc1
Lt_24b:
    v_pk_mul_f32 v[136:137], v[208:209], v[136:137] op_sel:[1,0] op_sel_hi:[1,1]
    v_pk_mul_f32 v[138:139], v[208:209], v[138:139] op_sel:[1,0] op_sel_hi:[1,1]
    v_pk_mul_f32 v[152:153], v[210:211], v[152:153] op_sel:[1,0] op_sel_hi:[1,1]
    v_pk_mul_f32 v[154:155], v[210:211], v[154:155] op_sel:[1,0] op_sel_hi:[1,1]
    v_pk_mul_f32 v[168:169], v[212:213], v[168:169] op_sel:[1,0] op_sel_hi:[1,1]
    v_pk_mul_f32 v[170:171], v[212:213], v[170:171] op_sel:[1,0] op_sel_hi:[1,1]
    v_pk_mul_f32 v[184:185], v[214:215], v[184:185] op_sel:[1,0] op_sel_hi:[1,1]
    v_pk_mul_f32 v[186:187], v[214:215], v[186:187] op_sel:[1,0] op_sel_hi:[1,1]
    v_pk_fma_f32 v[136:137], v[208:209], v[204:205], v[136:137] op_sel:[0,0,0] op_sel_hi:[0,1,1] neg_lo:[1,0,0] neg_hi:[1,0,0]
    v_pk_fma_f32 v[138:139], v[208:209], v[206:207], v[138:139] op_sel:[0,0,0] op_sel_hi:[0,1,1] neg_lo:[1,0,0] neg_hi:[1,0,0]
    v_pk_fma_f32 v[152:153], v[210:211], v[204:205], v[152:153] op_sel:[0,0,0] op_sel_hi:[0,1,1] neg_lo:[1,0,0] neg_hi:[1,0,0]
    v_pk_fma_f32 v[154:155], v[210:211], v[206:207], v[154:155] op_sel:[0,0,0] op_sel_hi:[0,1,1] neg_lo:[1,0,0] neg_hi:[1,0,0]
    v_pk_fma_f32 v[168:169], v[212:213], v[204:205], v[168:169] op_sel:[0,0,0] op_sel_hi:[0,1,1] neg_lo:[1,0,0] neg_hi:[1,0,0]
    v_pk_fma_f32 v[170:171], v[212:213], v[206:207], v[170:171] op_sel:[0,0,0] op_sel_hi:[0,1,1] neg_lo:[1,0,0] neg_hi:[1,0,0]
    v_pk_fma_f32 v[184:185], v[214:215], v[204:205], v[184:185] op_sel:[0,0,0] op_sel_hi:[0,1,1] neg_lo:[1,0,0] neg_hi:[1,0,0]
    v_pk_fma_f32 v[186:187], v[214:215], v[206:207], v[186:187] op_sel:[0,0,0] op_sel_hi:[0,1,1] neg_lo:[1,0,0] neg_hi:[1,0,0]
    v_cvt_pk_bf16_f32 v84, v136, v137
    v_cvt_pk_bf16_f32 v85, v138, v139
    v_cvt_pk_bf16_f32 v86, v152, v153
    v_cvt_pk_bf16_f32 v87, v154, v155
    v_cvt_pk_bf16_f32 v88, v168, v169
    v_cvt_pk_bf16_f32 v89, v170, v171
    v_cvt_pk_bf16_f32 v90, v184, v185
    v_cvt_pk_bf16_f32 v91, v186, v187
    v_permlane16_swap_b32 v84, v86
    v_permlane16_swap_b32 v85, v87
    v_permlane16_swap_b32 v88, v90
    v_permlane16_swap_b32 v89, v91
    s_nop 0
    v_permlane32_swap_b32 v84, v88
    v_permlane32_swap_b32 v86, v90
    v_permlane32_swap_b32 v85, v89
    v_permlane32_swap_b32 v87, v91
    s_bitcmp1_b32 s47, 6
    s_cbranch_scc1 Lt_25
    buffer_store_dwordx4 v[84:87], v41, s[20:23], s55 offen sc1
Lt_25b:
    s_bitcmp1_b32 s47, 7
    s_cbranch_scc1 Lt_26
    buffer_store_dwordx4 v[88:91], v41, s[20:23], s56 offen sc1
Lt_26b:
    s_branch Lp1_cdone
Lt_19:
    s_add_u32 s35, s49, s46
    buffer_store_dwordx2 v[60:61], v42, s[20:23], s49 offen sc1
    buffer_store_dwordx2 v[62:63], v42, s[20:23], s35 offen sc1
    s_branch Lt_19b
Lt_20:
    s_add_u32 s35, s50, s46
    buffer_store_dwordx2 v[64:65], v42, s[20:23], s50 offen sc1
    buffer_store_dwordx2 v[66:67], v42, s[20:23], s35 offen sc1
    s_branch Lt_20b
Lt_21:
    s_add_u32 s35, s51, s46
    buffer_store_dwordx2 v[68:69], v42, s[20:23], s51 offen sc1
    buffer_store_dwordx2 v[70:71], v42, s[20:23], s35 offen sc1
    s_branch Lt_21b
Lt_22:
    s_add_u32 s35, s52, s46
    buffer_store_dwordx2 v[72:73], v42, s[20:23], s52 offen sc1
    buffer_store_dwordx2 v[74:75], v42, s[20:23], s35 offen sc1
    s_branch Lt_22b
Lt_23:
    s_add_u32 s35, s53, s46
    buffer_store_dwordx2 v[76:77], v42, s[20:23], s53 offen sc1
    buffer_store_dwordx2 v[78:79], v42, s[20:23], s35 offen sc1
    s_branch Lt_23b
Lt_24:
    s_add_u32 s35, s54, s46
    buffer_store_dwordx2 v[80:81], v42, s[20:23], s54 offen sc1
    buffer_store_dwordx2 v[82:83], v42, s[20:23], s35 offen sc1
    s_branch Lt_24b
Lt_25:
    s_add_u32 s35, s55, s46
    buffer_store_dwordx2 v[84:85], v42, s[20:23], s55 offen sc1
    buffer_store_dwordx2 v[86:87], v42, s[20:23], s35 offen sc1
    s_branch Lt_25b
Lt_26:
    s_add_u32 s35, s56, s46
    buffer_store_dwordx2 v[88:89], v42, s[20:23], s56 offen sc1
    buffer_store_dwordx2 v[90:91], v42, s[20:23], s35 offen sc1
    s_branch Lt_26b
Lp2_touch:
    s_cmp_lg_u32 s33, 0
    s_cbranch_scc1 Ltch_28
    s_call_b64 s[38:39], Lpg5
    s_call_b64 s[38:39], Lpg9
    s_call_b64 s[38:39], Lpg10
    s_branch Ltch_27
Ltch_28:
    s_cmp_lg_u32 s33, 1
    s_cbranch_scc1 Ltch_29
    s_call_b64 s[38:39], Lpg6
    s_call_b64 s[38:39], LpgL
    s_branch Ltch_27
Ltch_29:
    s_cmp_lg_u32 s33, 2
    s_cbranch_scc1 Ltch_30
    s_call_b64 s[38:39], Lpg7
    s_call_b64 s[38:39], Lpg4
    s_branch Ltch_27
Ltch_30:
    s_call_b64 s[38:39], Lpg8
    s_call_b64 s[38:39], Lpg3
Ltch_27:
    s_branch Lp2_setup
Lp1_V:
    s_add_u32 s34, s34, s32
    s_branch Lpg2s
Lpg2:
    s_setpc_b64 s[38:39]
Lpg2s:
    s_lshl_b32 s34, s34, 8
    s_add_u32 s34, s34, 25673728
    v_lshl_add_u32 v51, v2, 3, s34
    s_lshl_b32 s34, s43, 8
    s_add_u32 s34, s34, 57344
    v_lshl_add_u32 v55, v49, 4, s34
    s_lshl_b32 s34, s32, 7
    s_add_u32 s34, s34, 57344
    v_lshl_add_u32 v56, v2, 2, s34
    v_lshl_add_u32 v56, v3, 9, v56
    s_mov_b32 s37, 0
    s_lshl_b32 s34, s2, 2
    s_add_u32 s36, s34, s32
    s_mul_i32 s34, s36, 2560
    v_mul_u32_u24 v5, 1280, v3
    v_lshl_add_u32 v5, v2, 3, v5
    s_mov_b32 s42, 0xffff0000
    s_waitcnt lgkmcnt(0)
    s_mov_b32 s24, s4
    s_mov_b32 s25, s5
    s_mov_b32 s26, 2621440
    s_mov_b32 s27, 0x20000
    buffer_load_dwordx2 v[20:21], v5, s[24:27], s34 offen offset:0
    buffer_load_dwordx2 v[22:23], v5, s[24:27], s34 offen offset:256
    buffer_load_dwordx2 v[24:25], v5, s[24:27], s34 offen offset:512
    buffer_load_dwordx2 v[26:27], v5, s[24:27], s34 offen offset:768
    buffer_load_dwordx2 v[28:29], v5, s[24:27], s34 offen offset:1024
    s_barrier
    ds_read_b64_tr_b16 v[92:93], v39 offset:0
    ds_read_b64_tr_b16 v[94:95], v39 offset:1024
    ds_read_b128 v[60:63], v38 offset:0
    ds_read_b64_tr_b16 v[96:97], v40 offset:0
    ds_read_b64_tr_b16 v[98:99], v40 offset:1024
    ds_read_b128 v[64:67], v38 offset:2048
    ds_read_b64_tr_b16 v[100:101], v39 offset:256
    ds_read_b64_tr_b16 v[102:103], v39 offset:1280
    ds_read_b128 v[68:71], v38 offset:4096
    ds_read_b64_tr_b16 v[104:105], v40 offset:256
    ds_read_b64_tr_b16 v[106:107], v40 offset:1280
    ds_read_b128 v[72:75], v38 offset:6144
    s_waitcnt lgkmcnt(0)
    v_mfma_f32_16x16x32_bf16 v[192:195], v[188:191], v[92:95], 0
    v_mfma_f32_16x16x32_bf16 v[200:203], v[188:191], v[100:103], 0
    v_mfma_f32_16x16x32_bf16 v[124:127], v[60:63], v[92:95], 0
    v_mfma_f32_16x16x32_bf16 v[140:143], v[64:67], v[92:95], 0
    v_mfma_f32_16x16x32_bf16 v[156:159], v[68:71], v[92:95], 0
    v_mfma_f32_16x16x32_bf16 v[172:175], v[72:75], v[92:95], 0
    v_mfma_f32_16x16x32_bf16 v[128:131], v[60:63], v[96:99], 0
    v_mfma_f32_16x16x32_bf16 v[144:147], v[64:67], v[96:99], 0
    v_mfma_f32_16x16x32_bf16 v[160:163], v[68:71], v[96:99], 0
    v_mfma_f32_16x16x32_bf16 v[176:179], v[72:75], v[96:99], 0
    v_mfma_f32_16x16x32_bf16 v[132:135], v[60:63], v[100:103], 0
    v_mfma_f32_16x16x32_bf16 v[148:151], v[64:67], v[100:103], 0
    v_mfma_f32_16x16x32_bf16 v[164:167], v[68:71], v[100:103], 0
    v_mfma_f32_16x16x32_bf16 v[180:183], v[72:75], v[100:103], 0
    v_mfma_f32_16x16x32_bf16 v[136:139], v[60:63], v[104:107], 0
    ds_read_b64_tr_b16 v[108:109], v39 offset:8192
    v_mfma_f32_16x16x32_bf16 v[152:155], v[64:67], v[104:107], 0
    ds_read_b64_tr_b16 v[110:111], v39 offset:9216
    v_mfma_f32_16x16x32_bf16 v[168:171], v[68:71], v[104:107], 0
    ds_read_b128 v[76:79], v38 offset:512
    v_mfma_f32_16x16x32_bf16 v[184:187], v[72:75], v[104:107], 0
    ds_read_b64_tr_b16 v[112:113], v40 offset:8192
    ds_read_b64_tr_b16 v[114:115], v40 offset:9216
    ds_read_b128 v[80:83], v38 offset:2560
    ds_read_b64_tr_b16 v[116:117], v39 offset:8448
    ds_read_b64_tr_b16 v[118:119], v39 offset:9472
    ds_read_b128 v[84:87], v38 offset:4608
    ds_read_b64_tr_b16 v[120:121], v40 offset:8448
    ds_read_b64_tr_b16 v[122:123], v40 offset:9472
    ds_read_b128 v[88:91], v38 offset:6656
    s_waitcnt lgkmcnt(0)
    s_barrier
    v_mfma_f32_16x16x32_bf16 v[192:195], v[188:191], v[108:111], v[192:195]
    v_mfma_f32_16x16x32_bf16 v[200:203], v[188:191], v[116:119], v[200:203]
    v_mfma_f32_16x16x32_bf16 v[124:127], v[76:79], v[108:111], v[124:127]
    v_mfma_f32_16x16x32_bf16 v[140:143], v[80:83], v[108:111], v[140:143]
    v_mfma_f32_16x16x32_bf16 v[156:159], v[84:87], v[108:111], v[156:159]
    v_mfma_f32_16x16x32_bf16 v[172:175], v[88:91], v[108:111], v[172:175]
    v_mfma_f32_16x16x32_bf16 v[128:131], v[76:79], v[112:115], v[128:131]
    v_mfma_f32_16x16x32_bf16 v[144:147], v[80:83], v[112:115], v[144:147]
    v_mfma_f32_16x16x32_bf16 v[160:163], v[84:87], v[112:115], v[160:163]
    v_mfma_f32_16x16x32_bf16 v[176:179], v[88:91], v[112:115], v[176:179]
    v_mfma_f32_16x16x32_bf16 v[132:135], v[76:79], v[116:119], v[132:135]
    v_mfma_f32_16x16x32_bf16 v[148:151], v[80:83], v[116:119], v[148:151]
    v_mfma_f32_16x16x32_bf16 v[164:167], v[84:87], v[116:119], v[164:167]
    v_mfma_f32_16x16x32_bf16 v[180:183], v[88:91], v[116:119], v[180:183]
    v_mfma_f32_16x16x32_bf16 v[136:139], v[76:79], v[120:123], v[136:139]
    ds_read_b64_tr_b16 v[92:93], v39 offset:32768
    v_mfma_f32_16x16x32_bf16 v[152:155], v[80:83], v[120:123], v[152:155]
    ds_read_b64_tr_b16 v[94:95], v39 offset:33792
    v_mfma_f32_16x16x32_bf16 v[168:171], v[84:87], v[120:123], v[168:171]
    ds_read_b128 v[60:63], v38 offset:32768
    v_mfma_f32_16x16x32_bf16 v[184:187], v[88:91], v[120:123], v[184:187]
    ds_read_b64_tr_b16 v[96:97], v40 offset:32768
    ds_read_b64_tr_b16 v[98:99], v40 offset:33792
    ds_read_b128 v[64:67], v38 offset:34816
    ds_read_b64_tr_b16 v[100:101], v39 offset:33024
    ds_read_b64_tr_b16 v[102:103], v39 offset:34048
    ds_read_b128 v[68:71], v38 offset:36864
    ds_read_b64_tr_b16 v[104:105], v40 offset:33024
    ds_read_b64_tr_b16 v[106:107], v40 offset:34048
    ds_read_b128 v[72:75], v38 offset:38912
    s_waitcnt lgkmcnt(0)
    v_mfma_f32_16x16x32_bf16 v[192:195], v[188:191], v[92:95], v[192:195]
    s_waitcnt vmcnt(0)
    v_lshlrev_b32 v36, 16, v20
    v_mfma_f32_16x16x32_bf16 v[200:203], v[188:191], v[100:103], v[200:203]
    v_and_b32 v37, s42, v20
    v_add_f32 v32, v36, v37
    v_mfma_f32_16x16x32_bf16 v[124:127], v[60:63], v[92:95], v[124:127]
    v_mul_f32 v34, v36, v36
    v_fmac_f32 v34, v37, v37
    v_mfma_f32_16x16x32_bf16 v[140:143], v[64:67], v[92:95], v[140:143]
    v_lshlrev_b32 v36, 16, v21
    v_and_b32 v37, s42, v21
    v_mfma_f32_16x16x32_bf16 v[156:159], v[68:71], v[92:95], v[156:159]
    v_add_f32 v32, v32, v36
    v_fmac_f32 v34, v36, v36
    v_mfma_f32_16x16x32_bf16 v[172:175], v[72:75], v[92:95], v[172:175]
    v_add_f32 v32, v32, v37
    v_fmac_f32 v34, v37, v37
    v_mfma_f32_16x16x32_bf16 v[128:131], v[60:63], v[96:99], v[128:131]
    v_lshlrev_b32 v36, 16, v22
    v_and_b32 v37, s42, v22
    v_mfma_f32_16x16x32_bf16 v[144:147], v[64:67], v[96:99], v[144:147]
    v_add_f32 v32, v32, v36
    v_fmac_f32 v34, v36, v36
    v_mfma_f32_16x16x32_bf16 v[160:163], v[68:71], v[96:99], v[160:163]
    v_add_f32 v32, v32, v37
    v_fmac_f32 v34, v37, v37
    v_mfma_f32_16x16x32_bf16 v[176:179], v[72:75], v[96:99], v[176:179]
    v_lshlrev_b32 v36, 16, v23
    v_and_b32 v37, s42, v23
    v_mfma_f32_16x16x32_bf16 v[132:135], v[60:63], v[100:103], v[132:135]
    v_add_f32 v32, v32, v36
    v_fmac_f32 v34, v36, v36
    v_mfma_f32_16x16x32_bf16 v[148:151], v[64:67], v[100:103], v[148:151]
    v_add_f32 v32, v32, v37
    v_fmac_f32 v34, v37, v37
    v_mfma_f32_16x16x32_bf16 v[164:167], v[68:71], v[100:103], v[164:167]
    v_lshlrev_b32 v36, 16, v24
    v_and_b32 v37, s42, v24
    v_mfma_f32_16x16x32_bf16 v[180:183], v[72:75], v[100:103], v[180:183]
    ds_read_b64_tr_b16 v[108:109], v39 offset:40960
    v_add_f32 v32, v32, v36
    v_mfma_f32_16x16x32_bf16 v[136:139], v[60:63], v[104:107], v[136:139]
    ds_read_b64_tr_b16 v[110:111], v39 offset:41984
    v_fmac_f32 v34, v36, v36
    v_mfma_f32_16x16x32_bf16 v[152:155], v[64:67], v[104:107], v[152:155]
    ds_read_b128 v[76:79], v38 offset:33280
    v_add_f32 v32, v32, v37
    v_mfma_f32_16x16x32_bf16 v[168:171], v[68:71], v[104:107], v[168:171]
    ds_read_b64_tr_b16 v[112:113], v40 offset:40960
    v_fmac_f32 v34, v37, v37
    v_mfma_f32_16x16x32_bf16 v[184:187], v[72:75], v[104:107], v[184:187]
    ds_read_b64_tr_b16 v[114:115], v40 offset:41984
    ds_read_b128 v[80:83], v38 offset:35328
    ds_read_b64_tr_b16 v[116:117], v39 offset:41216
    ds_read_b64_tr_b16 v[118:119], v39 offset:42240
    ds_read_b128 v[84:87], v38 offset:37376
    ds_read_b64_tr_b16 v[120:121], v40 offset:41216
    ds_read_b64_tr_b16 v[122:123], v40 offset:42240
    ds_read_b128 v[88:91], v38 offset:39424
    v_lshlrev_b32 v36, 16, v25
    v_add_u32 v38, 65536, v38
    v_add_u32 v39, 65536, v39
    v_add_u32 v40, 65536, v40
    s_waitcnt lgkmcnt(0)
    s_barrier
    v_mfma_f32_16x16x32_bf16 v[192:195], v[188:191], v[108:111], v[192:195]
    v_and_b32 v37, s42, v25
    v_add_f32 v32, v32, v36
    v_mfma_f32_16x16x32_bf16 v[200:203], v[188:191], v[116:119], v[200:203]
    v_fmac_f32 v34, v36, v36
    v_add_f32 v32, v32, v37
    v_mfma_f32_16x16x32_bf16 v[124:127], v[76:79], v[108:111], v[124:127]
    v_fmac_f32 v34, v37, v37
    v_lshlrev_b32 v36, 16, v26
    v_mfma_f32_16x16x32_bf16 v[140:143], v[80:83], v[108:111], v[140:143]
    v_and_b32 v37, s42, v26
    v_add_f32 v32, v32, v36
    v_mfma_f32_16x16x32_bf16 v[156:159], v[84:87], v[108:111], v[156:159]
    v_fmac_f32 v34, v36, v36
    v_add_f32 v32, v32, v37
    v_mfma_f32_16x16x32_bf16 v[172:175], v[88:91], v[108:111], v[172:175]
    v_fmac_f32 v34, v37, v37
    v_lshlrev_b32 v36, 16, v27
    v_mfma_f32_16x16x32_bf16 v[128:131], v[76:79], v[112:115], v[128:131]
    v_and_b32 v37, s42, v27
    v_add_f32 v32, v32, v36
    v_mfma_f32_16x16x32_bf16 v[144:147], v[80:83], v[112:115], v[144:147]
    v_fmac_f32 v34, v36, v36
    v_add_f32 v32, v32, v37
    v_mfma_f32_16x16x32_bf16 v[160:163], v[84:87], v[112:115], v[160:163]
    v_fmac_f32 v34, v37, v37
    v_lshlrev_b32 v36, 16, v28
    v_mfma_f32_16x16x32_bf16 v[176:179], v[88:91], v[112:115], v[176:179]
    v_and_b32 v37, s42, v28
    v_add_f32 v32, v32, v36
    v_mfma_f32_16x16x32_bf16 v[132:135], v[76:79], v[116:119], v[132:135]
    v_fmac_f32 v34, v36, v36
    v_add_f32 v32, v32, v37
    v_mfma_f32_16x16x32_bf16 v[148:151], v[80:83], v[116:119], v[148:151]
    v_fmac_f32 v34, v37, v37
    v_lshlrev_b32 v36, 16, v29
    v_mfma_f32_16x16x32_bf16 v[164:167], v[84:87], v[116:119], v[164:167]
    v_and_b32 v37, s42, v29
    v_add_f32 v32, v32, v36
    v_mfma_f32_16x16x32_bf16 v[180:183], v[88:91], v[116:119], v[180:183]
    ds_read_b64_tr_b16 v[92:93], v39 offset:0
    v_fmac_f32 v34, v36, v36
    v_mfma_f32_16x16x32_bf16 v[136:139], v[76:79], v[120:123], v[136:139]
    ds_read_b64_tr_b16 v[94:95], v39 offset:1024
    v_add_f32 v32, v32, v37
    v_mfma_f32_16x16x32_bf16 v[152:155], v[80:83], v[120:123], v[152:155]
    ds_read_b128 v[60:63], v38 offset:0
    v_fmac_f32 v34, v37, v37
    v_mfma_f32_16x16x32_bf16 v[168:171], v[84:87], v[120:123], v[168:171]
    ds_read_b64_tr_b16 v[96:97], v40 offset:0
    s_nop 0
    v_mfma_f32_16x16x32_bf16 v[184:187], v[88:91], v[120:123], v[184:187]
    ds_read_b64_tr_b16 v[98:99], v40 offset:1024
    ds_read_b128 v[64:67], v38 offset:2048
    ds_read_b64_tr_b16 v[100:101], v39 offset:256
    ds_read_b64_tr_b16 v[102:103], v39 offset:1280
    ds_read_b128 v[68:71], v38 offset:4096
    ds_read_b64_tr_b16 v[104:105], v40 offset:256
    ds_read_b64_tr_b16 v[106:107], v40 offset:1280
    ds_read_b128 v[72:75], v38 offset:6144
    v_add_f32_dpp v32, v32, v32 quad_perm:[1,0,3,2] row_mask:0xf bank_mask:0xf
    s_waitcnt lgkmcnt(0)
    v_mfma_f32_16x16x32_bf16 v[192:195], v[188:191], v[92:95], v[192:195]
    v_add_f32_dpp v34, v34, v34 quad_perm:[1,0,3,2] row_mask:0xf bank_mask:0xf
    s_nop 0
    v_mfma_f32_16x16x32_bf16 v[200:203], v[188:191], v[100:103], v[200:203]
    v_add_f32_dpp v32, v32, v32 quad_perm:[2,3,0,1] row_mask:0xf bank_mask:0xf
    v_add_f32_dpp v34, v34, v34 quad_perm:[2,3,0,1] row_mask:0xf bank_mask:0xf
    v_mfma_f32_16x16x32_bf16 v[124:127], v[60:63], v[92:95], v[124:127]
    s_nop 0
    v_add_f32_dpp v32, v32, v32 row_half_mirror row_mask:0xf bank_mask:0xf
    v_mfma_f32_16x16x32_bf16 v[140:143], v[64:67], v[92:95], v[140:143]
    v_add_f32_dpp v34, v34, v34 row_half_mirror row_mask:0xf bank_mask:0xf
    s_nop 0
    v_mfma_f32_16x16x32_bf16 v[156:159], v[68:71], v[92:95], v[156:159]
    v_add_f32_dpp v32, v32, v32 row_mirror row_mask:0xf bank_mask:0xf
    v_add_f32_dpp v34, v34, v34 row_mirror row_mask:0xf bank_mask:0xf
    v_mfma_f32_16x16x32_bf16 v[172:175], v[72:75], v[92:95], v[172:175]
    v_mov_b32 v33, v32
    v_mov_b32 v35, v34
    v_mfma_f32_16x16x32_bf16 v[128:131], v[60:63], v[96:99], v[128:131]
    s_nop 0
    v_permlane16_swap_b32 v32, v33
    v_mfma_f32_16x16x32_bf16 v[144:147], v[64:67], v[96:99], v[144:147]
    v_permlane16_swap_b32 v34, v35
    v_add_f32 v32, v32, v33
    v_mfma_f32_16x16x32_bf16 v[160:163], v[68:71], v[96:99], v[160:163]
    v_add_f32 v34, v34, v35
    v_mul_f32 v32, 0x3acccccd, v32
    v_mfma_f32_16x16x32_bf16 v[176:179], v[72:75], v[96:99], v[176:179]
    v_mul_f32 v34, 0x3acccccd, v34
    v_fma_f32 v34, -v32, v32, v34
    v_mfma_f32_16x16x32_bf16 v[132:135], v[60:63], v[100:103], v[132:135]
    v_max_f32 v34, 0, v34
    v_add_f32 v34, 0x3727c5ac, v34
    v_mfma_f32_16x16x32_bf16 v[148:151], v[64:67], v[100:103], v[148:151]
    v_rsq_f32 v33, v34
    s_nop 0
    v_mfma_f32_16x16x32_bf16 v[164:167], v[68:71], v[100:103], v[164:167]
    ds_read_b64_tr_b16 v[108:109], v39 offset:8192
    v_or_b32 v13, 1, v33
    v_and_b32 v5, 7, v0
    v_lshlrev_b32 v5, 2, v5
    global_load_dword v8, v5, s[18:19] sc1
    v_mfma_f32_16x16x32_bf16 v[180:183], v[72:75], v[100:103], v[180:183]
    ds_read_b64_tr_b16 v[110:111], v39 offset:9216
    v_mul_f32 v12, v32, v13
    v_mfma_f32_16x16x32_bf16 v[136:139], v[60:63], v[104:107], v[136:139]
    ds_read_b128 v[76:79], v38 offset:512
    v_mfma_f32_16x16x32_bf16 v[152:155], v[64:67], v[104:107], v[152:155]
    ds_read_b64_tr_b16 v[112:113], v40 offset:8192
    v_mfma_f32_16x16x32_bf16 v[168:171], v[68:71], v[104:107], v[168:171]
    ds_read_b64_tr_b16 v[114:115], v40 offset:9216
    v_mfma_f32_16x16x32_bf16 v[184:187], v[72:75], v[104:107], v[184:187]
    ds_read_b128 v[80:83], v38 offset:2560
    ds_read_b64_tr_b16 v[116:117], v39 offset:8448
    ds_read_b64_tr_b16 v[118:119], v39 offset:9472
    ds_read_b128 v[84:87], v38 offset:4608
    ds_read_b64_tr_b16 v[120:121], v40 offset:8448
    ds_read_b64_tr_b16 v[122:123], v40 offset:9472
    ds_read_b128 v[88:91], v38 offset:6656
    s_waitcnt lgkmcnt(0)
    s_barrier
    v_mfma_f32_16x16x32_bf16 v[192:195], v[188:191], v[108:111], v[192:195]
    v_mfma_f32_16x16x32_bf16 v[200:203], v[188:191], v[116:119], v[200:203]
    v_mfma_f32_16x16x32_bf16 v[124:127], v[76:79], v[108:111], v[124:127]
    v_mfma_f32_16x16x32_bf16 v[140:143], v[80:83], v[108:111], v[140:143]
    v_mfma_f32_16x16x32_bf16 v[156:159], v[84:87], v[108:111], v[156:159]
    v_mfma_f32_16x16x32_bf16 v[172:175], v[88:91], v[108:111], v[172:175]
    v_mfma_f32_16x16x32_bf16 v[128:131], v[76:79], v[112:115], v[128:131]
    v_mfma_f32_16x16x32_bf16 v[144:147], v[80:83], v[112:115], v[144:147]
    v_mfma_f32_16x16x32_bf16 v[160:163], v[84:87], v[112:115], v[160:163]
    v_mfma_f32_16x16x32_bf16 v[176:179], v[88:91], v[112:115], v[176:179]
    v_mfma_f32_16x16x32_bf16 v[132:135], v[76:79], v[116:119], v[132:135]
    v_mfma_f32_16x16x32_bf16 v[148:151], v[80:83], v[116:119], v[148:151]
    v_mfma_f32_16x16x32_bf16 v[164:167], v[84:87], v[116:119], v[164:167]
    ds_read_b64_tr_b16 v[92:93], v39 offset:32768
    v_mfma_f32_16x16x32_bf16 v[180:183], v[88:91], v[116:119], v[180:183]
    ds_read_b64_tr_b16 v[94:95], v39 offset:33792
    v_mfma_f32_16x16x32_bf16 v[136:139], v[76:79], v[120:123], v[136:139]
    ds_read_b128 v[60:63], v38 offset:32768
    v_mfma_f32_16x16x32_bf16 v[152:155], v[80:83], v[120:123], v[152:155]
    ds_read_b64_tr_b16 v[96:97], v40 offset:32768
    v_mfma_f32_16x16x32_bf16 v[168:171], v[84:87], v[120:123], v[168:171]
    ds_read_b64_tr_b16 v[98:99], v40 offset:33792
    v_mfma_f32_16x16x32_bf16 v[184:187], v[88:91], v[120:123], v[184:187]
    ds_read_b128 v[64:67], v38 offset:34816
    ds_read_b64_tr_b16 v[100:101], v39 offset:33024
    ds_read_b64_tr_b16 v[102:103], v39 offset:34048
    ds_read_b128 v[68:71], v38 offset:36864
    ds_read_b64_tr_b16 v[104:105], v40 offset:33024
    ds_read_b64_tr_b16 v[106:107], v40 offset:34048
    ds_read_b128 v[72:75], v38 offset:38912
    s_waitcnt lgkmcnt(0)
    v_mfma_f32_16x16x32_bf16 v[192:195], v[188:191], v[92:95], v[192:195]
    v_mfma_f32_16x16x32_bf16 v[200:203], v[188:191], v[100:103], v[200:203]
    v_mfma_f32_16x16x32_bf16 v[124:127], v[60:63], v[92:95], v[124:127]
    v_mfma_f32_16x16x32_bf16 v[140:143], v[64:67], v[92:95], v[140:143]
    v_mfma_f32_16x16x32_bf16 v[156:159], v[68:71], v[92:95], v[156:159]
    v_mfma_f32_16x16x32_bf16 v[172:175], v[72:75], v[92:95], v[172:175]
    v_mfma_f32_16x16x32_bf16 v[128:131], v[60:63], v[96:99], v[128:131]
    v_mfma_f32_16x16x32_bf16 v[144:147], v[64:67], v[96:99], v[144:147]
    v_mfma_f32_16x16x32_bf16 v[160:163], v[68:71], v[96:99], v[160:163]
    v_mfma_f32_16x16x32_bf16 v[176:179], v[72:75], v[96:99], v[176:179]
    v_mfma_f32_16x16x32_bf16 v[132:135], v[60:63], v[100:103], v[132:135]
    v_mfma_f32_16x16x32_bf16 v[148:151], v[64:67], v[100:103], v[148:151]
    ds_read_b64_tr_b16 v[108:109], v39 offset:40960
    v_mfma_f32_16x16x32_bf16 v[164:167], v[68:71], v[100:103], v[164:167]
    ds_read_b64_tr_b16 v[110:111], v39 offset:41984
    v_mfma_f32_16x16x32_bf16 v[180:183], v[72:75], v[100:103], v[180:183]
    ds_read_b128 v[76:79], v38 offset:33280
    v_mfma_f32_16x16x32_bf16 v[136:139], v[60:63], v[104:107], v[136:139]
    ds_read_b64_tr_b16 v[112:113], v40 offset:40960
    v_mfma_f32_16x16x32_bf16 v[152:155], v[64:67], v[104:107], v[152:155]
    ds_read_b64_tr_b16 v[114:115], v40 offset:41984
    v_mfma_f32_16x16x32_bf16 v[168:171], v[68:71], v[104:107], v[168:171]
    ds_read_b128 v[80:83], v38 offset:35328
    v_mfma_f32_16x16x32_bf16 v[184:187], v[72:75], v[104:107], v[184:187]
    ds_read_b64_tr_b16 v[116:117], v39 offset:41216
    ds_read_b64_tr_b16 v[118:119], v39 offset:42240
    ds_read_b128 v[84:87], v38 offset:37376
    ds_read_b64_tr_b16 v[120:121], v40 offset:41216
    ds_read_b64_tr_b16 v[122:123], v40 offset:42240
    ds_read_b128 v[88:91], v38 offset:39424
    v_add_u32 v38, 65536, v38
    v_add_u32 v39, 65536, v39
    v_add_u32 v40, 65536, v40
    s_waitcnt lgkmcnt(0)
    s_barrier
    v_mfma_f32_16x16x32_bf16 v[192:195], v[188:191], v[108:111], v[192:195]
    v_mfma_f32_16x16x32_bf16 v[200:203], v[188:191], v[116:119], v[200:203]
    v_mfma_f32_16x16x32_bf16 v[124:127], v[76:79], v[108:111], v[124:127]
    v_mfma_f32_16x16x32_bf16 v[140:143], v[80:83], v[108:111], v[140:143]
    v_mfma_f32_16x16x32_bf16 v[156:159], v[84:87], v[108:111], v[156:159]
    v_mfma_f32_16x16x32_bf16 v[172:175], v[88:91], v[108:111], v[172:175]
    v_mfma_f32_16x16x32_bf16 v[128:131], v[76:79], v[112:115], v[128:131]
    v_mfma_f32_16x16x32_bf16 v[144:147], v[80:83], v[112:115], v[144:147]
    v_mfma_f32_16x16x32_bf16 v[160:163], v[84:87], v[112:115], v[160:163]
    v_mfma_f32_16x16x32_bf16 v[176:179], v[88:91], v[112:115], v[176:179]
    v_mfma_f32_16x16x32_bf16 v[132:135], v[76:79], v[116:119], v[132:135]
    ds_read_b64_tr_b16 v[92:93], v39 offset:0
    v_mfma_f32_16x16x32_bf16 v[148:151], v[80:83], v[116:119], v[148:151]
    ds_read_b64_tr_b16 v[94:95], v39 offset:1024
    v_mfma_f32_16x16x32_bf16 v[164:167], v[84:87], v[116:119], v[164:167]
    ds_read_b128 v[60:63], v38 offset:0
    s_waitcnt vmcnt(0)
    v_cmp_ne_u32 vcc, 0, v8
    s_cmp_eq_u64 vcc, -1
    s_cbranch_scc0 Lp1_rwV
Lp1_rokV:
    s_lshl_b32 s34, s2, 2
    s_add_u32 s34, s34, s32
    s_lshl_b32 s34, s34, 4
    s_add_u32 s34, s34, 25673728
    v_lshlrev_b32 v6, 3, v3
    s_mov_b32 exec_lo, 1
    s_mov_b32 exec_hi, 1
    buffer_store_dwordx2 v[12:13], v6, s[20:23], s34 offen sc1
    s_mov_b64 exec, -1
    v_mfma_f32_16x16x32_bf16 v[180:183], v[88:91], v[116:119], v[180:183]
    ds_read_b64_tr_b16 v[96:97], v40 offset:0
    v_mfma_f32_16x16x32_bf16 v[136:139], v[76:79], v[120:123], v[136:139]
    ds_read_b64_tr_b16 v[98:99], v40 offset:1024
    v_mfma_f32_16x16x32_bf16 v[152:155], v[80:83], v[120:123], v[152:155]
    ds_read_b128 v[64:67], v38 offset:2048
    v_mfma_f32_16x16x32_bf16 v[168:171], v[84:87], v[120:123], v[168:171]
    ds_read_b64_tr_b16 v[100:101], v39 offset:256
    v_mfma_f32_16x16x32_bf16 v[184:187], v[88:91], v[120:123], v[184:187]
    ds_read_b64_tr_b16 v[102:103], v39 offset:1280
    ds_read_b128 v[68:71], v38 offset:4096
    ds_read_b64_tr_b16 v[104:105], v40 offset:256
    ds_read_b64_tr_b16 v[106:107], v40 offset:1280
    ds_read_b128 v[72:75], v38 offset:6144
    s_waitcnt lgkmcnt(0)
    v_mfma_f32_16x16x32_bf16 v[192:195], v[188:191], v[92:95], v[192:195]
    s_lshl_b32 s34, s40, 2
    s_lshl_b32 s36, s43, 1
    v_mfma_f32_16x16x32_bf16 v[200:203], v[188:191], v[100:103], v[200:203]
    s_add_u32 s36, s36, s34
    s_sub_u32 s41, s41, 10
    v_mfma_f32_16x16x32_bf16 v[124:127], v[60:63], v[92:95], v[124:127]
    s_lshl_b32 s41, s41, 1
    s_add_u32 s41, s41, s44
    v_mfma_f32_16x16x32_bf16 v[140:143], v[64:67], v[92:95], v[140:143]
    v_mfma_f32_16x16x32_bf16 v[156:159], v[68:71], v[92:95], v[156:159]
    v_mfma_f32_16x16x32_bf16 v[172:175], v[72:75], v[92:95], v[172:175]
    v_mfma_f32_16x16x32_bf16 v[128:131], v[60:63], v[96:99], v[128:131]
    v_mfma_f32_16x16x32_bf16 v[144:147], v[64:67], v[96:99], v[144:147]
    v_mfma_f32_16x16x32_bf16 v[160:163], v[68:71], v[96:99], v[160:163]
    v_mfma_f32_16x16x32_bf16 v[176:179], v[72:75], v[96:99], v[176:179]
    ds_read_b64_tr_b16 v[108:109], v39 offset:8192
    v_mfma_f32_16x16x32_bf16 v[132:135], v[60:63], v[100:103], v[132:135]
    ds_read_b64_tr_b16 v[110:111], v39 offset:9216
    v_mfma_f32_16x16x32_bf16 v[148:151], v[64:67], v[100:103], v[148:151]
    ds_read_b128 v[76:79], v38 offset:512
    v_mfma_f32_16x16x32_bf16 v[164:167], v[68:71], v[100:103], v[164:167]
    ds_read_b64_tr_b16 v[112:113], v40 offset:8192
    v_mfma_f32_16x16x32_bf16 v[180:183], v[72:75], v[100:103], v[180:183]
    ds_read_b64_tr_b16 v[114:115], v40 offset:9216
    v_mfma_f32_16x16x32_bf16 v[136:139], v[60:63], v[104:107], v[136:139]
    ds_read_b128 v[80:83], v38 offset:2560
    v_mfma_f32_16x16x32_bf16 v[152:155], v[64:67], v[104:107], v[152:155]
    ds_read_b64_tr_b16 v[116:117], v39 offset:8448
    v_mfma_f32_16x16x32_bf16 v[168:171], v[68:71], v[104:107], v[168:171]
    ds_read_b64_tr_b16 v[118:119], v39 offset:9472
    v_mfma_f32_16x16x32_bf16 v[184:187], v[72:75], v[104:107], v[184:187]
    ds_read_b128 v[84:87], v38 offset:4608
    ds_read_b64_tr_b16 v[120:121], v40 offset:8448
    ds_read_b64_tr_b16 v[122:123], v40 offset:9472
    ds_read_b128 v[88:91], v38 offset:6656
    v_add_u32 v38, -131072, v38
    v_add_u32 v39, -131072, v39
    v_add_u32 v40, -131072, v40
    s_waitcnt lgkmcnt(0)
    s_barrier
    v_mfma_f32_16x16x32_bf16 v[192:195], v[188:191], v[108:111], v[192:195]
    s_lshl_b32 s41, s41, 2
    v_mfma_f32_16x16x32_bf16 v[200:203], v[188:191], v[116:119], v[200:203]
    s_add_u32 s34, s36, 63
    v_add_u32 v5, s34, v3
    v_mfma_f32_16x16x32_bf16 v[124:127], v[76:79], v[108:111], v[124:127]
    v_and_b32 v5, 63, v5
    v_mul_u32_u24 v5, 2560, v5
    v_mfma_f32_16x16x32_bf16 v[140:143], v[80:83], v[108:111], v[140:143]
    v_mfma_f32_16x16x32_bf16 v[156:159], v[84:87], v[108:111], v[156:159]
    v_mfma_f32_16x16x32_bf16 v[172:175], v[88:91], v[108:111], v[172:175]
    v_mfma_f32_16x16x32_bf16 v[128:131], v[76:79], v[112:115], v[128:131]
    v_mfma_f32_16x16x32_bf16 v[144:147], v[80:83], v[112:115], v[144:147]
    v_mfma_f32_16x16x32_bf16 v[160:163], v[84:87], v[112:115], v[160:163]
    ds_read_b64_tr_b16 v[92:93], v39 offset:0
    v_mfma_f32_16x16x32_bf16 v[176:179], v[88:91], v[112:115], v[176:179]
    ds_read_b64_tr_b16 v[94:95], v39 offset:1024
    v_mfma_f32_16x16x32_bf16 v[132:135], v[76:79], v[116:119], v[132:135]
    ds_read_b128 v[60:63], v38 offset:0
    v_mfma_f32_16x16x32_bf16 v[148:151], v[80:83], v[116:119], v[148:151]
    ds_read_b64_tr_b16 v[96:97], v40 offset:0
    v_mfma_f32_16x16x32_bf16 v[164:167], v[84:87], v[116:119], v[164:167]
    ds_read_b64_tr_b16 v[98:99], v40 offset:1024
    v_mfma_f32_16x16x32_bf16 v[180:183], v[88:91], v[116:119], v[180:183]
    ds_read_b128 v[64:67], v38 offset:2048
    v_mfma_f32_16x16x32_bf16 v[136:139], v[76:79], v[120:123], v[136:139]
    ds_read_b64_tr_b16 v[100:101], v39 offset:256
    v_mfma_f32_16x16x32_bf16 v[152:155], v[80:83], v[120:123], v[152:155]
    ds_read_b64_tr_b16 v[102:103], v39 offset:1280
    v_mfma_f32_16x16x32_bf16 v[168:171], v[84:87], v[120:123], v[168:171]
    ds_read_b128 v[68:71], v38 offset:4096
    v_mfma_f32_16x16x32_bf16 v[184:187], v[88:91], v[120:123], v[184:187]
    ds_read_b64_tr_b16 v[104:105], v40 offset:256
    ds_read_b64_tr_b16 v[106:107], v40 offset:1280
    ds_read_b128 v[72:75], v38 offset:6144
    s_waitcnt lgkmcnt(0)
    v_mfma_f32_16x16x32_bf16 v[192:195], v[188:191], v[92:95], v[192:195]
    v_mul_u32_u24 v6, 320, v49
    v_add_u32 v5, 2622720, v5
    v_mfma_f32_16x16x32_bf16 v[200:203], v[188:191], v[100:103], v[200:203]
    v_add_u32 v36, v5, v6
    s_add_u32 s34, s36, 64
    v_mfma_f32_16x16x32_bf16 v[124:127], v[60:63], v[92:95], v[124:127]
    v_add_u32 v5, s34, v3
    v_and_b32 v5, 63, v5
    v_mfma_f32_16x16x32_bf16 v[140:143], v[64:67], v[92:95], v[140:143]
    v_mfma_f32_16x16x32_bf16 v[156:159], v[68:71], v[92:95], v[156:159]
    v_mfma_f32_16x16x32_bf16 v[172:175], v[72:75], v[92:95], v[172:175]
    v_mfma_f32_16x16x32_bf16 v[128:131], v[60:63], v[96:99], v[128:131]
    v_mfma_f32_16x16x32_bf16 v[144:147], v[64:67], v[96:99], v[144:147]
    ds_read_b64_tr_b16 v[108:109], v39 offset:8192
    v_mfma_f32_16x16x32_bf16 v[160:163], v[68:71], v[96:99], v[160:163]
    ds_read_b64_tr_b16 v[110:111], v39 offset:9216
    v_mfma_f32_16x16x32_bf16 v[176:179], v[72:75], v[96:99], v[176:179]
    ds_read_b128 v[76:79], v38 offset:512
    v_mfma_f32_16x16x32_bf16 v[132:135], v[60:63], v[100:103], v[132:135]
    ds_read_b64_tr_b16 v[112:113], v40 offset:8192
    v_mfma_f32_16x16x32_bf16 v[148:151], v[64:67], v[100:103], v[148:151]
    ds_read_b64_tr_b16 v[114:115], v40 offset:9216
    v_mfma_f32_16x16x32_bf16 v[164:167], v[68:71], v[100:103], v[164:167]
    ds_read_b128 v[80:83], v38 offset:2560
    v_mfma_f32_16x16x32_bf16 v[180:183], v[72:75], v[100:103], v[180:183]
    ds_read_b64_tr_b16 v[116:117], v39 offset:8448
    v_mfma_f32_16x16x32_bf16 v[136:139], v[60:63], v[104:107], v[136:139]
    ds_read_b64_tr_b16 v[118:119], v39 offset:9472
    v_mfma_f32_16x16x32_bf16 v[152:155], v[64:67], v[104:107], v[152:155]
    ds_read_b128 v[84:87], v38 offset:4608
    v_mfma_f32_16x16x32_bf16 v[168:171], v[68:71], v[104:107], v[168:171]
    ds_read_b64_tr_b16 v[120:121], v40 offset:8448
    v_mfma_f32_16x16x32_bf16 v[184:187], v[72:75], v[104:107], v[184:187]
    ds_read_b64_tr_b16 v[122:123], v40 offset:9472
    ds_read_b128 v[88:91], v38 offset:6656
    s_waitcnt lgkmcnt(0)
    s_barrier
    v_mfma_f32_16x16x32_bf16 v[192:195], v[188:191], v[108:111], v[192:195]
    v_mul_u32_u24 v5, 2560, v5
    v_mul_u32_u24 v6, 320, v49
    v_mfma_f32_16x16x32_bf16 v[200:203], v[188:191], v[116:119], v[200:203]
    v_add_u32 v5, 2622720, v5
    v_add_u32 v37, v5, v6
    v_mfma_f32_16x16x32_bf16 v[124:127], v[76:79], v[108:111], v[124:127]
    s_xor_b32 s34, s43, 0
    s_add_u32 s34, s34, s41
    v_mfma_f32_16x16x32_bf16 v[140:143], v[80:83], v[108:111], v[140:143]
    v_mfma_f32_16x16x32_bf16 v[156:159], v[84:87], v[108:111], v[156:159]
    v_mfma_f32_16x16x32_bf16 v[172:175], v[88:91], v[108:111], v[172:175]
    v_mfma_f32_16x16x32_bf16 v[128:131], v[76:79], v[112:115], v[128:131]
    ds_read_b64_tr_b16 v[92:93], v39 offset:32768
    v_mfma_f32_16x16x32_bf16 v[144:147], v[80:83], v[112:115], v[144:147]
    ds_read_b64_tr_b16 v[94:95], v39 offset:33792
    v_mfma_f32_16x16x32_bf16 v[160:163], v[84:87], v[112:115], v[160:163]
    ds_read_b128 v[60:63], v38 offset:32768
    v_mfma_f32_16x16x32_bf16 v[176:179], v[88:91], v[112:115], v[176:179]
    ds_read_b64_tr_b16 v[96:97], v40 offset:32768
    v_mfma_f32_16x16x32_bf16 v[132:135], v[76:79], v[116:119], v[132:135]
    ds_read_b64_tr_b16 v[98:99], v40 offset:33792
    v_mfma_f32_16x16x32_bf16 v[148:151], v[80:83], v[116:119], v[148:151]
    ds_read_b128 v[64:67], v38 offset:34816
    v_mfma_f32_16x16x32_bf16 v[164:167], v[84:87], v[116:119], v[164:167]
    ds_read_b64_tr_b16 v[100:101], v39 offset:33024
    v_mfma_f32_16x16x32_bf16 v[180:183], v[88:91], v[116:119], v[180:183]
    ds_read_b64_tr_b16 v[102:103], v39 offset:34048
    v_mfma_f32_16x16x32_bf16 v[136:139], v[76:79], v[120:123], v[136:139]
    ds_read_b128 v[68:71], v38 offset:36864
    v_mfma_f32_16x16x32_bf16 v[152:155], v[80:83], v[120:123], v[152:155]
    ds_read_b64_tr_b16 v[104:105], v40 offset:33024
    v_mfma_f32_16x16x32_bf16 v[168:171], v[84:87], v[120:123], v[168:171]
    ds_read_b64_tr_b16 v[106:107], v40 offset:34048
    v_mfma_f32_16x16x32_bf16 v[184:187], v[88:91], v[120:123], v[184:187]
    ds_read_b128 v[72:75], v38 offset:38912
    s_waitcnt lgkmcnt(0)
    v_mfma_f32_16x16x32_bf16 v[192:195], v[188:191], v[92:95], v[192:195]
    s_lshl_b32 s34, s34, 4
    v_add_u32 v5, s34, v50
    v_mfma_f32_16x16x32_bf16 v[200:203], v[188:191], v[100:103], v[200:203]
    v_mul_u32_u24 v6, 3277, v5
    v_lshrrev_b32 v6, 16, v6
    v_mfma_f32_16x16x32_bf16 v[124:127], v[60:63], v[92:95], v[124:127]
    v_mul_u32_u24 v6, 163520, v6
    v_lshl_add_u32 v6, v5, 4, v6
    v_mfma_f32_16x16x32_bf16 v[140:143], v[64:67], v[92:95], v[140:143]
    v_mfma_f32_16x16x32_bf16 v[156:159], v[68:71], v[92:95], v[156:159]
    v_mfma_f32_16x16x32_bf16 v[172:175], v[72:75], v[92:95], v[172:175]
    ds_read_b64_tr_b16 v[108:109], v39 offset:40960
    v_mfma_f32_16x16x32_bf16 v[128:131], v[60:63], v[96:99], v[128:131]
    ds_read_b64_tr_b16 v[110:111], v39 offset:41984
    v_mfma_f32_16x16x32_bf16 v[144:147], v[64:67], v[96:99], v[144:147]
    ds_read_b128 v[76:79], v38 offset:33280
    v_mfma_f32_16x16x32_bf16 v[160:163], v[68:71], v[96:99], v[160:163]
    ds_read_b64_tr_b16 v[112:113], v40 offset:40960
    v_mfma_f32_16x16x32_bf16 v[176:179], v[72:75], v[96:99], v[176:179]
    ds_read_b64_tr_b16 v[114:115], v40 offset:41984
    v_mfma_f32_16x16x32_bf16 v[132:135], v[60:63], v[100:103], v[132:135]
    ds_read_b128 v[80:83], v38 offset:35328
    v_mfma_f32_16x16x32_bf16 v[148:151], v[64:67], v[100:103], v[148:151]
    ds_read_b64_tr_b16 v[116:117], v39 offset:41216
    s_branch Lpg3s
Lpg3:
    s_setpc_b64 s[38:39]
Lpg3s:
    v_mfma_f32_16x16x32_bf16 v[164:167], v[68:71], v[100:103], v[164:167]
    ds_read_b64_tr_b16 v[118:119], v39 offset:42240
    v_mfma_f32_16x16x32_bf16 v[180:183], v[72:75], v[100:103], v[180:183]
    ds_read_b128 v[84:87], v38 offset:37376
    v_mfma_f32_16x16x32_bf16 v[136:139], v[60:63], v[104:107], v[136:139]
    ds_read_b64_tr_b16 v[120:121], v40 offset:41216
    v_mfma_f32_16x16x32_bf16 v[152:155], v[64:67], v[104:107], v[152:155]
    ds_read_b64_tr_b16 v[122:123], v40 offset:42240
    v_mfma_f32_16x16x32_bf16 v[168:171], v[68:71], v[104:107], v[168:171]
    ds_read_b128 v[88:91], v38 offset:39424
    v_mfma_f32_16x16x32_bf16 v[184:187], v[72:75], v[104:107], v[184:187]
    v_add_u32 v38, 65536, v38
    v_add_u32 v39, 65536, v39
    v_add_u32 v40, 65536, v40
    s_waitcnt lgkmcnt(0)
    s_barrier
    v_mfma_f32_16x16x32_bf16 v[192:195], v[188:191], v[108:111], v[192:195]
    v_add_u32 v41, v6, v36
    v_add_u32 v42, v6, v37
    v_mfma_f32_16x16x32_bf16 v[200:203], v[188:191], v[116:119], v[200:203]
    s_xor_b32 s34, s43, 1
    s_add_u32 s34, s34, s41
    v_mfma_f32_16x16x32_bf16 v[124:127], v[76:79], v[108:111], v[124:127]
    s_lshl_b32 s34, s34, 4
    v_add_u32 v5, s34, v50
    v_mfma_f32_16x16x32_bf16 v[140:143], v[80:83], v[108:111], v[140:143]
    v_mfma_f32_16x16x32_bf16 v[156:159], v[84:87], v[108:111], v[156:159]
    ds_read_b64_tr_b16 v[92:93], v39 offset:0
    v_mfma_f32_16x16x32_bf16 v[172:175], v[88:91], v[108:111], v[172:175]
    ds_read_b64_tr_b16 v[94:95], v39 offset:1024
    v_mfma_f32_16x16x32_bf16 v[128:131], v[76:79], v[112:115], v[128:131]
    ds_read_b128 v[60:63], v38 offset:0
    v_mfma_f32_16x16x32_bf16 v[144:147], v[80:83], v[112:115], v[144:147]
    ds_read_b64_tr_b16 v[96:97], v40 offset:0
    v_mfma_f32_16x16x32_bf16 v[160:163], v[84:87], v[112:115], v[160:163]
    ds_read_b64_tr_b16 v[98:99], v40 offset:1024
    v_mfma_f32_16x16x32_bf16 v[176:179], v[88:91], v[112:115], v[176:179]
    ds_read_b128 v[64:67], v38 offset:2048
    v_mfma_f32_16x16x32_bf16 v[132:135], v[76:79], v[116:119], v[132:135]
    ds_read_b64_tr_b16 v[100:101], v39 offset:256
    v_mfma_f32_16x16x32_bf16 v[148:151], v[80:83], v[116:119], v[148:151]
    ds_read_b64_tr_b16 v[102:103], v39 offset:1280
    v_mfma_f32_16x16x32_bf16 v[164:167], v[84:87], v[116:119], v[164:167]
    ds_read_b128 v[68:71], v38 offset:4096
    v_mfma_f32_16x16x32_bf16 v[180:183], v[88:91], v[116:119], v[180:183]
    ds_read_b64_tr_b16 v[104:105], v40 offset:256
    v_mfma_f32_16x16x32_bf16 v[136:139], v[76:79], v[120:123], v[136:139]
    ds_read_b64_tr_b16 v[106:107], v40 offset:1280
    v_mfma_f32_16x16x32_bf16 v[152:155], v[80:83], v[120:123], v[152:155]
    ds_read_b128 v[72:75], v38 offset:6144
    v_mfma_f32_16x16x32_bf16 v[168:171], v[84:87], v[120:123], v[168:171]
    v_mfma_f32_16x16x32_bf16 v[184:187], v[88:91], v[120:123], v[184:187]
    s_waitcnt lgkmcnt(0)
    v_mfma_f32_16x16x32_bf16 v[192:195], v[188:191], v[92:95], v[192:195]
    v_mul_u32_u24 v6, 3277, v5
    v_lshrrev_b32 v6, 16, v6
    v_mfma_f32_16x16x32_bf16 v[200:203], v[188:191], v[100:103], v[200:203]
    v_mul_u32_u24 v6, 163520, v6
    v_lshl_add_u32 v6, v5, 4, v6
    v_mfma_f32_16x16x32_bf16 v[124:127], v[60:63], v[92:95], v[124:127]
    v_add_u32 v43, v6, v36
    v_add_u32 v44, v6, v37
    v_mfma_f32_16x16x32_bf16 v[140:143], v[64:67], v[92:95], v[140:143]
    ds_read_b64_tr_b16 v[108:109], v39 offset:8192
    v_mfma_f32_16x16x32_bf16 v[156:159], v[68:71], v[92:95], v[156:159]
    ds_read_b64_tr_b16 v[110:111], v39 offset:9216
    v_mfma_f32_16x16x32_bf16 v[172:175], v[72:75], v[92:95], v[172:175]
    ds_read_b128 v[76:79], v38 offset:512
    v_mfma_f32_16x16x32_bf16 v[128:131], v[60:63], v[96:99], v[128:131]
    ds_read_b64_tr_b16 v[112:113], v40 offset:8192
    v_mfma_f32_16x16x32_bf16 v[144:147], v[64:67], v[96:99], v[144:147]
    ds_read_b64_tr_b16 v[114:115], v40 offset:9216
    v_mfma_f32_16x16x32_bf16 v[160:163], v[68:71], v[96:99], v[160:163]
    ds_read_b128 v[80:83], v38 offset:2560
    v_mfma_f32_16x16x32_bf16 v[176:179], v[72:75], v[96:99], v[176:179]
    ds_read_b64_tr_b16 v[116:117], v39 offset:8448
    v_mfma_f32_16x16x32_bf16 v[132:135], v[60:63], v[100:103], v[132:135]
    ds_read_b64_tr_b16 v[118:119], v39 offset:9472
    v_mfma_f32_16x16x32_bf16 v[148:151], v[64:67], v[100:103], v[148:151]
    ds_read_b128 v[84:87], v38 offset:4608
    v_mfma_f32_16x16x32_bf16 v[164:167], v[68:71], v[100:103], v[164:167]
    ds_read_b64_tr_b16 v[120:121], v40 offset:8448
    v_mfma_f32_16x16x32_bf16 v[180:183], v[72:75], v[100:103], v[180:183]
    ds_read_b64_tr_b16 v[122:123], v40 offset:9472
    v_mfma_f32_16x16x32_bf16 v[136:139], v[60:63], v[104:107], v[136:139]
    ds_read_b128 v[88:91], v38 offset:6656
    v_mfma_f32_16x16x32_bf16 v[152:155], v[64:67], v[104:107], v[152:155]
    v_mfma_f32_16x16x32_bf16 v[168:171], v[68:71], v[104:107], v[168:171]
    v_mfma_f32_16x16x32_bf16 v[184:187], v[72:75], v[104:107], v[184:187]
    s_waitcnt lgkmcnt(0)
    s_barrier
    v_mfma_f32_16x16x32_bf16 v[192:195], v[188:191], v[108:111], v[192:195]
    ds_read_b64_tr_b16 v[92:93], v39 offset:32768
    s_xor_b32 s34, s43, 2
    v_mfma_f32_16x16x32_bf16 v[200:203], v[188:191], v[116:119], v[200:203]
    ds_read_b64_tr_b16 v[94:95], v39 offset:33792
    s_add_u32 s34, s34, s41
    v_mfma_f32_16x16x32_bf16 v[124:127], v[76:79], v[108:111], v[124:127]
    ds_read_b128 v[60:63], v38 offset:32768
    s_lshl_b32 s34, s34, 4
    v_mfma_f32_16x16x32_bf16 v[140:143], v[80:83], v[108:111], v[140:143]
    ds_read_b64_tr_b16 v[96:97], v40 offset:32768
    v_add_u32 v5, s34, v50
    v_mfma_f32_16x16x32_bf16 v[156:159], v[84:87], v[108:111], v[156:159]
    ds_read_b64_tr_b16 v[98:99], v40 offset:33792
    v_mul_u32_u24 v6, 3277, v5
    v_mfma_f32_16x16x32_bf16 v[172:175], v[88:91], v[108:111], v[172:175]
    ds_read_b128 v[64:67], v38 offset:34816
    v_mfma_f32_16x16x32_bf16 v[128:131], v[76:79], v[112:115], v[128:131]
    ds_read_b64_tr_b16 v[100:101], v39 offset:33024
    v_mfma_f32_16x16x32_bf16 v[144:147], v[80:83], v[112:115], v[144:147]
    ds_read_b64_tr_b16 v[102:103], v39 offset:34048
    v_mfma_f32_16x16x32_bf16 v[160:163], v[84:87], v[112:115], v[160:163]
    ds_read_b128 v[68:71], v38 offset:36864
    v_mfma_f32_16x16x32_bf16 v[176:179], v[88:91], v[112:115], v[176:179]
    ds_read_b64_tr_b16 v[104:105], v40 offset:33024
    v_mfma_f32_16x16x32_bf16 v[132:135], v[76:79], v[116:119], v[132:135]
    ds_read_b64_tr_b16 v[106:107], v40 offset:34048
    v_mfma_f32_16x16x32_bf16 v[148:151], v[80:83], v[116:119], v[148:151]
    ds_read_b128 v[72:75], v38 offset:38912
    v_mfma_f32_16x16x32_bf16 v[164:167], v[84:87], v[116:119], v[164:167]
    v_mfma_f32_16x16x32_bf16 v[180:183], v[88:91], v[116:119], v[180:183]
    v_mfma_f32_16x16x32_bf16 v[136:139], v[76:79], v[120:123], v[136:139]
    v_mfma_f32_16x16x32_bf16 v[152:155], v[80:83], v[120:123], v[152:155]
    v_mfma_f32_16x16x32_bf16 v[168:171], v[84:87], v[120:123], v[168:171]
    v_mfma_f32_16x16x32_bf16 v[184:187], v[88:91], v[120:123], v[184:187]
    s_waitcnt lgkmcnt(0)
    v_mfma_f32_16x16x32_bf16 v[192:195], v[188:191], v[92:95], v[192:195]
    ds_read_b64_tr_b16 v[108:109], v39 offset:40960
    v_lshrrev_b32 v6, 16, v6
    v_mfma_f32_16x16x32_bf16 v[200:203], v[188:191], v[100:103], v[200:203]
    ds_read_b64_tr_b16 v[110:111], v39 offset:41984
    v_mul_u32_u24 v6, 163520, v6
    v_mfma_f32_16x16x32_bf16 v[124:127], v[60:63], v[92:95], v[124:127]
    ds_read_b128 v[76:79], v38 offset:33280
    v_lshl_add_u32 v6, v5, 4, v6
    v_mfma_f32_16x16x32_bf16 v[140:143], v[64:67], v[92:95], v[140:143]
    ds_read_b64_tr_b16 v[112:113], v40 offset:40960
    v_add_u32 v45, v6, v36
    v_mfma_f32_16x16x32_bf16 v[156:159], v[68:71], v[92:95], v[156:159]
    ds_read_b64_tr_b16 v[114:115], v40 offset:41984
    v_add_u32 v46, v6, v37
    v_mfma_f32_16x16x32_bf16 v[172:175], v[72:75], v[92:95], v[172:175]
    ds_read_b128 v[80:83], v38 offset:35328
    v_mfma_f32_16x16x32_bf16 v[128:131], v[60:63], v[96:99], v[128:131]
    ds_read_b64_tr_b16 v[116:117], v39 offset:41216
    v_mfma_f32_16x16x32_bf16 v[144:147], v[64:67], v[96:99], v[144:147]
    ds_read_b64_tr_b16 v[118:119], v39 offset:42240
    v_mfma_f32_16x16x32_bf16 v[160:163], v[68:71], v[96:99], v[160:163]
    ds_read_b128 v[84:87], v38 offset:37376
    v_mfma_f32_16x16x32_bf16 v[176:179], v[72:75], v[96:99], v[176:179]
    ds_read_b64_tr_b16 v[120:121], v40 offset:41216
    v_mfma_f32_16x16x32_bf16 v[132:135], v[60:63], v[100:103], v[132:135]
    ds_read_b64_tr_b16 v[122:123], v40 offset:42240
    v_mfma_f32_16x16x32_bf16 v[148:151], v[64:67], v[100:103], v[148:151]
    ds_read_b128 v[88:91], v38 offset:39424
    v_mfma_f32_16x16x32_bf16 v[164:167], v[68:71], v[100:103], v[164:167]
    buffer_load_dwordx2 v[208:209], v51, s[20:23], 0 offen offset:0 sc1
    v_mfma_f32_16x16x32_bf16 v[180:183], v[72:75], v[100:103], v[180:183]
    v_mfma_f32_16x16x32_bf16 v[136:139], v[60:63], v[104:107], v[136:139]
    v_mfma_f32_16x16x32_bf16 v[152:155], v[64:67], v[104:107], v[152:155]
    v_mfma_f32_16x16x32_bf16 v[168:171], v[68:71], v[104:107], v[168:171]
    v_mfma_f32_16x16x32_bf16 v[184:187], v[72:75], v[104:107], v[184:187]
    v_add_u32 v38, 65536, v38
    v_add_u32 v39, 65536, v39
    v_add_u32 v40, 65536, v40
    s_waitcnt lgkmcnt(0)
    s_barrier
    v_mfma_f32_16x16x32_bf16 v[192:195], v[188:191], v[108:111], v[192:195]
    ds_read_b64_tr_b16 v[92:93], v39 offset:0
    s_xor_b32 s34, s43, 3
    v_mfma_f32_16x16x32_bf16 v[200:203], v[188:191], v[116:119], v[200:203]
    ds_read_b64_tr_b16 v[94:95], v39 offset:1024
    s_add_u32 s34, s34, s41
    v_mfma_f32_16x16x32_bf16 v[124:127], v[76:79], v[108:111], v[124:127]
    ds_read_b128 v[60:63], v38 offset:0
    s_lshl_b32 s34, s34, 4
    v_mfma_f32_16x16x32_bf16 v[140:143], v[80:83], v[108:111], v[140:143]
    ds_read_b64_tr_b16 v[96:97], v40 offset:0
    v_add_u32 v5, s34, v50
    v_mfma_f32_16x16x32_bf16 v[156:159], v[84:87], v[108:111], v[156:159]
    ds_read_b64_tr_b16 v[98:99], v40 offset:1024
    v_mul_u32_u24 v6, 3277, v5
    v_mfma_f32_16x16x32_bf16 v[172:175], v[88:91], v[108:111], v[172:175]
    ds_read_b128 v[64:67], v38 offset:2048
    v_mfma_f32_16x16x32_bf16 v[128:131], v[76:79], v[112:115], v[128:131]
    ds_read_b64_tr_b16 v[100:101], v39 offset:256
    v_mfma_f32_16x16x32_bf16 v[144:147], v[80:83], v[112:115], v[144:147]
    ds_read_b64_tr_b16 v[102:103], v39 offset:1280
    v_mfma_f32_16x16x32_bf16 v[160:163], v[84:87], v[112:115], v[160:163]
    ds_read_b128 v[68:71], v38 offset:4096
    v_mfma_f32_16x16x32_bf16 v[176:179], v[88:91], v[112:115], v[176:179]
    ds_read_b64_tr_b16 v[104:105], v40 offset:256
    v_mfma_f32_16x16x32_bf16 v[132:135], v[76:79], v[116:119], v[132:135]
    ds_read_b64_tr_b16 v[106:107], v40 offset:1280
    v_mfma_f32_16x16x32_bf16 v[148:151], v[80:83], v[116:119], v[148:151]
    ds_read_b128 v[72:75], v38 offset:6144
    v_mfma_f32_16x16x32_bf16 v[164:167], v[84:87], v[116:119], v[164:167]
    v_mfma_f32_16x16x32_bf16 v[180:183], v[88:91], v[116:119], v[180:183]
    v_mfma_f32_16x16x32_bf16 v[136:139], v[76:79], v[120:123], v[136:139]
    v_mfma_f32_16x16x32_bf16 v[152:155], v[80:83], v[120:123], v[152:155]
    v_mfma_f32_16x16x32_bf16 v[168:171], v[84:87], v[120:123], v[168:171]
    v_mfma_f32_16x16x32_bf16 v[184:187], v[88:91], v[120:123], v[184:187]
    s_waitcnt lgkmcnt(0)
    v_mfma_f32_16x16x32_bf16 v[192:195], v[188:191], v[92:95], v[192:195]
    ds_read_b64_tr_b16 v[108:109], v39 offset:8192
    v_lshrrev_b32 v6, 16, v6
    v_mfma_f32_16x16x32_bf16 v[200:203], v[188:191], v[100:103], v[200:203]
    ds_read_b64_tr_b16 v[110:111], v39 offset:9216
    v_mul_u32_u24 v6, 163520, v6
    v_mfma_f32_16x16x32_bf16 v[124:127], v[60:63], v[92:95], v[124:127]
    ds_read_b128 v[76:79], v38 offset:512
    v_lshl_add_u32 v6, v5, 4, v6
    v_mfma_f32_16x16x32_bf16 v[140:143], v[64:67], v[92:95], v[140:143]
    ds_read_b64_tr_b16 v[112:113], v40 offset:8192
    v_add_u32 v47, v6, v36
    v_mfma_f32_16x16x32_bf16 v[156:159], v[68:71], v[92:95], v[156:159]
    ds_read_b64_tr_b16 v[114:115], v40 offset:9216
    v_add_u32 v48, v6, v37
    v_mfma_f32_16x16x32_bf16 v[172:175], v[72:75], v[92:95], v[172:175]
    ds_read_b128 v[80:83], v38 offset:2560
    v_mfma_f32_16x16x32_bf16 v[128:131], v[60:63], v[96:99], v[128:131]
    ds_read_b64_tr_b16 v[116:117], v39 offset:8448
    v_mfma_f32_16x16x32_bf16 v[144:147], v[64:67], v[96:99], v[144:147]
    ds_read_b64_tr_b16 v[118:119], v39 offset:9472
    v_mfma_f32_16x16x32_bf16 v[160:163], v[68:71], v[96:99], v[160:163]
    ds_read_b128 v[84:87], v38 offset:4608
    v_mfma_f32_16x16x32_bf16 v[176:179], v[72:75], v[96:99], v[176:179]
    ds_read_b64_tr_b16 v[120:121], v40 offset:8448
    v_mfma_f32_16x16x32_bf16 v[132:135], v[60:63], v[100:103], v[132:135]
    ds_read_b64_tr_b16 v[122:123], v40 offset:9472
    v_mfma_f32_16x16x32_bf16 v[148:151], v[64:67], v[100:103], v[148:151]
    ds_read_b128 v[88:91], v38 offset:6656
    v_mfma_f32_16x16x32_bf16 v[164:167], v[68:71], v[100:103], v[164:167]
    v_mfma_f32_16x16x32_bf16 v[180:183], v[72:75], v[100:103], v[180:183]
    v_mfma_f32_16x16x32_bf16 v[136:139], v[60:63], v[104:107], v[136:139]
    v_mfma_f32_16x16x32_bf16 v[152:155], v[64:67], v[104:107], v[152:155]
    v_mfma_f32_16x16x32_bf16 v[168:171], v[68:71], v[104:107], v[168:171]
    v_mfma_f32_16x16x32_bf16 v[184:187], v[72:75], v[104:107], v[184:187]
    s_waitcnt lgkmcnt(0)
    v_mfma_f32_16x16x32_bf16 v[192:195], v[188:191], v[108:111], v[192:195]
    v_mfma_f32_16x16x32_bf16 v[200:203], v[188:191], v[116:119], v[200:203]
    v_mfma_f32_16x16x32_bf16 v[124:127], v[76:79], v[108:111], v[124:127]
    s_waitcnt vmcnt(0)
Lp1_xsV:
    v_cmp_ne_u32 vcc, 0, v209
    s_cmp_eq_u64 vcc, -1
    s_cbranch_scc0 Lp1_xrV
Lp1_xsokV:
    v_mfma_f32_16x16x32_bf16 v[140:143], v[80:83], v[108:111], v[140:143]
    v_cmp_eq_u32 vcc, 0, v3
    v_mfma_f32_16x16x32_bf16 v[156:159], v[84:87], v[108:111], v[156:159]
    v_mfma_f32_16x16x32_bf16 v[172:175], v[88:91], v[108:111], v[172:175]
    v_cndmask_b32 v208, v209, v208, vcc
    ds_write_b32 v56, v208
    v_mfma_f32_16x16x32_bf16 v[128:131], v[76:79], v[112:115], v[128:131]
    ds_write_b128 v52, v[192:195] offset:0
    v_mfma_f32_16x16x32_bf16 v[144:147], v[80:83], v[112:115], v[144:147]
    ds_write_b128 v52, v[200:203] offset:1024
    v_mfma_f32_16x16x32_bf16 v[160:163], v[84:87], v[112:115], v[160:163]
    v_mfma_f32_16x16x32_bf16 v[176:179], v[88:91], v[112:115], v[176:179]
    v_mfma_f32_16x16x32_bf16 v[132:135], v[76:79], v[116:119], v[132:135]
    v_mfma_f32_16x16x32_bf16 v[148:151], v[80:83], v[116:119], v[148:151]
    v_mfma_f32_16x16x32_bf16 v[164:167], v[84:87], v[116:119], v[164:167]
    v_mfma_f32_16x16x32_bf16 v[180:183], v[88:91], v[116:119], v[180:183]
    s_waitcnt lgkmcnt(0)
    s_barrier
    v_mfma_f32_16x16x32_bf16 v[136:139], v[76:79], v[120:123], v[136:139]
    ds_read_b32 v192, v53 offset:0
    v_mfma_f32_16x16x32_bf16 v[152:155], v[80:83], v[120:123], v[152:155]
    ds_read_b32 v196, v54 offset:0
    v_mfma_f32_16x16x32_bf16 v[168:171], v[84:87], v[120:123], v[168:171]
    ds_read_b32 v200, v53 offset:1024
    v_mfma_f32_16x16x32_bf16 v[184:187], v[88:91], v[120:123], v[184:187]
    ds_read_b32 v204, v54 offset:1024
    ds_read_b128 v[60:63], v55 offset:512
    ds_read_b128 v[64:67], v55 offset:0
    ds_read_b128 v[68:71], v55 offset:576
    ds_read_b128 v[72:75], v55 offset:64
    ds_read_b128 v[76:79], v55 offset:640
    ds_read_b128 v[80:83], v55 offset:128
    ds_read_b128 v[84:87], v55 offset:704
    ds_read_b128 v[88:91], v55 offset:192
    s_waitcnt lgkmcnt(4)
    v_pk_mul_f32 v[124:125], v[60:61], v[124:125]
    v_pk_mul_f32 v[126:127], v[62:63], v[126:127]
    v_pk_fma_f32 v[124:125], v[192:193], v[64:65], v[124:125] op_sel_hi:[0,1,1] neg_lo:[1,0,0] neg_hi:[1,0,0]
    v_pk_fma_f32 v[126:127], v[192:193], v[66:67], v[126:127] op_sel_hi:[0,1,1] neg_lo:[1,0,0] neg_hi:[1,0,0]
    v_pk_mul_f32 v[140:141], v[68:69], v[140:141]
    v_pk_mul_f32 v[142:143], v[70:71], v[142:143]
    v_pk_fma_f32 v[140:141], v[192:193], v[72:73], v[140:141] op_sel_hi:[0,1,1] neg_lo:[1,0,0] neg_hi:[1,0,0]
    v_pk_fma_f32 v[142:143], v[192:193], v[74:75], v[142:143] op_sel_hi:[0,1,1] neg_lo:[1,0,0] neg_hi:[1,0,0]
    v_cvt_pk_bf16_f32 v124, v124, v125
    v_cvt_pk_bf16_f32 v125, v126, v127
    v_cvt_pk_bf16_f32 v126, v140, v141
    v_cvt_pk_bf16_f32 v127, v142, v143
    buffer_store_dwordx4 v[124:127], v41, s[20:23], 0 offen sc1
    v_pk_mul_f32 v[128:129], v[60:61], v[128:129]
    v_pk_mul_f32 v[130:131], v[62:63], v[130:131]
    v_pk_fma_f32 v[128:129], v[196:197], v[64:65], v[128:129] op_sel_hi:[0,1,1] neg_lo:[1,0,0] neg_hi:[1,0,0]
    v_pk_fma_f32 v[130:131], v[196:197], v[66:67], v[130:131] op_sel_hi:[0,1,1] neg_lo:[1,0,0] neg_hi:[1,0,0]
    v_pk_mul_f32 v[144:145], v[68:69], v[144:145]
    v_pk_mul_f32 v[146:147], v[70:71], v[146:147]
    v_pk_fma_f32 v[144:145], v[196:197], v[72:73], v[144:145] op_sel_hi:[0,1,1] neg_lo:[1,0,0] neg_hi:[1,0,0]
    v_pk_fma_f32 v[146:147], v[196:197], v[74:75], v[146:147] op_sel_hi:[0,1,1] neg_lo:[1,0,0] neg_hi:[1,0,0]
    v_cvt_pk_bf16_f32 v128, v128, v129
    v_cvt_pk_bf16_f32 v129, v130, v131
    v_cvt_pk_bf16_f32 v130, v144, v145
    v_cvt_pk_bf16_f32 v131, v146, v147
    buffer_store_dwordx4 v[128:131], v43, s[20:23], 0 offen sc1
    v_pk_mul_f32 v[132:133], v[60:61], v[132:133]
    v_pk_mul_f32 v[134:135], v[62:63], v[134:135]
    v_pk_fma_f32 v[132:133], v[200:201], v[64:65], v[132:133] op_sel_hi:[0,1,1] neg_lo:[1,0,0] neg_hi:[1,0,0]
    v_pk_fma_f32 v[134:135], v[200:201], v[66:67], v[134:135] op_sel_hi:[0,1,1] neg_lo:[1,0,0] neg_hi:[1,0,0]
    v_pk_mul_f32 v[148:149], v[68:69], v[148:149]
    v_pk_mul_f32 v[150:151], v[70:71], v[150:151]
    v_pk_fma_f32 v[148:149], v[200:201], v[72:73], v[148:149] op_sel_hi:[0,1,1] neg_lo:[1,0,0] neg_hi:[1,0,0]
    v_pk_fma_f32 v[150:151], v[200:201], v[74:75], v[150:151] op_sel_hi:[0,1,1] neg_lo:[1,0,0] neg_hi:[1,0,0]
    v_cvt_pk_bf16_f32 v132, v132, v133
    v_cvt_pk_bf16_f32 v133, v134, v135
    v_cvt_pk_bf16_f32 v134, v148, v149
    v_cvt_pk_bf16_f32 v135, v150, v151
    buffer_store_dwordx4 v[132:135], v45, s[20:23], 0 offen sc1
    v_pk_mul_f32 v[136:137], v[60:61], v[136:137]
    v_pk_mul_f32 v[138:139], v[62:63], v[138:139]
    v_pk_fma_f32 v[136:137], v[204:205], v[64:65], v[136:137] op_sel_hi:[0,1,1] neg_lo:[1,0,0] neg_hi:[1,0,0]
    v_pk_fma_f32 v[138:139], v[204:205], v[66:67], v[138:139] op_sel_hi:[0,1,1] neg_lo:[1,0,0] neg_hi:[1,0,0]
    v_pk_mul_f32 v[152:153], v[68:69], v[152:153]
    v_pk_mul_f32 v[154:155], v[70:71], v[154:155]
    v_pk_fma_f32 v[152:153], v[204:205], v[72:73], v[152:153] op_sel_hi:[0,1,1] neg_lo:[1,0,0] neg_hi:[1,0,0]
    v_pk_fma_f32 v[154:155], v[204:205], v[74:75], v[154:155] op_sel_hi:[0,1,1] neg_lo:[1,0,0] neg_hi:[1,0,0]
    v_cvt_pk_bf16_f32 v136, v136, v137
    v_cvt_pk_bf16_f32 v137, v138, v139
    v_cvt_pk_bf16_f32 v138, v152, v153
    v_cvt_pk_bf16_f32 v139, v154, v155
    buffer_store_dwordx4 v[136:139], v47, s[20:23], 0 offen sc1
    s_waitcnt lgkmcnt(0)
    v_pk_mul_f32 v[156:157], v[76:77], v[156:157]
    v_pk_mul_f32 v[158:159], v[78:79], v[158:159]
    v_pk_fma_f32 v[156:157], v[192:193], v[80:81], v[156:157] op_sel_hi:[0,1,1] neg_lo:[1,0,0] neg_hi:[1,0,0]
    v_pk_fma_f32 v[158:159], v[192:193], v[82:83], v[158:159] op_sel_hi:[0,1,1] neg_lo:[1,0,0] neg_hi:[1,0,0]
    v_pk_mul_f32 v[172:173], v[84:85], v[172:173]
    v_pk_mul_f32 v[174:175], v[86:87], v[174:175]
    v_pk_fma_f32 v[172:173], v[192:193], v[88:89], v[172:173] op_sel_hi:[0,1,1] neg_lo:[1,0,0] neg_hi:[1,0,0]
    v_pk_fma_f32 v[174:175], v[192:193], v[90:91], v[174:175] op_sel_hi:[0,1,1] neg_lo:[1,0,0] neg_hi:[1,0,0]
    v_cvt_pk_bf16_f32 v156, v156, v157
    v_cvt_pk_bf16_f32 v157, v158, v159
    v_cvt_pk_bf16_f32 v158, v172, v173
    v_cvt_pk_bf16_f32 v159, v174, v175
    buffer_store_dwordx4 v[156:159], v42, s[20:23], 0 offen sc1
    v_pk_mul_f32 v[160:161], v[76:77], v[160:161]
    v_pk_mul_f32 v[162:163], v[78:79], v[162:163]
    v_pk_fma_f32 v[160:161], v[196:197], v[80:81], v[160:161] op_sel_hi:[0,1,1] neg_lo:[1,0,0] neg_hi:[1,0,0]
    v_pk_fma_f32 v[162:163], v[196:197], v[82:83], v[162:163] op_sel_hi:[0,1,1] neg_lo:[1,0,0] neg_hi:[1,0,0]
    v_pk_mul_f32 v[176:177], v[84:85], v[176:177]
    v_pk_mul_f32 v[178:179], v[86:87], v[178:179]
    v_pk_fma_f32 v[176:177], v[196:197], v[88:89], v[176:177] op_sel_hi:[0,1,1] neg_lo:[1,0,0] neg_hi:[1,0,0]
    v_pk_fma_f32 v[178:179], v[196:197], v[90:91], v[178:179] op_sel_hi:[0,1,1] neg_lo:[1,0,0] neg_hi:[1,0,0]
    v_cvt_pk_bf16_f32 v160, v160, v161
    v_cvt_pk_bf16_f32 v161, v162, v163
    v_cvt_pk_bf16_f32 v162, v176, v177
    v_cvt_pk_bf16_f32 v163, v178, v179
    buffer_store_dwordx4 v[160:163], v44, s[20:23], 0 offen sc1
    v_pk_mul_f32 v[164:165], v[76:77], v[164:165]
    v_pk_mul_f32 v[166:167], v[78:79], v[166:167]
    v_pk_fma_f32 v[164:165], v[200:201], v[80:81], v[164:165] op_sel_hi:[0,1,1] neg_lo:[1,0,0] neg_hi:[1,0,0]
    v_pk_fma_f32 v[166:167], v[200:201], v[82:83], v[166:167] op_sel_hi:[0,1,1] neg_lo:[1,0,0] neg_hi:[1,0,0]
    v_pk_mul_f32 v[180:181], v[84:85], v[180:181]
    v_pk_mul_f32 v[182:183], v[86:87], v[182:183]
    v_pk_fma_f32 v[180:181], v[200:201], v[88:89], v[180:181] op_sel_hi:[0,1,1] neg_lo:[1,0,0] neg_hi:[1,0,0]
    v_pk_fma_f32 v[182:183], v[200:201], v[90:91], v[182:183] op_sel_hi:[0,1,1] neg_lo:[1,0,0] neg_hi:[1,0,0]
    v_cvt_pk_bf16_f32 v164, v164, v165
    v_cvt_pk_bf16_f32 v165, v166, v167
    v_cvt_pk_bf16_f32 v166, v180, v181
    v_cvt_pk_bf16_f32 v167, v182, v183
    buffer_store_dwordx4 v[164:167], v46, s[20:23], 0 offen sc1
    v_pk_mul_f32 v[168:169], v[76:77], v[168:169]
    v_pk_mul_f32 v[170:171], v[78:79], v[170:171]
    v_pk_fma_f32 v[168:169], v[204:205], v[80:81], v[168:169] op_sel_hi:[0,1,1] neg_lo:[1,0,0] neg_hi:[1,0,0]
    v_pk_fma_f32 v[170:171], v[204:205], v[82:83], v[170:171] op_sel_hi:[0,1,1] neg_lo:[1,0,0] neg_hi:[1,0,0]
    v_pk_mul_f32 v[184:185], v[84:85], v[184:185]
    v_pk_mul_f32 v[186:187], v[86:87], v[186:187]
    v_pk_fma_f32 v[184:185], v[204:205], v[88:89], v[184:185] op_sel_hi:[0,1,1] neg_lo:[1,0,0] neg_hi:[1,0,0]
    v_pk_fma_f32 v[186:187], v[204:205], v[90:91], v[186:187] op_sel_hi:[0,1,1] neg_lo:[1,0,0] neg_hi:[1,0,0]
    v_cvt_pk_bf16_f32 v168, v168, v169
    v_cvt_pk_bf16_f32 v169, v170, v171
    v_cvt_pk_bf16_f32 v170, v184, v185
    v_cvt_pk_bf16_f32 v171, v186, v187
    buffer_store_dwordx4 v[168:171], v48, s[20:23], 0 offen sc1
Lp1_cdone:
Lp2_setup:
    s_lshl_b32 s42, s2, 3
    s_add_u32 s42, s42, s32
    s_add_u32 s42, s42, 1024
    s_call_b64 s[38:39], Ljob
    s_mov_b32 s28, s24
    s_mov_b32 s29, s25
    s_mov_b32 s30, s26
    s_mov_b32 s31, 0x20000
    s_mov_b32 s40, s43
    v_mov_b32 v22, v20
    s_add_u32 s42, s42, 2048
    s_call_b64 s[38:39], Ljob
    s_cmp_ge_u32 s32, 4
    s_cbranch_scc1 Ls1_na
    s_waitcnt vmcnt(0)
    s_barrier
Ls1_na:
    s_and_b32 s48, s2, 7
    s_lshl_b32 s48, s48, 2
    s_lshr_b32 s34, s2, 6
    s_add_u32 s48, s48, s34
    s_lshr_b32 s53, s32, 2
    s_bfe_u32 s49, s2, 0x30003
    s_lshl_b32 s49, s49, 2
    s_add_u32 s49, s49, s33
    s_lshl_b32 s49, s49, 1
    s_add_u32 s49, s49, s53
    s_mul_i32 s50, s48, 163840
    s_add_u32 s50, s50, 2621440
    s_mul_i32 s34, s33, 2560
    s_mul_i32 s51, s53, 81920
    s_add_u32 s51, s51, s50
    s_add_u32 s51, s51, s34
    s_mul_i32 s35, s53, 10240
    s_add_u32 s35, s35, 256
    s_add_u32 s52, s35, s34
    s_mul_i32 s34, s32, 12800
    s_add_u32 s55, s34, 61440
    s_lshr_b32 s54, s2, 5
    s_mul_i32 s54, s54, 102400
    s_add_u32 s54, s54, s34
    s_add_u32 s54, s54, 20316160
    v_lshlrev_b32 v34, 7, v1
    v_lshlrev_b32 v32, 3, v2
    v_mul_u32_u24 v33, 320, v3
    v_lshl_add_u32 v33, v2, 4, v33
    v_mov_b32 v25, 0x3f803f80
    v_mov_b32 v24, 0xdddd
    v_cmp_eq_u32 s[56:57], 0, v3
    v_cmp_gt_u32 s[58:59], 20, v2
    v_cmp_eq_u32 vcc, 20, v2
    v_add_u32 v27, s35, v4
    v_add_u32 v28, s35, v32
    v_add_u32 v30, s35, v33
    v_cndmask_b32 v26, 0, v25, vcc
    v_add_u32 v29, 20480, v28
    v_add_u32 v31, 20480, v30
    v_mov_b32 v5, 41472
    v_add_u32 v6, 41216, v33
    v_cndmask_b32 v28, v5, v28, s[56:57]
    v_cndmask_b32 v30, v6, v30, s[58:59]
    v_cndmask_b32 v29, v5, v29, s[56:57]
    v_cndmask_b32 v31, v6, v31, s[58:59]
    s_lshr_b32 s34, s2, 5
    s_lshl_b32 s34, s34, 1
    s_bfe_u32 s35, s2, 0x10003
    s_add_u32 s34, s34, s35
    s_mul_i32 s34, s34, 140
    s_mul_i32 s35, s53, 100
    s_add_u32 s34, s34, s35
    s_add_u32 s34, s34, s33
    s_lshl_b32 s34, s34, 10
    s_add_u32 s65, s34, 21135360
    s_add_u32 s34, s65, 40960
    s_lshr_b32 s35, s2, 5
    s_mul_i32 s35, s35, 270
    s_add_u32 s35, s35, s33
    s_lshl_b32 s35, s35, 10
    s_add_u32 s35, s35, 23582720
    s_cmp_eq_u32 s53, 0
    s_cselect_b32 s66, s34, s35
    s_lshl_b32 s34, s2, 7
    s_add_u32 s34, s34, 25640960
    v_mov_b32 v232, s34
    v_mov_b32 v5, 0x7f000000
    v_cmp_eq_u32 vcc, 0, v0
    s_or_b32 s34, s3, 0x200
    v_mov_b32 v233, s34
    v_cndmask_b32 v232, v5, v232, vcc
    s_lshl_b32 s34, s32, 12
    s_add_u32 s34, s34, 25640960
    v_lshrrev_b32 v6, 1, v1
    v_lshl_add_u32 v234, v6, 7, s34
    s_and_b32 s36, s2, 7
    s_lshl_b32 s34, s36, 1
    s_lshl_b32 s64, 0x00010001, s34
    s_lshl_b32 s34, s36, 8
    s_and_b32 s35, s2, 0xf8
    s_add_u32 s34, s34, s35
    s_add_u32 s34, s34, s32
    s_mul_i32 s35, s34, 1280
    s_add_u32 s35, s35, 10485760
    v_add_u32 v248, s35, v34
    v_cmp_gt_u32 vcc, 10, v1
    s_lshl_b32 s35, s34, 6
    s_add_u32 s35, s35, 13107200
    v_cndmask_b32 v248, v5, v248, vcc
    v_writelane_b32 v248, s35, 10
    s_lshl_b32 s35, s34, 2
    s_add_u32 s35, s35, 25690112
    v_writelane_b32 v248, s35, 11
    s_lshl_b32 s34, s36, 2
    s_bfe_u32 s35, s2, 0x20003
    s_add_u32 s34, s34, s35
    s_lshl_b32 s34, s34, 2
    s_add_u32 s34, s34, s33
    s_mul_i32 s34, s34, 20480
    s_lshr_b32 s35, s2, 5
    s_mul_i32 s35, s35, 160
    s_add_u32 s34, s34, s35
    v_and_b32 v5, 15, v0
    v_mul_u32_u24 v5, 1280, v5
    v_bfe_u32 v6, v0, 4, 2
    v_lshl_add_u32 v5, v6, 3, v5
    s_sub_u32 s35, s53, 1
    v_and_b32 v5, s35, v5
    v_add_u32 v236, s34, v5
    s_mul_i32 s34, s53, 12800
    s_add_u32 s34, s34, 116736
    s_lshl_b32 s35, s33, 10
    s_add_u32 s60, s34, s35
    s_lshl_b32 s35, s33, 5
    s_add_u32 s34, s34, s35
    v_bfe_u32 v5, v0, 4, 2
    v_lshlrev_b32 v5, 10, v5
    v_bfe_u32 v6, v0, 2, 2
    v_lshl_add_u32 v5, v6, 7, v5
    v_and_b32 v6, 3, v0
    v_lshl_add_u32 v5, v6, 3, v5
    v_add_u32 v21, s34, v5
    v_add_u32 v5, 0, v0
    v_mul_u32_u24 v6, 3277, v5
    v_lshrrev_b32 v6, 16, v6
    v_mul_u32_u24 v6, 20, v6
    v_cmp_eq_u32 vcc, v5, v6
    v_min_u32 v5, 703, v5
    v_lshlrev_b32 v5, 4, v5
    v_cndmask_b32 v64, 0, v25, vcc
    v_cndmask_b32 v65, 0, v25, vcc
    v_cndmask_b32 v66, 0, v25, vcc
    v_cndmask_b32 v67, 0, v25, vcc
    ds_write_b128 v5, v[64:67] offset:41216
    v_add_u32 v5, 512, v0
    v_mul_u32_u24 v6, 3277, v5
    v_lshrrev_b32 v6, 16, v6
    v_mul_u32_u24 v6, 20, v6
    v_cmp_eq_u32 vcc, v5, v6
    v_min_u32 v5, 703, v5
    v_lshlrev_b32 v5, 4, v5
    v_cndmask_b32 v64, 0, v25, vcc
    v_cndmask_b32 v65, 0, v25, vcc
    v_cndmask_b32 v66, 0, v25, vcc
    v_cndmask_b32 v67, 0, v25, vcc
    ds_write_b128 v5, v[64:67] offset:41216
    v_mov_b32 v116, 0
    v_mov_b32 v117, 0
    v_mov_b32 v118, 0
    v_mov_b32 v119, 0
    v_mov_b32 v120, 0
    v_mov_b32 v121, 0
    v_mov_b32 v122, 0
    v_mov_b32 v123, 0
    v_mov_b32 v124, 0
    v_mov_b32 v125, 0
    v_mov_b32 v126, 0
    v_mov_b32 v127, 0
    v_mov_b32 v128, 0
    v_mov_b32 v129, 0
    v_mov_b32 v130, 0
    v_mov_b32 v131, 0
    v_mov_b32 v132, 0
    v_mov_b32 v133, 0
    v_mov_b32 v134, 0
    v_mov_b32 v135, 0
    v_mov_b32 v136, 0
    v_mov_b32 v137, 0
    v_mov_b32 v138, 0
    v_mov_b32 v139, 0
    v_mov_b32 v140, 0
    v_mov_b32 v141, 0
    v_mov_b32 v142, 0
    v_mov_b32 v143, 0
    v_mov_b32 v144, 0
    v_mov_b32 v145, 0
    v_mov_b32 v146, 0
    v_mov_b32 v147, 0
    v_mov_b32 v176, -1
    v_mov_b32 v177, -1
    v_mov_b32 v178, -1
    v_mov_b32 v179, -1
    s_lshl_b32 s67, s48, 6
    s_add_u32 s67, s67, s49
    s_mul_i32 s67, s67, 1280
    s_mul_i32 s68, s53, 81920
    s_sub_u32 s68, s50, s68
    s_add_u32 s68, s68, 161280
    s_mov_b32 m0, s52
    s_cmp_lt_u32 s32, 4
    s_cbranch_scc1 Ls1_done
    s_mul_i32 s34, s48, 20
    v_bfe_u32 v5, v0, 4, 1
    v_mul_u32_u24 v5, 19, v5
    v_add_u32 v5, s34, v5
    v_lshrrev_b32 v5, 7, v5
    v_and_b32 v6, 15, v0
    s_cmp_eq_u32 s32, 4
    s_cbranch_scc1 Ls1_kv
    s_bfe_u32 s34, s2, 0x30003
    s_lshl_b32 s34, s34, 1
    v_and_b32 v6, 1, v0
    s_branch Lpg4s
Lpg4:
    s_setpc_b64 s[38:39]
Lpg4s:
    v_add_u32 v6, s34, v6
    s_branch Ls1_id
Ls1_kv:
    v_mad_u32_u24 v5, v3, 5, v5
    v_add_u32 v5, 5, v5
Ls1_id:
    v_and_b32 v7, 3, v6
    v_lshl_add_u32 v5, v5, 2, v7
    v_lshrrev_b32 v6, 2, v6
    v_lshlrev_b32 v6, 1, v6
    v_lshl_add_u32 v6, v5, 3, v6
    v_cmp_le_u32 vcc, 30, v5
    v_subrev_u32 v7, 239, v6
    v_and_b32 v5, 15, v0
    v_cndmask_b32 v6, v6, v7, vcc
    v_add_u32 v5, 240, v5
    s_cmp_eq_u32 s32, 4
    s_cselect_b64 vcc, -1, s[56:57]
    v_cndmask_b32 v6, v5, v6, vcc
    v_lshlrev_b32 v6, 7, v6
    v_add_u32 v5, 25640960, v6
    s_barrier
    s_cmp_lg_u32 s32, 6
    s_cbranch_scc1 Lpub_32
    s_lshl_b32 s34, s2, 7
    s_add_u32 s34, s34, 25640960
    s_or_b32 s36, s3, 256
    v_mov_b32 v6, s36
    s_mov_b64 exec, 1
    buffer_store_dword v6, v4, s[20:23], s34 offen sc1
    s_mov_b64 exec, -1
Lpub_32:
    s_cmp_ge_u32 s32, 6
    s_cbranch_scc1 Ls1_done
    s_mov_b32 s37, 0
    buffer_load_dword v8, v5, s[20:23], 0 offen sc1
Lpoll_33:
    s_waitcnt vmcnt(0)
    v_cmp_gt_u32 vcc, 256, v8
    s_and_b64 exec, exec, vcc
    s_cbranch_scc0 Lpolle_34
    buffer_load_dword v8, v5, s[20:23], 0 offen sc1
    s_add_u32 s37, s37, 1
    s_cmp_lt_u32 s37, 0x200000
    s_cbranch_scc1 Lpoll_33
Lpolle_34:
    s_mov_b64 exec, -1
Ls1_done:
    s_setprio 3
    s_waitcnt lgkmcnt(0)
    s_barrier
    buffer_load_dwordx4 v[36:39], v4, s[20:23], s67 offen sc1
    buffer_load_dwordx2 v[44:45], v32, s[20:23], s67 offen offset:1024 sc1
    buffer_load_dwordx4 v[52:55], v4, s[20:23], s68 offen sc1
    buffer_load_dwordx2 v[48:49], v32, s[20:23], s68 offen offset:1024 sc1
    s_setprio 0
    buffer_load_dwordx4 v4, s[20:23], s51 offen offset:0 sc1 lds
    buffer_load_dwordx4 v4, s[20:23], s51 offen offset:1024 sc1 lds
    s_mov_b32 exec_hi, 0
    buffer_load_dwordx4 v4, s[20:23], s51 offen offset:2048 sc1 lds
    s_mov_b32 exec_hi, -1
    buffer_load_dwordx4 v[56:59], v33, s[20:23], s68 offen offset:1280 sc1
    v_lshlrev_b32 v7, 4, v0
    v_add_u32 v7, 0x10000, v7
    v_xor_b32 v8, 0x1000, v7
    s_waitcnt vmcnt(4)
    v_cndmask_b32 v44, 0, v44, s[56:57]
    v_cndmask_b32 v45, 0, v45, s[56:57]
    v_cndmask_b32 v48, v25, v48, s[56:57]
    v_cndmask_b32 v49, v25, v49, s[56:57]
    s_nop 1
    v_mfma_f32_32x32x8_bf16 v[68:83], v[48:49], v[44:45], 0
    v_mfma_f32_32x32x16_bf16 v[68:83], v[52:55], v[36:39], v[68:83]
    ds_write_b128 v7, v[36:39]
    s_nop 10
    v_max3_f32 v5, v68, v69, v70
    v_max3_f32 v5, v5, v71, v72
    v_max3_f32 v5, v5, v73, v74
    v_max3_f32 v5, v5, v75, v76
    v_max3_f32 v5, v5, v77, v78
    v_max3_f32 v5, v5, v79, v80
    v_max3_f32 v5, v5, v81, v82
    v_max_f32 v5, v5, v83
    v_mov_b32 v6, v5
    s_nop 1
    v_permlane32_swap_b32 v5, v6
    v_max_f32 v5, v5, v6
    v_sub_f32 v5, 0, v5
    v_cvt_pk_bf16_f32 v5, v5, 0
    v_cndmask_b32 v44, v5, v44, s[56:57]
    ds_write_b64 v7, v[44:45] offset:8192
    v_lshlrev_b32 v6, 16, v5
    v_add_f32 v68, v6, v68
    v_add_f32 v69, v6, v69
    v_add_f32 v70, v6, v70
    v_add_f32 v71, v6, v71
    v_add_f32 v72, v6, v72
    v_add_f32 v73, v6, v73
    v_add_f32 v74, v6, v74
    v_add_f32 v75, v6, v75
    v_exp_f32 v68, v68
    v_exp_f32 v69, v69
    v_exp_f32 v70, v70
    v_exp_f32 v71, v71
    v_exp_f32 v72, v72
    v_exp_f32 v73, v73
    v_exp_f32 v74, v74
    v_exp_f32 v75, v75
    s_waitcnt vmcnt(1) lgkmcnt(0)
    s_barrier
    ds_read_b64 v[46:47], v8 offset:8192
    ds_read_b128 v[40:43], v8
    v_add_f32 v76, v6, v76
    v_add_f32 v77, v6, v77
    v_add_f32 v78, v6, v78
    v_add_f32 v79, v6, v79
    v_add_f32 v80, v6, v80
    v_add_f32 v81, v6, v81
    v_add_f32 v82, v6, v82
    v_add_f32 v83, v6, v83
    s_waitcnt vmcnt(0)
    v_cndmask_b32 v56, v26, v56, s[58:59]
    v_cndmask_b32 v57, v26, v57, s[58:59]
    v_cndmask_b32 v58, v26, v58, s[58:59]
    v_cndmask_b32 v59, v26, v59, s[58:59]
    s_waitcnt lgkmcnt(0)
    s_setprio 3
    v_mfma_f32_32x32x8_bf16 v[84:99], v[48:49], v[46:47], 0
    ds_read_b64 v[48:49], v28 offset:1024
    v_mfma_f32_32x32x16_bf16 v[84:99], v[52:55], v[40:43], v[84:99]
    ds_read_b128 v[52:55], v27 offset:0
    ds_read_b128 v[60:63], v30 offset:1280
    ds_read_b128 v[64:67], v30 offset:1920
    s_add_u32 m0, s52, 20480
    s_add_u32 s51, s51, 10240
    buffer_load_dwordx4 v4, s[20:23], s51 offen offset:0 sc1 lds
    v_smfmac_f32_32x32x32_bf16 v[116:131], v[56:59], v[68:75], v24
    buffer_load_dwordx4 v4, s[20:23], s51 offen offset:1024 sc1 lds
    v_exp_f32 v76, v76
    v_exp_f32 v77, v77
    v_exp_f32 v78, v78
    v_exp_f32 v79, v79
    v_exp_f32 v80, v80
    v_exp_f32 v81, v81
    v_exp_f32 v82, v82
    v_exp_f32 v83, v83
    s_waitcnt lgkmcnt(0)
    v_mfma_f32_32x32x8_bf16 v[100:115], v[48:49], v[44:45], 0
    v_exp_f32 v84, v84
    v_exp_f32 v85, v85
    v_exp_f32 v86, v86
    v_exp_f32 v87, v87
    s_mov_b32 exec_hi, 0
    buffer_load_dwordx4 v4, s[20:23], s51 offen offset:2048 sc1 lds
    s_mov_b32 exec_hi, -1
    v_mfma_f32_32x32x16_bf16 v[100:115], v[52:55], v[36:39], v[100:115]
    v_exp_f32 v88, v88
    v_exp_f32 v89, v89
    v_exp_f32 v90, v90
    v_exp_f32 v91, v91
    v_smfmac_f32_32x32x32_bf16 v[116:131], v[64:67], v[76:83], v24
    v_exp_f32 v92, v92
    v_exp_f32 v93, v93
    v_exp_f32 v94, v94
    v_exp_f32 v95, v95
    v_smfmac_f32_32x32x32_bf16 v[132:147], v[56:59], v[84:91], v24
    v_exp_f32 v96, v96
    v_exp_f32 v97, v97
    v_exp_f32 v98, v98
    v_exp_f32 v99, v99
    v_mfma_f32_32x32x8_bf16 v[68:83], v[48:49], v[46:47], 0
    ds_read_b64 v[48:49], v28 offset:3584
    v_exp_f32 v100, v100
    v_exp_f32 v101, v101
    v_exp_f32 v102, v102
    v_exp_f32 v103, v103
    s_add_u32 m0, s60, 0
    s_nop 0
    buffer_load_dwordx4 v22, s[28:31], 0 offen lds
    v_mfma_f32_32x32x16_bf16 v[68:83], v[52:55], v[40:43], v[68:83]
    ds_read_b128 v[52:55], v27 offset:2560
    v_exp_f32 v104, v104
    v_exp_f32 v105, v105
    ds_read_b128 v[56:59], v30 offset:3840
    v_exp_f32 v106, v106
    v_exp_f32 v107, v107
    v_smfmac_f32_32x32x32_bf16 v[132:147], v[64:67], v[92:99], v24
    ds_read_b128 v[64:67], v30 offset:4480
    v_exp_f32 v108, v108
    v_exp_f32 v109, v109
    v_exp_f32 v110, v110
    v_exp_f32 v111, v111
    v_smfmac_f32_32x32x32_bf16 v[116:131], v[60:63], v[100:107], v24
    v_exp_f32 v112, v112
    v_exp_f32 v113, v113
    v_exp_f32 v114, v114
    v_exp_f32 v115, v115
    s_waitcnt lgkmcnt(0)
    v_mfma_f32_32x32x8_bf16 v[84:99], v[48:49], v[44:45], 0
    v_exp_f32 v68, v68
    v_exp_f32 v69, v69
    v_exp_f32 v70, v70
    v_exp_f32 v71, v71
    v_mfma_f32_32x32x16_bf16 v[84:99], v[52:55], v[36:39], v[84:99]
    v_exp_f32 v72, v72
    v_exp_f32 v73, v73
    v_exp_f32 v74, v74
    v_exp_f32 v75, v75
    v_smfmac_f32_32x32x32_bf16 v[116:131], v[64:67], v[108:115], v24
    v_exp_f32 v76, v76
    v_exp_f32 v77, v77
    v_exp_f32 v78, v78
    v_exp_f32 v79, v79
    v_smfmac_f32_32x32x32_bf16 v[132:147], v[60:63], v[68:75], v24
    v_exp_f32 v80, v80
    v_exp_f32 v81, v81
    v_exp_f32 v82, v82
    v_exp_f32 v83, v83
    v_mfma_f32_32x32x8_bf16 v[100:115], v[48:49], v[46:47], 0
    ds_read_b64 v[48:49], v28 offset:6144
    v_exp_f32 v84, v84
    v_exp_f32 v85, v85
    v_exp_f32 v86, v86
    v_exp_f32 v87, v87
    s_add_u32 m0, s60, 25600
    s_nop 0
    buffer_load_dwordx4 v20, s[24:27], 0 offen lds
    v_mfma_f32_32x32x16_bf16 v[100:115], v[52:55], v[40:43], v[100:115]
    ds_read_b128 v[52:55], v27 offset:5120
    v_exp_f32 v88, v88
    v_exp_f32 v89, v89
    ds_read_b128 v[60:63], v30 offset:6400
    v_exp_f32 v90, v90
    v_exp_f32 v91, v91
    v_smfmac_f32_32x32x32_bf16 v[132:147], v[64:67], v[76:83], v24
    ds_read_b128 v[64:67], v30 offset:7040
    v_exp_f32 v92, v92
    v_exp_f32 v93, v93
    v_exp_f32 v94, v94
    v_exp_f32 v95, v95
    v_smfmac_f32_32x32x32_bf16 v[116:131], v[56:59], v[84:91], v24
    v_exp_f32 v96, v96
    v_exp_f32 v97, v97
    v_exp_f32 v98, v98
    v_exp_f32 v99, v99
    s_setprio 2
    s_waitcnt lgkmcnt(0)
    v_mfma_f32_32x32x8_bf16 v[68:83], v[48:49], v[44:45], 0
    v_exp_f32 v100, v100
    v_exp_f32 v101, v101
    v_exp_f32 v102, v102
    v_exp_f32 v103, v103
    v_mfma_f32_32x32x16_bf16 v[68:83], v[52:55], v[36:39], v[68:83]
    v_exp_f32 v104, v104
    v_exp_f32 v105, v105
    v_exp_f32 v106, v106
    v_exp_f32 v107, v107
    v_smfmac_f32_32x32x32_bf16 v[116:131], v[64:67], v[92:99], v24
    v_exp_f32 v108, v108
    v_exp_f32 v109, v109
    v_exp_f32 v110, v110
    v_exp_f32 v111, v111
    v_smfmac_f32_32x32x32_bf16 v[132:147], v[56:59], v[100:107], v24
    v_exp_f32 v112, v112
    v_exp_f32 v113, v113
    v_exp_f32 v114, v114
    v_exp_f32 v115, v115
    s_setprio 1
    v_mfma_f32_32x32x8_bf16 v[84:99], v[48:49], v[46:47], 0
    ds_read_b64 v[48:49], v28 offset:8704
    v_exp_f32 v68, v68
    v_exp_f32 v69, v69
    v_exp_f32 v70, v70
    v_exp_f32 v71, v71
    v_mfma_f32_32x32x16_bf16 v[84:99], v[52:55], v[40:43], v[84:99]
    ds_read_b128 v[52:55], v27 offset:7680
    v_exp_f32 v72, v72
    v_exp_f32 v73, v73
    ds_read_b128 v[56:59], v30 offset:8960
    v_exp_f32 v74, v74
    v_exp_f32 v75, v75
    v_smfmac_f32_32x32x32_bf16 v[132:147], v[64:67], v[108:115], v24
    ds_read_b128 v[64:67], v30 offset:9600
    v_exp_f32 v76, v76
    v_exp_f32 v77, v77
    v_exp_f32 v78, v78
    v_exp_f32 v79, v79
    v_smfmac_f32_32x32x32_bf16 v[116:131], v[60:63], v[68:75], v24
    v_exp_f32 v80, v80
    v_exp_f32 v81, v81
    v_exp_f32 v82, v82
    v_exp_f32 v83, v83
    s_setprio 0
    s_waitcnt lgkmcnt(0)
    v_mfma_f32_32x32x8_bf16 v[100:115], v[48:49], v[44:45], 0
    v_exp_f32 v84, v84
    v_exp_f32 v85, v85
    v_exp_f32 v86, v86
    v_exp_f32 v87, v87
    v_mfma_f32_32x32x16_bf16 v[100:115], v[52:55], v[36:39], v[100:115]
    v_exp_f32 v88, v88
    v_exp_f32 v89, v89
    v_exp_f32 v90, v90
    v_exp_f32 v91, v91
    v_smfmac_f32_32x32x32_bf16 v[116:131], v[64:67], v[76:83], v24
    v_exp_f32 v92, v92
    v_exp_f32 v93, v93
    v_exp_f32 v94, v94
    v_exp_f32 v95, v95
    v_smfmac_f32_32x32x32_bf16 v[132:147], v[60:63], v[84:91], v24
    v_exp_f32 v96, v96
    v_exp_f32 v97, v97
    v_exp_f32 v98, v98
    v_exp_f32 v99, v99
    s_waitcnt vmcnt(2)
    s_barrier
    s_setprio 3
    v_mfma_f32_32x32x8_bf16 v[68:83], v[48:49], v[46:47], 0
    ds_read_b64 v[48:49], v29 offset:1024
    v_exp_f32 v100, v100
    v_exp_f32 v101, v101
    v_exp_f32 v102, v102
    v_exp_f32 v103, v103
    s_add_u32 m0, s52, 0
    s_add_u32 s51, s51, 10240
    buffer_load_dwordx4 v4, s[20:23], s51 offen offset:0 sc1 lds
    v_mfma_f32_32x32x16_bf16 v[68:83], v[52:55], v[40:43], v[68:83]
    ds_read_b128 v[52:55], v27 offset:20480
    v_exp_f32 v104, v104
    v_exp_f32 v105, v105
    ds_read_b128 v[60:63], v31 offset:1280
    v_exp_f32 v106, v106
    v_exp_f32 v107, v107
    v_smfmac_f32_32x32x32_bf16 v[132:147], v[64:67], v[92:99], v24
    ds_read_b128 v[64:67], v31 offset:1920
    v_exp_f32 v108, v108
    v_exp_f32 v109, v109
    v_exp_f32 v110, v110
    v_exp_f32 v111, v111
    buffer_load_dwordx4 v4, s[20:23], s51 offen offset:1024 sc1 lds
    v_smfmac_f32_32x32x32_bf16 v[116:131], v[56:59], v[100:107], v24
    v_exp_f32 v112, v112
    v_exp_f32 v113, v113
    v_exp_f32 v114, v114
    v_exp_f32 v115, v115
    s_waitcnt lgkmcnt(0)
    v_mfma_f32_32x32x8_bf16 v[84:99], v[48:49], v[44:45], 0
    v_exp_f32 v68, v68
    v_exp_f32 v69, v69
    v_exp_f32 v70, v70
    v_exp_f32 v71, v71
    s_mov_b32 exec_hi, 0
    buffer_load_dwordx4 v4, s[20:23], s51 offen offset:2048 sc1 lds
    s_mov_b32 exec_hi, -1
    v_mfma_f32_32x32x16_bf16 v[84:99], v[52:55], v[36:39], v[84:99]
    v_exp_f32 v72, v72
    v_exp_f32 v73, v73
    v_exp_f32 v74, v74
    v_exp_f32 v75, v75
    v_smfmac_f32_32x32x32_bf16 v[116:131], v[64:67], v[108:115], v24
    v_exp_f32 v76, v76
    v_exp_f32 v77, v77
    v_exp_f32 v78, v78
    v_exp_f32 v79, v79
    s_xor_b32 s34, s49, 1
    s_lshl_b32 s34, s34, 5
    s_add_u32 s34, s34, s48
    s_lshl_b32 s67, s34, 10
    s_add_u32 s67, s67, 7864320
    buffer_store_dwordx4 v[176:179], v4, s[20:23], s67 offen sc1
    v_smfmac_f32_32x32x32_bf16 v[132:147], v[56:59], v[68:75], v24
    v_exp_f32 v80, v80
    v_exp_f32 v81, v81
    v_exp_f32 v82, v82
    v_exp_f32 v83, v83
    v_mfma_f32_32x32x8_bf16 v[100:115], v[48:49], v[46:47], 0
    ds_read_b64 v[48:49], v29 offset:3584
    v_exp_f32 v84, v84
    v_exp_f32 v85, v85
    v_exp_f32 v86, v86
    v_exp_f32 v87, v87
    global_load_dwordx2 v[10:11], v236, s[4:5] offset:0
    v_mfma_f32_32x32x16_bf16 v[100:115], v[52:55], v[40:43], v[100:115]
    ds_read_b128 v[52:55], v27 offset:23040
    v_exp_f32 v88, v88
    v_exp_f32 v89, v89
    ds_read_b128 v[56:59], v31 offset:3840
    v_exp_f32 v90, v90
    v_exp_f32 v91, v91
    v_smfmac_f32_32x32x32_bf16 v[132:147], v[64:67], v[76:83], v24
    ds_read_b128 v[64:67], v31 offset:4480
    v_exp_f32 v92, v92
    v_exp_f32 v93, v93
    v_exp_f32 v94, v94
    v_exp_f32 v95, v95
    s_lshl_b32 s68, s34, 8
    s_add_u32 s68, s68, 9961472
    s_mov_b64 exec, 0xffff
    buffer_store_dwordx4 v[176:179], v4, s[20:23], s68 offen sc1
    s_mov_b64 exec, -1
    v_smfmac_f32_32x32x32_bf16 v[116:131], v[60:63], v[84:91], v24
    v_exp_f32 v96, v96
    v_exp_f32 v97, v97
    v_exp_f32 v98, v98
    v_exp_f32 v99, v99
    s_waitcnt lgkmcnt(0)
    v_mfma_f32_32x32x8_bf16 v[68:83], v[48:49], v[44:45], 0
    v_exp_f32 v100, v100
    v_exp_f32 v101, v101
    v_exp_f32 v102, v102
    v_exp_f32 v103, v103
    global_load_dwordx2 v[12:13], v236, s[4:5] offset:32
    v_mfma_f32_32x32x16_bf16 v[68:83], v[52:55], v[36:39], v[68:83]
    v_exp_f32 v104, v104
    v_exp_f32 v105, v105
    v_exp_f32 v106, v106
    v_exp_f32 v107, v107
    v_smfmac_f32_32x32x32_bf16 v[116:131], v[64:67], v[92:99], v24
    v_exp_f32 v108, v108
    v_exp_f32 v109, v109
    v_exp_f32 v110, v110
    v_exp_f32 v111, v111
    v_smfmac_f32_32x32x32_bf16 v[132:147], v[60:63], v[100:107], v24
    v_exp_f32 v112, v112
    v_exp_f32 v113, v113
    v_exp_f32 v114, v114
    v_exp_f32 v115, v115
    v_mfma_f32_32x32x8_bf16 v[84:99], v[48:49], v[46:47], 0
    ds_read_b64 v[48:49], v29 offset:6144
    v_exp_f32 v68, v68
    v_exp_f32 v69, v69
    v_exp_f32 v70, v70
    v_exp_f32 v71, v71
    global_load_dwordx2 v[14:15], v236, s[4:5] offset:64
    v_mfma_f32_32x32x16_bf16 v[84:99], v[52:55], v[40:43], v[84:99]
    ds_read_b128 v[52:55], v27 offset:25600
    v_exp_f32 v72, v72
    v_exp_f32 v73, v73
    ds_read_b128 v[60:63], v31 offset:6400
    v_exp_f32 v74, v74
    v_exp_f32 v75, v75
    v_smfmac_f32_32x32x32_bf16 v[132:147], v[64:67], v[108:115], v24
    ds_read_b128 v[64:67], v31 offset:7040
    v_exp_f32 v76, v76
    v_exp_f32 v77, v77
    v_exp_f32 v78, v78
    v_exp_f32 v79, v79
    v_smfmac_f32_32x32x32_bf16 v[116:131], v[56:59], v[68:75], v24
    v_exp_f32 v80, v80
    v_exp_f32 v81, v81
    v_exp_f32 v82, v82
    v_exp_f32 v83, v83
    s_setprio 2
    s_waitcnt lgkmcnt(0)
    v_mfma_f32_32x32x8_bf16 v[100:115], v[48:49], v[44:45], 0
    v_exp_f32 v84, v84
    v_exp_f32 v85, v85
    v_exp_f32 v86, v86
    v_exp_f32 v87, v87
    global_load_dwordx2 v[16:17], v236, s[4:5] offset:96
    v_mfma_f32_32x32x16_bf16 v[100:115], v[52:55], v[36:39], v[100:115]
    v_exp_f32 v88, v88
    v_exp_f32 v89, v89
    v_exp_f32 v90, v90
    v_exp_f32 v91, v91
    v_smfmac_f32_32x32x32_bf16 v[116:131], v[64:67], v[76:83], v24
    v_exp_f32 v92, v92
    v_exp_f32 v93, v93
    v_exp_f32 v94, v94
    v_exp_f32 v95, v95
    v_smfmac_f32_32x32x32_bf16 v[132:147], v[56:59], v[84:91], v24
    v_exp_f32 v96, v96
    v_exp_f32 v97, v97
    v_exp_f32 v98, v98
    v_exp_f32 v99, v99
    s_setprio 1
    v_mfma_f32_32x32x8_bf16 v[68:83], v[48:49], v[46:47], 0
    ds_read_b64 v[48:49], v29 offset:8704
    v_exp_f32 v100, v100
    v_exp_f32 v101, v101
    v_exp_f32 v102, v102
    v_exp_f32 v103, v103
    global_load_dwordx2 v[18:19], v236, s[4:5] offset:128
    v_mfma_f32_32x32x16_bf16 v[68:83], v[52:55], v[40:43], v[68:83]
    ds_read_b128 v[52:55], v27 offset:28160
    v_exp_f32 v104, v104
    v_exp_f32 v105, v105
    ds_read_b128 v[56:59], v31 offset:8960
    v_exp_f32 v106, v106
    v_exp_f32 v107, v107
    v_smfmac_f32_32x32x32_bf16 v[132:147], v[64:67], v[92:99], v24
    ds_read_b128 v[64:67], v31 offset:9600
    v_exp_f32 v108, v108
    v_exp_f32 v109, v109
    v_exp_f32 v110, v110
    v_exp_f32 v111, v111
    v_smfmac_f32_32x32x32_bf16 v[116:131], v[60:63], v[100:107], v24
    v_exp_f32 v112, v112
    v_exp_f32 v113, v113
    v_exp_f32 v114, v114
    v_exp_f32 v115, v115
    s_setprio 0
    s_waitcnt lgkmcnt(0)
    v_mfma_f32_32x32x8_bf16 v[84:99], v[48:49], v[44:45], 0
    v_exp_f32 v68, v68
    v_exp_f32 v69, v69
    v_exp_f32 v70, v70
    v_exp_f32 v71, v71
    v_mfma_f32_32x32x16_bf16 v[84:99], v[52:55], v[36:39], v[84:99]
    v_exp_f32 v72, v72
    v_exp_f32 v73, v73
    v_exp_f32 v74, v74
    v_exp_f32 v75, v75
    v_smfmac_f32_32x32x32_bf16 v[116:131], v[64:67], v[108:115], v24
    v_exp_f32 v76, v76
    v_exp_f32 v77, v77
    v_exp_f32 v78, v78
    v_exp_f32 v79, v79
    v_smfmac_f32_32x32x32_bf16 v[132:147], v[60:63], v[68:75], v24
    v_exp_f32 v80, v80
    v_exp_f32 v81, v81
    v_exp_f32 v82, v82
    v_exp_f32 v83, v83
    s_waitcnt vmcnt(7)
    s_barrier
    s_setprio 3
    v_mfma_f32_32x32x8_bf16 v[100:115], v[48:49], v[46:47], 0
    ds_read_b64 v[48:49], v28 offset:1024
    v_exp_f32 v84, v84
    v_exp_f32 v85, v85
    v_exp_f32 v86, v86
    v_exp_f32 v87, v87
    s_add_u32 m0, s52, 20480
    s_add_u32 s51, s51, 10240
    buffer_load_dwordx4 v4, s[20:23], s51 offen offset:0 sc1 lds
    ds_read_b64_tr_b16 v[152:153], v21 offset:0
    ds_read_b64_tr_b16 v[154:155], v21 offset:512
    v_mfma_f32_32x32x16_bf16 v[100:115], v[52:55], v[40:43], v[100:115]
    ds_read_b128 v[52:55], v27 offset:0
    v_exp_f32 v88, v88
    v_exp_f32 v89, v89
    ds_read_b128 v[60:63], v30 offset:1280
    v_exp_f32 v90, v90
    v_exp_f32 v91, v91
    v_smfmac_f32_32x32x32_bf16 v[132:147], v[64:67], v[76:83], v24
    ds_read_b128 v[64:67], v30 offset:1920
    v_exp_f32 v92, v92
    v_exp_f32 v93, v93
    v_exp_f32 v94, v94
    v_exp_f32 v95, v95
    buffer_load_dwordx4 v4, s[20:23], s51 offen offset:1024 sc1 lds
    ds_read_b64_tr_b16 v[160:161], v21 offset:25600
    ds_read_b64_tr_b16 v[162:163], v21 offset:26112
    v_smfmac_f32_32x32x32_bf16 v[116:131], v[56:59], v[84:91], v24
    v_exp_f32 v96, v96
    v_exp_f32 v97, v97
    v_exp_f32 v98, v98
    v_exp_f32 v99, v99
    s_waitcnt lgkmcnt(0)
    v_mfma_f32_32x32x8_bf16 v[68:83], v[48:49], v[44:45], 0
    v_exp_f32 v100, v100
    v_exp_f32 v101, v101
    v_exp_f32 v102, v102
    v_exp_f32 v103, v103
    s_mov_b32 exec_hi, 0
    buffer_load_dwordx4 v4, s[20:23], s51 offen offset:2048 sc1 lds
    s_mov_b32 exec_hi, -1
    v_mfma_f32_32x32x16_bf16 v[68:83], v[52:55], v[36:39], v[68:83]
    v_exp_f32 v104, v104
    v_exp_f32 v105, v105
    v_exp_f32 v106, v106
    v_exp_f32 v107, v107
    v_smfmac_f32_32x32x32_bf16 v[116:131], v[64:67], v[92:99], v24
    v_exp_f32 v108, v108
    v_exp_f32 v109, v109
    v_exp_f32 v110, v110
    v_exp_f32 v111, v111
    buffer_store_dwordx4 v[152:155], v4, s[20:23], s40 offen sc1
    v_smfmac_f32_32x32x32_bf16 v[132:147], v[56:59], v[100:107], v24
    v_exp_f32 v112, v112
    v_exp_f32 v113, v113
    v_exp_f32 v114, v114
    v_exp_f32 v115, v115
    v_mfma_f32_32x32x8_bf16 v[84:99], v[48:49], v[46:47], 0
    ds_read_b64 v[48:49], v28 offset:3584
    v_exp_f32 v68, v68
    v_exp_f32 v69, v69
    v_exp_f32 v70, v70
    v_exp_f32 v71, v71
    buffer_store_dwordx4 v[160:163], v4, s[20:23], s43 offen sc1
    v_mfma_f32_32x32x16_bf16 v[84:99], v[52:55], v[40:43], v[84:99]
    ds_read_b128 v[52:55], v27 offset:2560
    v_exp_f32 v72, v72
    v_exp_f32 v73, v73
    ds_read_b128 v[56:59], v30 offset:3840
    v_exp_f32 v74, v74
    v_exp_f32 v75, v75
    v_smfmac_f32_32x32x32_bf16 v[132:147], v[64:67], v[108:115], v24
    ds_read_b128 v[64:67], v30 offset:4480
    v_exp_f32 v76, v76
    v_exp_f32 v77, v77
    v_exp_f32 v78, v78
    v_exp_f32 v79, v79
    v_smfmac_f32_32x32x32_bf16 v[116:131], v[60:63], v[68:75], v24
    v_exp_f32 v80, v80
    v_exp_f32 v81, v81
    v_exp_f32 v82, v82
    v_exp_f32 v83, v83
    s_waitcnt lgkmcnt(0)
    v_mfma_f32_32x32x8_bf16 v[100:115], v[48:49], v[44:45], 0
    v_exp_f32 v84, v84
    v_exp_f32 v85, v85
    v_exp_f32 v86, v86
    v_exp_f32 v87, v87
    v_mfma_f32_32x32x16_bf16 v[100:115], v[52:55], v[36:39], v[100:115]
    v_exp_f32 v88, v88
    v_exp_f32 v89, v89
    v_exp_f32 v90, v90
    v_exp_f32 v91, v91
    v_smfmac_f32_32x32x32_bf16 v[116:131], v[64:67], v[76:83], v24
    v_exp_f32 v92, v92
    v_exp_f32 v93, v93
    v_exp_f32 v94, v94
    v_exp_f32 v95, v95
    s_add_u32 m0, s55, 0
    s_add_u32 s34, s54, 0
    buffer_load_dwordx4 v4, s[20:23], s34 offen offset:0 sc1 lds
    v_smfmac_f32_32x32x32_bf16 v[132:147], v[60:63], v[84:91], v24
    v_exp_f32 v96, v96
    v_exp_f32 v97, v97
    v_exp_f32 v98, v98
    v_exp_f32 v99, v99
    v_mfma_f32_32x32x8_bf16 v[68:83], v[48:49], v[46:47], 0
    ds_read_b64 v[48:49], v28 offset:6144
    v_exp_f32 v100, v100
    v_exp_f32 v101, v101
    v_exp_f32 v102, v102
    v_exp_f32 v103, v103
    v_mfma_f32_32x32x16_bf16 v[68:83], v[52:55], v[40:43], v[68:83]
    ds_read_b128 v[52:55], v27 offset:5120
    v_exp_f32 v104, v104
    v_exp_f32 v105, v105
    ds_read_b128 v[60:63], v30 offset:6400
    v_exp_f32 v106, v106
    v_exp_f32 v107, v107
    v_smfmac_f32_32x32x32_bf16 v[132:147], v[64:67], v[92:99], v24
    ds_read_b128 v[64:67], v30 offset:7040
    v_exp_f32 v108, v108
    v_exp_f32 v109, v109
    v_exp_f32 v110, v110
    v_exp_f32 v111, v111
    buffer_load_dwordx4 v4, s[20:23], s34 offen offset:1024 sc1 lds
    v_smfmac_f32_32x32x32_bf16 v[116:131], v[56:59], v[100:107], v24
    v_exp_f32 v112, v112
    v_exp_f32 v113, v113
    v_exp_f32 v114, v114
    v_exp_f32 v115, v115
    s_setprio 2
    s_waitcnt lgkmcnt(0)
    v_mfma_f32_32x32x8_bf16 v[84:99], v[48:49], v[44:45], 0
    v_exp_f32 v68, v68
    v_exp_f32 v69, v69
    v_exp_f32 v70, v70
    v_exp_f32 v71, v71
    v_mfma_f32_32x32x16_bf16 v[84:99], v[52:55], v[36:39], v[84:99]
    v_exp_f32 v72, v72
    v_exp_f32 v73, v73
    v_exp_f32 v74, v74
    v_exp_f32 v75, v75
    v_smfmac_f32_32x32x32_bf16 v[116:131], v[64:67], v[108:115], v24
    v_exp_f32 v76, v76
    v_exp_f32 v77, v77
    v_exp_f32 v78, v78
    v_exp_f32 v79, v79
    buffer_load_dwordx4 v4, s[20:23], s34 offen offset:2048 sc1 lds
    v_smfmac_f32_32x32x32_bf16 v[132:147], v[56:59], v[68:75], v24
    v_exp_f32 v80, v80
    v_exp_f32 v81, v81
    v_exp_f32 v82, v82
    v_exp_f32 v83, v83
    s_setprio 1
    v_mfma_f32_32x32x8_bf16 v[100:115], v[48:49], v[46:47], 0
    ds_read_b64 v[48:49], v28 offset:8704
    v_exp_f32 v84, v84
    v_exp_f32 v85, v85
    v_exp_f32 v86, v86
    v_exp_f32 v87, v87
    v_mfma_f32_32x32x16_bf16 v[100:115], v[52:55], v[40:43], v[100:115]
    ds_read_b128 v[52:55], v27 offset:7680
    v_exp_f32 v88, v88
    v_exp_f32 v89, v89
    ds_read_b128 v[56:59], v30 offset:8960
    v_exp_f32 v90, v90
    v_exp_f32 v91, v91
    v_smfmac_f32_32x32x32_bf16 v[132:147], v[64:67], v[76:83], v24
    ds_read_b128 v[64:67], v30 offset:9600
    v_exp_f32 v92, v92
    v_exp_f32 v93, v93
    v_exp_f32 v94, v94
    v_exp_f32 v95, v95
    buffer_load_dwordx4 v4, s[20:23], s34 offen offset:3072 sc1 lds
    v_smfmac_f32_32x32x32_bf16 v[116:131], v[60:63], v[84:91], v24
    v_exp_f32 v96, v96
    v_exp_f32 v97, v97
    v_exp_f32 v98, v98
    v_exp_f32 v99, v99
    s_setprio 0
    s_waitcnt lgkmcnt(0)
    v_mfma_f32_32x32x8_bf16 v[68:83], v[48:49], v[44:45], 0
    v_exp_f32 v100, v100
    v_exp_f32 v101, v101
    v_exp_f32 v102, v102
    v_exp_f32 v103, v103
    v_mfma_f32_32x32x16_bf16 v[68:83], v[52:55], v[36:39], v[68:83]
    v_exp_f32 v104, v104
    v_exp_f32 v105, v105
    v_exp_f32 v106, v106
    v_exp_f32 v107, v107
    v_smfmac_f32_32x32x32_bf16 v[116:131], v[64:67], v[92:99], v24
    v_exp_f32 v108, v108
    v_exp_f32 v109, v109
    v_exp_f32 v110, v110
    v_exp_f32 v111, v111
    v_smfmac_f32_32x32x32_bf16 v[132:147], v[60:63], v[100:107], v24
    v_exp_f32 v112, v112
    v_exp_f32 v113, v113
    v_exp_f32 v114, v114
    v_exp_f32 v115, v115
    s_waitcnt vmcnt(4)
    s_barrier
    s_setprio 3
    v_mfma_f32_32x32x8_bf16 v[84:99], v[48:49], v[46:47], 0
    ds_read_b64 v[48:49], v29 offset:1024
    v_exp_f32 v68, v68
    v_exp_f32 v69, v69
    v_exp_f32 v70, v70
    v_exp_f32 v71, v71
    s_add_u32 m0, s52, 0
    s_add_u32 s51, s51, 10240
    buffer_load_dwordx4 v4, s[20:23], s51 offen offset:0 sc1 lds
    v_mfma_f32_32x32x16_bf16 v[84:99], v[52:55], v[40:43], v[84:99]
    ds_read_b128 v[52:55], v27 offset:20480
    v_exp_f32 v72, v72
    v_exp_f32 v73, v73
    ds_read_b128 v[60:63], v31 offset:1280
    v_exp_f32 v74, v74
    v_exp_f32 v75, v75
    v_smfmac_f32_32x32x32_bf16 v[132:147], v[64:67], v[108:115], v24
    ds_read_b128 v[64:67], v31 offset:1920
    v_exp_f32 v76, v76
    v_exp_f32 v77, v77
    v_exp_f32 v78, v78
    v_exp_f32 v79, v79
    buffer_load_dwordx4 v4, s[20:23], s51 offen offset:1024 sc1 lds
    v_smfmac_f32_32x32x32_bf16 v[116:131], v[56:59], v[68:75], v24
    v_exp_f32 v80, v80
    v_exp_f32 v81, v81
    v_exp_f32 v82, v82
    v_exp_f32 v83, v83
    s_waitcnt lgkmcnt(0)
    v_mfma_f32_32x32x8_bf16 v[100:115], v[48:49], v[44:45], 0
    v_exp_f32 v84, v84
    v_exp_f32 v85, v85
    v_exp_f32 v86, v86
    v_exp_f32 v87, v87
    s_mov_b32 exec_hi, 0
    buffer_load_dwordx4 v4, s[20:23], s51 offen offset:2048 sc1 lds
    s_mov_b32 exec_hi, -1
    v_mfma_f32_32x32x16_bf16 v[100:115], v[52:55], v[36:39], v[100:115]
    v_exp_f32 v88, v88
    v_exp_f32 v89, v89
    v_exp_f32 v90, v90
    v_exp_f32 v91, v91
    v_smfmac_f32_32x32x32_bf16 v[116:131], v[64:67], v[76:83], v24
    v_exp_f32 v92, v92
    v_exp_f32 v93, v93
    v_exp_f32 v94, v94
    v_exp_f32 v95, v95
    buffer_store_dword v233, v232, s[20:23], 0 offen sc1
    v_smfmac_f32_32x32x32_bf16 v[132:147], v[56:59], v[84:91], v24
    v_exp_f32 v96, v96
    v_exp_f32 v97, v97
    v_exp_f32 v98, v98
    v_exp_f32 v99, v99
    s_branch Lpg5s
    s_nop 0
Lpg5:
    s_setpc_b64 s[38:39]
Lpg5s:
    v_mfma_f32_32x32x8_bf16 v[68:83], v[48:49], v[46:47], 0
    ds_read_b64 v[48:49], v29 offset:3584
    v_exp_f32 v100, v100
    v_exp_f32 v101, v101
    v_exp_f32 v102, v102
    v_exp_f32 v103, v103
    s_add_u32 m0, s55, 4096
    s_add_u32 s34, s54, 4096
    buffer_load_dwordx4 v4, s[20:23], s34 offen offset:0 sc1 lds
    v_mfma_f32_32x32x16_bf16 v[68:83], v[52:55], v[40:43], v[68:83]
    ds_read_b128 v[52:55], v27 offset:23040
    v_exp_f32 v104, v104
    v_exp_f32 v105, v105
    ds_read_b128 v[56:59], v31 offset:3840
    v_exp_f32 v106, v106
    v_exp_f32 v107, v107
    v_smfmac_f32_32x32x32_bf16 v[132:147], v[64:67], v[92:99], v24
    ds_read_b128 v[64:67], v31 offset:4480
    v_exp_f32 v108, v108
    v_exp_f32 v109, v109
    v_exp_f32 v110, v110
    v_exp_f32 v111, v111
    buffer_load_dwordx4 v4, s[20:23], s34 offen offset:1024 sc1 lds
    v_smfmac_f32_32x32x32_bf16 v[116:131], v[60:63], v[100:107], v24
    v_exp_f32 v112, v112
    v_exp_f32 v113, v113
    v_exp_f32 v114, v114
    v_exp_f32 v115, v115
    s_waitcnt lgkmcnt(0)
    v_mfma_f32_32x32x8_bf16 v[84:99], v[48:49], v[44:45], 0
    v_exp_f32 v68, v68
    v_exp_f32 v69, v69
    v_exp_f32 v70, v70
    v_exp_f32 v71, v71
    v_mfma_f32_32x32x16_bf16 v[84:99], v[52:55], v[36:39], v[84:99]
    v_exp_f32 v72, v72
    v_exp_f32 v73, v73
    v_exp_f32 v74, v74
    v_exp_f32 v75, v75
    v_smfmac_f32_32x32x32_bf16 v[116:131], v[64:67], v[108:115], v24
    v_exp_f32 v76, v76
    v_exp_f32 v77, v77
    v_exp_f32 v78, v78
    v_exp_f32 v79, v79
    buffer_load_dwordx4 v4, s[20:23], s34 offen offset:2048 sc1 lds
    v_smfmac_f32_32x32x32_bf16 v[132:147], v[60:63], v[68:75], v24
    v_exp_f32 v80, v80
    v_exp_f32 v81, v81
    v_exp_f32 v82, v82
    v_exp_f32 v83, v83
    v_mfma_f32_32x32x8_bf16 v[100:115], v[48:49], v[46:47], 0
    ds_read_b64 v[48:49], v29 offset:6144
    v_exp_f32 v84, v84
    v_exp_f32 v85, v85
    v_exp_f32 v86, v86
    v_exp_f32 v87, v87
    buffer_load_dwordx4 v4, s[20:23], s34 offen offset:3072 sc1 lds
    v_mfma_f32_32x32x16_bf16 v[100:115], v[52:55], v[40:43], v[100:115]
    ds_read_b128 v[52:55], v27 offset:25600
    v_exp_f32 v88, v88
    v_exp_f32 v89, v89
    ds_read_b128 v[60:63], v31 offset:6400
    v_exp_f32 v90, v90
    v_exp_f32 v91, v91
    v_smfmac_f32_32x32x32_bf16 v[132:147], v[64:67], v[76:83], v24
    ds_read_b128 v[64:67], v31 offset:7040
    v_exp_f32 v92, v92
    v_exp_f32 v93, v93
    v_exp_f32 v94, v94
    v_exp_f32 v95, v95
    v_smfmac_f32_32x32x32_bf16 v[116:131], v[56:59], v[84:91], v24
    v_exp_f32 v96, v96
    v_exp_f32 v97, v97
    v_exp_f32 v98, v98
    v_exp_f32 v99, v99
    s_setprio 2
    s_waitcnt lgkmcnt(0)
    v_mfma_f32_32x32x8_bf16 v[68:83], v[48:49], v[44:45], 0
    v_exp_f32 v100, v100
    v_exp_f32 v101, v101
    v_exp_f32 v102, v102
    v_exp_f32 v103, v103
    s_add_u32 m0, s55, 8192
    s_add_u32 s34, s54, 8192
    buffer_load_dwordx4 v4, s[20:23], s34 offen offset:0 sc1 lds
    v_mfma_f32_32x32x16_bf16 v[68:83], v[52:55], v[36:39], v[68:83]
    v_exp_f32 v104, v104
    v_exp_f32 v105, v105
    v_exp_f32 v106, v106
    v_exp_f32 v107, v107
    v_smfmac_f32_32x32x32_bf16 v[116:131], v[64:67], v[92:99], v24
    v_exp_f32 v108, v108
    v_exp_f32 v109, v109
    v_exp_f32 v110, v110
    v_exp_f32 v111, v111
    buffer_load_dwordx4 v4, s[20:23], s34 offen offset:1024 sc1 lds
    v_smfmac_f32_32x32x32_bf16 v[132:147], v[56:59], v[100:107], v24
    v_exp_f32 v112, v112
    v_exp_f32 v113, v113
    v_exp_f32 v114, v114
    v_exp_f32 v115, v115
    s_setprio 1
    v_mfma_f32_32x32x8_bf16 v[84:99], v[48:49], v[46:47], 0
    ds_read_b64 v[48:49], v29 offset:8704
    v_exp_f32 v68, v68
    v_exp_f32 v69, v69
    v_exp_f32 v70, v70
    v_exp_f32 v71, v71
    v_mfma_f32_32x32x16_bf16 v[84:99], v[52:55], v[40:43], v[84:99]
    ds_read_b128 v[52:55], v27 offset:28160
    v_exp_f32 v72, v72
    v_exp_f32 v73, v73
    ds_read_b128 v[56:59], v31 offset:8960
    v_exp_f32 v74, v74
    v_exp_f32 v75, v75
    v_smfmac_f32_32x32x32_bf16 v[132:147], v[64:67], v[108:115], v24
    ds_read_b128 v[64:67], v31 offset:9600
    v_exp_f32 v76, v76
    v_exp_f32 v77, v77
    v_exp_f32 v78, v78
    v_exp_f32 v79, v79
    buffer_load_dwordx4 v4, s[20:23], s34 offen offset:2048 sc1 lds
    v_smfmac_f32_32x32x32_bf16 v[116:131], v[60:63], v[68:75], v24
    v_exp_f32 v80, v80
    v_exp_f32 v81, v81
    v_exp_f32 v82, v82
    v_exp_f32 v83, v83
    s_setprio 0
    s_waitcnt lgkmcnt(0)
    v_mfma_f32_32x32x8_bf16 v[100:115], v[48:49], v[44:45], 0
    v_exp_f32 v84, v84
    v_exp_f32 v85, v85
    v_exp_f32 v86, v86
    v_exp_f32 v87, v87
    buffer_load_dwordx4 v4, s[20:23], s34 offen offset:3072 sc1 lds
    v_mfma_f32_32x32x16_bf16 v[100:115], v[52:55], v[36:39], v[100:115]
    v_exp_f32 v88, v88
    v_exp_f32 v89, v89
    v_exp_f32 v90, v90
    v_exp_f32 v91, v91
    v_smfmac_f32_32x32x32_bf16 v[116:131], v[64:67], v[76:83], v24
    v_exp_f32 v92, v92
    v_exp_f32 v93, v93
    v_exp_f32 v94, v94
    v_exp_f32 v95, v95
    v_smfmac_f32_32x32x32_bf16 v[132:147], v[60:63], v[84:91], v24
    v_exp_f32 v96, v96
    v_exp_f32 v97, v97
    v_exp_f32 v98, v98
    v_exp_f32 v99, v99
    s_waitcnt vmcnt(9)
    s_barrier
    s_setprio 3
    v_mfma_f32_32x32x8_bf16 v[68:83], v[48:49], v[46:47], 0
    ds_read_b64 v[48:49], v28 offset:1024
    v_exp_f32 v100, v100
    v_exp_f32 v101, v101
    v_exp_f32 v102, v102
    v_exp_f32 v103, v103
    s_add_u32 m0, s52, 20480
    s_add_u32 s51, s51, 10240
    buffer_load_dwordx4 v4, s[20:23], s51 offen offset:0 sc1 lds
    v_mfma_f32_32x32x16_bf16 v[68:83], v[52:55], v[40:43], v[68:83]
    ds_read_b128 v[52:55], v27 offset:0
    v_exp_f32 v104, v104
    v_exp_f32 v105, v105
    ds_read_b128 v[60:63], v30 offset:1280
    v_exp_f32 v106, v106
    v_exp_f32 v107, v107
    v_smfmac_f32_32x32x32_bf16 v[132:147], v[64:67], v[92:99], v24
    ds_read_b128 v[64:67], v30 offset:1920
    v_exp_f32 v108, v108
    v_exp_f32 v109, v109
    v_exp_f32 v110, v110
    v_exp_f32 v111, v111
    buffer_load_dwordx4 v4, s[20:23], s51 offen offset:1024 sc1 lds
    v_smfmac_f32_32x32x32_bf16 v[116:131], v[56:59], v[100:107], v24
    v_exp_f32 v112, v112
    v_exp_f32 v113, v113
    v_exp_f32 v114, v114
    v_exp_f32 v115, v115
    s_waitcnt lgkmcnt(0)
    v_mfma_f32_32x32x8_bf16 v[84:99], v[48:49], v[44:45], 0
    v_exp_f32 v68, v68
    v_exp_f32 v69, v69
    v_exp_f32 v70, v70
    v_exp_f32 v71, v71
    s_mov_b32 exec_hi, 0
    buffer_load_dwordx4 v4, s[20:23], s51 offen offset:2048 sc1 lds
    s_mov_b32 exec_hi, -1
    v_mfma_f32_32x32x16_bf16 v[84:99], v[52:55], v[36:39], v[84:99]
    v_exp_f32 v72, v72
    v_exp_f32 v73, v73
    v_exp_f32 v74, v74
    v_exp_f32 v75, v75
    v_smfmac_f32_32x32x32_bf16 v[116:131], v[64:67], v[108:115], v24
    v_exp_f32 v76, v76
    v_exp_f32 v77, v77
    v_exp_f32 v78, v78
    v_exp_f32 v79, v79
    s_add_u32 m0, s55, 11776
    s_add_u32 s34, s54, 11776
    buffer_load_dwordx4 v4, s[20:23], s34 offen offset:0 sc1 lds
    v_smfmac_f32_32x32x32_bf16 v[132:147], v[56:59], v[68:75], v24
    v_exp_f32 v80, v80
    v_exp_f32 v81, v81
    v_exp_f32 v82, v82
    v_exp_f32 v83, v83
    v_mfma_f32_32x32x8_bf16 v[100:115], v[48:49], v[46:47], 0
    ds_read_b64 v[48:49], v28 offset:3584
    v_exp_f32 v84, v84
    v_exp_f32 v85, v85
    v_exp_f32 v86, v86
    v_exp_f32 v87, v87
    v_mfma_f32_32x32x16_bf16 v[100:115], v[52:55], v[40:43], v[100:115]
    ds_read_b128 v[52:55], v27 offset:2560
    v_exp_f32 v88, v88
    v_exp_f32 v89, v89
    ds_read_b128 v[56:59], v30 offset:3840
    v_exp_f32 v90, v90
    v_exp_f32 v91, v91
    v_smfmac_f32_32x32x32_bf16 v[132:147], v[64:67], v[76:83], v24
    ds_read_b128 v[64:67], v30 offset:4480
    v_exp_f32 v92, v92
    v_exp_f32 v93, v93
    v_exp_f32 v94, v94
    v_exp_f32 v95, v95
    buffer_load_dword v235, v234, s[20:23], 0 offen sc1
    v_smfmac_f32_32x32x32_bf16 v[116:131], v[60:63], v[84:91], v24
    v_exp_f32 v96, v96
    v_exp_f32 v97, v97
    v_exp_f32 v98, v98
    v_exp_f32 v99, v99
    s_waitcnt lgkmcnt(0)
    v_mfma_f32_32x32x8_bf16 v[68:83], v[48:49], v[44:45], 0
    v_exp_f32 v100, v100
    v_exp_f32 v101, v101
    v_exp_f32 v102, v102
    v_exp_f32 v103, v103
    v_mfma_f32_32x32x16_bf16 v[68:83], v[52:55], v[36:39], v[68:83]
    v_exp_f32 v104, v104
    v_exp_f32 v105, v105
    v_exp_f32 v106, v106
    v_exp_f32 v107, v107
    v_smfmac_f32_32x32x32_bf16 v[116:131], v[64:67], v[92:99], v24
    v_exp_f32 v108, v108
    v_exp_f32 v109, v109
    v_exp_f32 v110, v110
    v_exp_f32 v111, v111
    v_smfmac_f32_32x32x32_bf16 v[132:147], v[60:63], v[100:107], v24
    v_exp_f32 v112, v112
    v_exp_f32 v113, v113
    v_exp_f32 v114, v114
    v_exp_f32 v115, v115
    v_mfma_f32_32x32x8_bf16 v[84:99], v[48:49], v[46:47], 0
    ds_read_b64 v[48:49], v28 offset:6144
    v_exp_f32 v68, v68
    v_exp_f32 v69, v69
    v_exp_f32 v70, v70
    v_exp_f32 v71, v71
    v_mfma_f32_32x32x16_bf16 v[84:99], v[52:55], v[40:43], v[84:99]
    ds_read_b128 v[52:55], v27 offset:5120
    v_exp_f32 v72, v72
    v_exp_f32 v73, v73
    ds_read_b128 v[60:63], v30 offset:6400
    v_exp_f32 v74, v74
    v_exp_f32 v75, v75
    v_smfmac_f32_32x32x32_bf16 v[132:147], v[64:67], v[108:115], v24
    ds_read_b128 v[64:67], v30 offset:7040
    v_exp_f32 v76, v76
    v_exp_f32 v77, v77
    v_exp_f32 v78, v78
    v_exp_f32 v79, v79
    v_smfmac_f32_32x32x32_bf16 v[116:131], v[56:59], v[68:75], v24
    v_exp_f32 v80, v80
    v_exp_f32 v81, v81
    v_exp_f32 v82, v82
    v_exp_f32 v83, v83
    s_setprio 2
    s_waitcnt lgkmcnt(0)
    v_mfma_f32_32x32x8_bf16 v[100:115], v[48:49], v[44:45], 0
    v_exp_f32 v84, v84
    v_exp_f32 v85, v85
    v_exp_f32 v86, v86
    v_exp_f32 v87, v87
    v_mfma_f32_32x32x16_bf16 v[100:115], v[52:55], v[36:39], v[100:115]
    v_exp_f32 v88, v88
    v_exp_f32 v89, v89
    v_exp_f32 v90, v90
    v_exp_f32 v91, v91
    v_smfmac_f32_32x32x32_bf16 v[116:131], v[64:67], v[76:83], v24
    v_exp_f32 v92, v92
    v_exp_f32 v93, v93
    v_exp_f32 v94, v94
    v_exp_f32 v95, v95
    v_smfmac_f32_32x32x32_bf16 v[132:147], v[56:59], v[84:91], v24
    v_exp_f32 v96, v96
    v_exp_f32 v97, v97
    v_exp_f32 v98, v98
    v_exp_f32 v99, v99
    s_setprio 1
    v_mfma_f32_32x32x8_bf16 v[68:83], v[48:49], v[46:47], 0
    ds_read_b64 v[48:49], v28 offset:8704
    v_exp_f32 v100, v100
    v_exp_f32 v101, v101
    v_exp_f32 v102, v102
    v_exp_f32 v103, v103
    v_mfma_f32_32x32x16_bf16 v[68:83], v[52:55], v[40:43], v[68:83]
    ds_read_b128 v[52:55], v27 offset:7680
    v_exp_f32 v104, v104
    v_exp_f32 v105, v105
    ds_read_b128 v[56:59], v30 offset:8960
    v_exp_f32 v106, v106
    v_exp_f32 v107, v107
    v_smfmac_f32_32x32x32_bf16 v[132:147], v[64:67], v[92:99], v24
    ds_read_b128 v[64:67], v30 offset:9600
    v_exp_f32 v108, v108
    v_exp_f32 v109, v109
    v_exp_f32 v110, v110
    v_exp_f32 v111, v111
    v_smfmac_f32_32x32x32_bf16 v[116:131], v[60:63], v[100:107], v24
    v_exp_f32 v112, v112
    v_exp_f32 v113, v113
    v_exp_f32 v114, v114
    v_exp_f32 v115, v115
    s_setprio 0
    s_waitcnt lgkmcnt(0)
    v_mfma_f32_32x32x8_bf16 v[84:99], v[48:49], v[44:45], 0
    v_exp_f32 v68, v68
    v_exp_f32 v69, v69
    v_exp_f32 v70, v70
    v_exp_f32 v71, v71
    s_waitcnt vmcnt(0)
    v_cmp_le_u32 vcc, 0x200, v235
    s_cmp_eq_u64 vcc, -1
    s_cbranch_scc0 Lp2_rwait
Lp2_rok:
    v_and_b32 v235, 15, v235
    v_cmp_ne_u32 vcc, s3, v235
    s_or_b32 s34, vcc_lo, vcc_hi
    s_and_b32 s34, s34, s64
    s_cbranch_scc1 Lp2_nofast
Lp2_fok:
    v_mfma_f32_32x32x16_bf16 v[84:99], v[52:55], v[36:39], v[84:99]
    v_exp_f32 v72, v72
    v_exp_f32 v73, v73
    v_exp_f32 v74, v74
    v_exp_f32 v75, v75
    v_smfmac_f32_32x32x32_bf16 v[116:131], v[64:67], v[108:115], v24
    v_exp_f32 v76, v76
    v_exp_f32 v77, v77
    v_exp_f32 v78, v78
    v_exp_f32 v79, v79
    v_smfmac_f32_32x32x32_bf16 v[132:147], v[60:63], v[68:75], v24
    v_exp_f32 v80, v80
    v_exp_f32 v81, v81
    v_exp_f32 v82, v82
    v_exp_f32 v83, v83
    s_waitcnt vmcnt(0)
    s_barrier
    s_setprio 3
    v_mfma_f32_32x32x8_bf16 v[100:115], v[48:49], v[46:47], 0
    ds_read_b64 v[48:49], v29 offset:1024
    v_exp_f32 v84, v84
    v_exp_f32 v85, v85
    v_exp_f32 v86, v86
    v_exp_f32 v87, v87
    s_add_u32 m0, s52, 0
    s_add_u32 s51, s51, 10240
    buffer_load_dwordx4 v4, s[20:23], s51 offen offset:0 sc1 lds
    v_mfma_f32_32x32x16_bf16 v[100:115], v[52:55], v[40:43], v[100:115]
    ds_read_b128 v[52:55], v27 offset:20480
    v_exp_f32 v88, v88
    v_exp_f32 v89, v89
    ds_read_b128 v[60:63], v31 offset:1280
    v_exp_f32 v90, v90
    v_exp_f32 v91, v91
    v_smfmac_f32_32x32x32_bf16 v[132:147], v[64:67], v[76:83], v24
    ds_read_b128 v[64:67], v31 offset:1920
    v_exp_f32 v92, v92
    v_exp_f32 v93, v93
    v_exp_f32 v94, v94
    v_exp_f32 v95, v95
    buffer_load_dwordx4 v4, s[20:23], s51 offen offset:1024 sc1 lds
    v_smfmac_f32_32x32x32_bf16 v[116:131], v[56:59], v[84:91], v24
    v_exp_f32 v96, v96
    v_exp_f32 v97, v97
    v_exp_f32 v98, v98
    v_exp_f32 v99, v99
    s_waitcnt lgkmcnt(0)
    v_mfma_f32_32x32x8_bf16 v[68:83], v[48:49], v[44:45], 0
    v_exp_f32 v100, v100
    v_exp_f32 v101, v101
    v_exp_f32 v102, v102
    v_exp_f32 v103, v103
    s_mov_b32 exec_hi, 0
    buffer_load_dwordx4 v4, s[20:23], s51 offen offset:2048 sc1 lds
    s_mov_b32 exec_hi, -1
    v_mfma_f32_32x32x16_bf16 v[68:83], v[52:55], v[36:39], v[68:83]
    v_exp_f32 v104, v104
    v_exp_f32 v105, v105
    v_exp_f32 v106, v106
    v_exp_f32 v107, v107
    v_smfmac_f32_32x32x32_bf16 v[116:131], v[64:67], v[92:99], v24
    v_exp_f32 v108, v108
    v_exp_f32 v109, v109
    v_exp_f32 v110, v110
    v_exp_f32 v111, v111
    buffer_load_dwordx4 v[152:155], v4, s[20:23], s65 offen sc1
    s_add_u32 s65, s65, 4096
    v_smfmac_f32_32x32x32_bf16 v[132:147], v[56:59], v[100:107], v24
    v_exp_f32 v112, v112
    v_exp_f32 v113, v113
    v_exp_f32 v114, v114
    v_exp_f32 v115, v115
    v_mfma_f32_32x32x8_bf16 v[84:99], v[48:49], v[46:47], 0
    ds_read_b64 v[48:49], v29 offset:3584
    v_exp_f32 v68, v68
    v_exp_f32 v69, v69
    v_exp_f32 v70, v70
    v_exp_f32 v71, v71
    buffer_load_dwordx4 v[156:159], v4, s[20:23], s65 offen sc1
    s_add_u32 s65, s65, 4096
    v_mfma_f32_32x32x16_bf16 v[84:99], v[52:55], v[40:43], v[84:99]
    ds_read_b128 v[52:55], v27 offset:23040
    v_exp_f32 v72, v72
    v_exp_f32 v73, v73
    ds_read_b128 v[56:59], v31 offset:3840
    v_exp_f32 v74, v74
    v_exp_f32 v75, v75
    v_smfmac_f32_32x32x32_bf16 v[132:147], v[64:67], v[108:115], v24
    ds_read_b128 v[64:67], v31 offset:4480
    v_exp_f32 v76, v76
    v_exp_f32 v77, v77
    v_exp_f32 v78, v78
    v_exp_f32 v79, v79
    buffer_load_dwordx4 v[160:163], v4, s[20:23], s65 offen sc1
    s_add_u32 s65, s65, 4096
    v_smfmac_f32_32x32x32_bf16 v[116:131], v[60:63], v[68:75], v24
    v_exp_f32 v80, v80
    v_exp_f32 v81, v81
    v_exp_f32 v82, v82
    v_exp_f32 v83, v83
    s_waitcnt lgkmcnt(0)
    v_mfma_f32_32x32x8_bf16 v[100:115], v[48:49], v[44:45], 0
    v_exp_f32 v84, v84
    v_exp_f32 v85, v85
    v_exp_f32 v86, v86
    v_exp_f32 v87, v87
    v_mfma_f32_32x32x16_bf16 v[100:115], v[52:55], v[36:39], v[100:115]
    v_exp_f32 v88, v88
    v_exp_f32 v89, v89
    v_exp_f32 v90, v90
    v_exp_f32 v91, v91
    v_smfmac_f32_32x32x32_bf16 v[116:131], v[64:67], v[76:83], v24
    v_exp_f32 v92, v92
    v_exp_f32 v93, v93
    v_exp_f32 v94, v94
    v_exp_f32 v95, v95
    buffer_load_dwordx4 v[164:167], v4, s[20:23], s65 offen sc1
    s_add_u32 s65, s65, 4096
    v_smfmac_f32_32x32x32_bf16 v[132:147], v[60:63], v[84:91], v24
    v_exp_f32 v96, v96
    v_exp_f32 v97, v97
    v_exp_f32 v98, v98
    v_exp_f32 v99, v99
    v_mfma_f32_32x32x8_bf16 v[68:83], v[48:49], v[46:47], 0
    ds_read_b64 v[48:49], v29 offset:6144
    v_exp_f32 v100, v100
    v_exp_f32 v101, v101
    v_exp_f32 v102, v102
    v_exp_f32 v103, v103
    buffer_load_dwordx4 v[168:171], v4, s[20:23], s65 offen sc1
    s_add_u32 s65, s65, 4096
    v_mfma_f32_32x32x16_bf16 v[68:83], v[52:55], v[40:43], v[68:83]
    ds_read_b128 v[52:55], v27 offset:25600
    v_exp_f32 v104, v104
    v_exp_f32 v105, v105
    ds_read_b128 v[60:63], v31 offset:6400
    v_exp_f32 v106, v106
    v_exp_f32 v107, v107
    v_smfmac_f32_32x32x32_bf16 v[132:147], v[64:67], v[92:99], v24
    ds_read_b128 v[64:67], v31 offset:7040
    v_exp_f32 v108, v108
    v_exp_f32 v109, v109
    v_exp_f32 v110, v110
    v_exp_f32 v111, v111
    v_smfmac_f32_32x32x32_bf16 v[116:131], v[56:59], v[100:107], v24
    v_exp_f32 v112, v112
    v_exp_f32 v113, v113
    v_exp_f32 v114, v114
    v_exp_f32 v115, v115
    s_setprio 2
    s_waitcnt lgkmcnt(0)
    v_mfma_f32_32x32x8_bf16 v[84:99], v[48:49], v[44:45], 0
    v_exp_f32 v68, v68
    v_exp_f32 v69, v69
    v_exp_f32 v70, v70
    v_exp_f32 v71, v71
    buffer_load_dwordx4 v[172:175], v4, s[20:23], s65 offen sc1
    s_add_u32 s65, s65, 4096
    v_mfma_f32_32x32x16_bf16 v[84:99], v[52:55], v[36:39], v[84:99]
    v_exp_f32 v72, v72
    v_exp_f32 v73, v73
    v_exp_f32 v74, v74
    v_exp_f32 v75, v75
    v_smfmac_f32_32x32x32_bf16 v[116:131], v[64:67], v[108:115], v24
    v_exp_f32 v76, v76
    v_exp_f32 v77, v77
    v_exp_f32 v78, v78
    v_exp_f32 v79, v79
    buffer_load_dwordx4 v[176:179], v4, s[20:23], s65 offen sc1
    s_add_u32 s65, s65, 4096
    v_smfmac_f32_32x32x32_bf16 v[132:147], v[56:59], v[68:75], v24
    v_exp_f32 v80, v80
    v_exp_f32 v81, v81
    v_exp_f32 v82, v82
    v_exp_f32 v83, v83
    s_setprio 1
    v_mfma_f32_32x32x8_bf16 v[100:115], v[48:49], v[46:47], 0
    ds_read_b64 v[48:49], v29 offset:8704
    v_exp_f32 v84, v84
    v_exp_f32 v85, v85
    v_exp_f32 v86, v86
    v_exp_f32 v87, v87
    buffer_load_dwordx4 v[180:183], v4, s[20:23], s65 offen sc1
    s_add_u32 s65, s65, 4096
    v_mfma_f32_32x32x16_bf16 v[100:115], v[52:55], v[40:43], v[100:115]
    ds_read_b128 v[52:55], v27 offset:28160
    v_exp_f32 v88, v88
    v_exp_f32 v89, v89
    ds_read_b128 v[56:59], v31 offset:8960
    v_exp_f32 v90, v90
    v_exp_f32 v91, v91
    v_smfmac_f32_32x32x32_bf16 v[132:147], v[64:67], v[76:83], v24
    ds_read_b128 v[64:67], v31 offset:9600
    v_exp_f32 v92, v92
    v_exp_f32 v93, v93
    v_exp_f32 v94, v94
    v_exp_f32 v95, v95
    v_smfmac_f32_32x32x32_bf16 v[116:131], v[60:63], v[84:91], v24
    v_exp_f32 v96, v96
    v_exp_f32 v97, v97
    v_exp_f32 v98, v98
    v_exp_f32 v99, v99
    s_setprio 0
    s_waitcnt lgkmcnt(0)
    v_mfma_f32_32x32x8_bf16 v[68:83], v[48:49], v[44:45], 0
    v_exp_f32 v100, v100
    v_exp_f32 v101, v101
    v_exp_f32 v102, v102
    v_exp_f32 v103, v103
    buffer_load_dwordx4 v[184:187], v4, s[20:23], s65 offen sc1
    s_add_u32 s65, s65, 4096
    v_mfma_f32_32x32x16_bf16 v[68:83], v[52:55], v[36:39], v[68:83]
    v_exp_f32 v104, v104
    v_exp_f32 v105, v105
    v_exp_f32 v106, v106
    v_exp_f32 v107, v107
    v_smfmac_f32_32x32x32_bf16 v[116:131], v[64:67], v[92:99], v24
    v_exp_f32 v108, v108
    v_exp_f32 v109, v109
    v_exp_f32 v110, v110
    v_exp_f32 v111, v111
    buffer_load_dwordx4 v[188:191], v4, s[20:23], s65 offen sc1
    v_smfmac_f32_32x32x32_bf16 v[132:147], v[60:63], v[100:107], v24
    v_exp_f32 v112, v112
    v_exp_f32 v113, v113
    v_exp_f32 v114, v114
    v_exp_f32 v115, v115
    s_waitcnt vmcnt(10)
    s_barrier
    s_setprio 3
    v_mfma_f32_32x32x8_bf16 v[84:99], v[48:49], v[46:47], 0
    ds_read_b64 v[48:49], v28 offset:1024
    v_exp_f32 v68, v68
    v_exp_f32 v69, v69
    v_exp_f32 v70, v70
    v_exp_f32 v71, v71
    s_add_u32 m0, s52, 20480
    s_add_u32 s51, s51, 10240
    buffer_load_dwordx4 v4, s[20:23], s51 offen offset:0 sc1 lds
    v_mfma_f32_32x32x16_bf16 v[84:99], v[52:55], v[40:43], v[84:99]
    ds_read_b128 v[52:55], v27 offset:0
    v_exp_f32 v72, v72
    v_exp_f32 v73, v73
    ds_read_b128 v[60:63], v30 offset:1280
    v_exp_f32 v74, v74
    v_exp_f32 v75, v75
    v_smfmac_f32_32x32x32_bf16 v[132:147], v[64:67], v[108:115], v24
    ds_read_b128 v[64:67], v30 offset:1920
    v_exp_f32 v76, v76
    v_exp_f32 v77, v77
    v_exp_f32 v78, v78
    v_exp_f32 v79, v79
    buffer_load_dwordx4 v4, s[20:23], s51 offen offset:1024 sc1 lds
    v_smfmac_f32_32x32x32_bf16 v[116:131], v[56:59], v[68:75], v24
    v_exp_f32 v80, v80
    v_exp_f32 v81, v81
    v_exp_f32 v82, v82
    v_exp_f32 v83, v83
    s_waitcnt lgkmcnt(0)
    v_mfma_f32_32x32x8_bf16 v[100:115], v[48:49], v[44:45], 0
    v_exp_f32 v84, v84
    v_exp_f32 v85, v85
    v_exp_f32 v86, v86
    v_exp_f32 v87, v87
    s_mov_b32 exec_hi, 0
    buffer_load_dwordx4 v4, s[20:23], s51 offen offset:2048 sc1 lds
    s_mov_b32 exec_hi, -1
    v_mfma_f32_32x32x16_bf16 v[100:115], v[52:55], v[36:39], v[100:115]
    v_exp_f32 v88, v88
    v_exp_f32 v89, v89
    v_exp_f32 v90, v90
    v_exp_f32 v91, v91
    v_smfmac_f32_32x32x32_bf16 v[116:131], v[64:67], v[76:83], v24
    v_exp_f32 v92, v92
    v_exp_f32 v93, v93
    v_exp_f32 v94, v94
    v_exp_f32 v95, v95
    v_smfmac_f32_32x32x32_bf16 v[132:147], v[56:59], v[84:91], v24
    v_exp_f32 v96, v96
    v_exp_f32 v97, v97
    v_exp_f32 v98, v98
    v_exp_f32 v99, v99
    v_mfma_f32_32x32x8_bf16 v[68:83], v[48:49], v[46:47], 0
    ds_read_b64 v[48:49], v28 offset:3584
    v_exp_f32 v100, v100
    v_exp_f32 v101, v101
    v_exp_f32 v102, v102
    v_exp_f32 v103, v103
    buffer_load_dwordx4 v[192:195], v4, s[20:23], s66 offen sc1
    s_add_u32 s66, s66, 4096
    v_mfma_f32_32x32x16_bf16 v[68:83], v[52:55], v[40:43], v[68:83]
    ds_read_b128 v[52:55], v27 offset:2560
    v_exp_f32 v104, v104
    v_exp_f32 v105, v105
    ds_read_b128 v[56:59], v30 offset:3840
    v_exp_f32 v106, v106
    v_exp_f32 v107, v107
    v_smfmac_f32_32x32x32_bf16 v[132:147], v[64:67], v[92:99], v24
    ds_read_b128 v[64:67], v30 offset:4480
    v_exp_f32 v108, v108
    v_exp_f32 v109, v109
    v_exp_f32 v110, v110
    v_exp_f32 v111, v111
    buffer_load_dwordx4 v[196:199], v4, s[20:23], s66 offen sc1
    s_add_u32 s66, s66, 4096
    v_smfmac_f32_32x32x32_bf16 v[116:131], v[60:63], v[100:107], v24
    v_exp_f32 v112, v112
    v_exp_f32 v113, v113
    v_exp_f32 v114, v114
    v_exp_f32 v115, v115
    s_waitcnt lgkmcnt(0)
    v_mfma_f32_32x32x8_bf16 v[84:99], v[48:49], v[44:45], 0
    v_exp_f32 v68, v68
    v_exp_f32 v69, v69
    v_exp_f32 v70, v70
    v_exp_f32 v71, v71
    buffer_load_dwordx4 v[200:203], v4, s[20:23], s66 offen sc1
    s_add_u32 s66, s66, 4096
    v_mfma_f32_32x32x16_bf16 v[84:99], v[52:55], v[36:39], v[84:99]
    v_exp_f32 v72, v72
    v_exp_f32 v73, v73
    v_exp_f32 v74, v74
    v_exp_f32 v75, v75
    v_smfmac_f32_32x32x32_bf16 v[116:131], v[64:67], v[108:115], v24
    v_exp_f32 v76, v76
    v_exp_f32 v77, v77
    v_exp_f32 v78, v78
    v_exp_f32 v79, v79
    v_smfmac_f32_32x32x32_bf16 v[132:147], v[60:63], v[68:75], v24
    v_exp_f32 v80, v80
    v_exp_f32 v81, v81
    v_exp_f32 v82, v82
    v_exp_f32 v83, v83
    v_mfma_f32_32x32x8_bf16 v[100:115], v[48:49], v[46:47], 0
    ds_read_b64 v[48:49], v28 offset:6144
    v_exp_f32 v84, v84
    v_exp_f32 v85, v85
    v_exp_f32 v86, v86
    v_exp_f32 v87, v87
    buffer_load_dwordx4 v[204:207], v4, s[20:23], s66 offen sc1
    s_add_u32 s66, s66, 4096
    v_mfma_f32_32x32x16_bf16 v[100:115], v[52:55], v[40:43], v[100:115]
    ds_read_b128 v[52:55], v27 offset:5120
    v_exp_f32 v88, v88
    v_exp_f32 v89, v89
    ds_read_b128 v[60:63], v30 offset:6400
    v_exp_f32 v90, v90
    v_exp_f32 v91, v91
    v_smfmac_f32_32x32x32_bf16 v[132:147], v[64:67], v[76:83], v24
    ds_read_b128 v[64:67], v30 offset:7040
    v_exp_f32 v92, v92
    v_exp_f32 v93, v93
    v_exp_f32 v94, v94
    v_exp_f32 v95, v95
    buffer_load_dwordx4 v[208:211], v4, s[20:23], s66 offen sc1
    s_add_u32 s66, s66, 4096
    v_smfmac_f32_32x32x32_bf16 v[116:131], v[56:59], v[84:91], v24
    v_exp_f32 v96, v96
    v_exp_f32 v97, v97
    v_exp_f32 v98, v98
    v_exp_f32 v99, v99
    s_setprio 2
    s_waitcnt lgkmcnt(0)
    v_mfma_f32_32x32x8_bf16 v[68:83], v[48:49], v[44:45], 0
    v_exp_f32 v100, v100
    v_exp_f32 v101, v101
    v_exp_f32 v102, v102
    v_exp_f32 v103, v103
    v_mfma_f32_32x32x16_bf16 v[68:83], v[52:55], v[36:39], v[68:83]
    v_exp_f32 v104, v104
    v_exp_f32 v105, v105
    v_exp_f32 v106, v106
    v_exp_f32 v107, v107
    v_smfmac_f32_32x32x32_bf16 v[116:131], v[64:67], v[92:99], v24
    v_exp_f32 v108, v108
    v_exp_f32 v109, v109
    v_exp_f32 v110, v110
    v_exp_f32 v111, v111
    buffer_load_dwordx4 v[212:215], v4, s[20:23], s66 offen sc1
    s_add_u32 s66, s66, 4096
    v_smfmac_f32_32x32x32_bf16 v[132:147], v[56:59], v[100:107], v24
    v_exp_f32 v112, v112
    v_exp_f32 v113, v113
    v_exp_f32 v114, v114
    v_exp_f32 v115, v115
    s_setprio 1
    v_mfma_f32_32x32x8_bf16 v[84:99], v[48:49], v[46:47], 0
    ds_read_b64 v[48:49], v28 offset:8704
    v_exp_f32 v68, v68
    v_exp_f32 v69, v69
    v_exp_f32 v70, v70
    v_exp_f32 v71, v71
    buffer_load_dwordx4 v[216:219], v4, s[20:23], s66 offen sc1
    s_add_u32 s66, s66, 4096
    buffer_load_dword v20, v248, s[20:23], 0 offen sc1
    v_mfma_f32_32x32x16_bf16 v[84:99], v[52:55], v[40:43], v[84:99]
    ds_read_b128 v[52:55], v27 offset:7680
    v_exp_f32 v72, v72
    v_exp_f32 v73, v73
    ds_read_b128 v[56:59], v30 offset:8960
    v_exp_f32 v74, v74
    v_exp_f32 v75, v75
    v_smfmac_f32_32x32x32_bf16 v[132:147], v[64:67], v[108:115], v24
    ds_read_b128 v[64:67], v30 offset:9600
    v_exp_f32 v76, v76
    v_exp_f32 v77, v77
    v_exp_f32 v78, v78
    v_exp_f32 v79, v79
    buffer_load_dwordx4 v[220:223], v4, s[20:23], s66 offen sc1
    s_add_u32 s66, s66, 4096
    v_smfmac_f32_32x32x32_bf16 v[116:131], v[60:63], v[68:75], v24
    v_exp_f32 v80, v80
    v_exp_f32 v81, v81
    v_exp_f32 v82, v82
    v_exp_f32 v83, v83
    s_setprio 0
    s_waitcnt lgkmcnt(0)
    v_mfma_f32_32x32x8_bf16 v[100:115], v[48:49], v[44:45], 0
    v_exp_f32 v84, v84
    v_exp_f32 v85, v85
    v_exp_f32 v86, v86
    v_exp_f32 v87, v87
    v_mov_b32 v22, v232
    v_add_u32 v23, 0x100, v233
    v_mfma_f32_32x32x16_bf16 v[100:115], v[52:55], v[36:39], v[100:115]
    v_exp_f32 v88, v88
    v_exp_f32 v89, v89
    v_exp_f32 v90, v90
    v_exp_f32 v91, v91
    v_smfmac_f32_32x32x32_bf16 v[116:131], v[64:67], v[76:83], v24
    v_exp_f32 v92, v92
    v_exp_f32 v93, v93
    v_exp_f32 v94, v94
    v_exp_f32 v95, v95
    s_branch Lpg6s
Lpg6:
    s_setpc_b64 s[38:39]
Lpg6s:
    buffer_load_dwordx4 v[224:227], v4, s[20:23], s66 offen sc1
    s_add_u32 s66, s66, 4096
    v_smfmac_f32_32x32x32_bf16 v[132:147], v[60:63], v[84:91], v24
    v_exp_f32 v96, v96
    v_exp_f32 v97, v97
    v_exp_f32 v98, v98
    v_exp_f32 v99, v99
    s_waitcnt vmcnt(10)
    s_barrier
    s_setprio 3
    v_mfma_f32_32x32x8_bf16 v[68:83], v[48:49], v[46:47], 0
    ds_read_b64 v[48:49], v29 offset:1024
    v_exp_f32 v100, v100
    v_exp_f32 v101, v101
    v_exp_f32 v102, v102
    v_exp_f32 v103, v103
    s_mul_i32 s34, s32, 2048
    s_add_u32 s34, s34, 256
    v_add_u32 v5, s34, v4
    v_lshlrev_b32 v6, 4, v0
    s_xor_b32 s34, s32, 4
    s_mul_i32 s34, s34, 2048
    s_add_u32 s34, s34, 256
    v_mfma_f32_32x32x16_bf16 v[68:83], v[52:55], v[40:43], v[68:83]
    ds_read_b128 v[52:55], v27 offset:20480
    v_exp_f32 v104, v104
    v_exp_f32 v105, v105
    ds_read_b128 v[60:63], v31 offset:1280
    v_exp_f32 v106, v106
    v_exp_f32 v107, v107
    v_smfmac_f32_32x32x32_bf16 v[132:147], v[64:67], v[92:99], v24
    ds_read_b128 v[64:67], v31 offset:1920
    v_exp_f32 v108, v108
    v_exp_f32 v109, v109
    v_exp_f32 v110, v110
    v_exp_f32 v111, v111
    v_add_u32 v7, s34, v4
    v_xor_b32 v8, 0x1000, v6
    v_smfmac_f32_32x32x32_bf16 v[116:131], v[56:59], v[100:107], v24
    v_exp_f32 v112, v112
    v_exp_f32 v113, v113
    v_exp_f32 v114, v114
    v_exp_f32 v115, v115
    s_waitcnt lgkmcnt(0)
    v_mfma_f32_32x32x8_bf16 v[84:99], v[48:49], v[44:45], 0
    v_exp_f32 v68, v68
    v_exp_f32 v69, v69
    v_exp_f32 v70, v70
    v_exp_f32 v71, v71
    v_mfma_f32_32x32x16_bf16 v[84:99], v[52:55], v[36:39], v[84:99]
    v_exp_f32 v72, v72
    v_exp_f32 v73, v73
    v_exp_f32 v74, v74
    v_exp_f32 v75, v75
    v_smfmac_f32_32x32x32_bf16 v[116:131], v[64:67], v[108:115], v24
    v_exp_f32 v76, v76
    v_exp_f32 v77, v77
    v_exp_f32 v78, v78
    v_exp_f32 v79, v79
    buffer_load_dwordx4 v[228:231], v4, s[20:23], s66 offen sc1
    s_add_u32 s66, s66, 4096
    v_smfmac_f32_32x32x32_bf16 v[132:147], v[56:59], v[68:75], v24
    v_exp_f32 v80, v80
    v_exp_f32 v81, v81
    v_exp_f32 v82, v82
    v_exp_f32 v83, v83
    v_mfma_f32_32x32x8_bf16 v[100:115], v[48:49], v[46:47], 0
    ds_read_b64 v[48:49], v29 offset:3584
    v_exp_f32 v84, v84
    v_exp_f32 v85, v85
    v_exp_f32 v86, v86
    v_exp_f32 v87, v87
    v_mfma_f32_32x32x16_bf16 v[100:115], v[52:55], v[40:43], v[100:115]
    ds_read_b128 v[52:55], v27 offset:23040
    v_exp_f32 v88, v88
    v_exp_f32 v89, v89
    ds_read_b128 v[56:59], v31 offset:3840
    v_exp_f32 v90, v90
    v_exp_f32 v91, v91
    v_smfmac_f32_32x32x32_bf16 v[132:147], v[64:67], v[76:83], v24
    ds_read_b128 v[64:67], v31 offset:4480
    v_exp_f32 v92, v92
    v_exp_f32 v93, v93
    v_exp_f32 v94, v94
    v_exp_f32 v95, v95
    buffer_load_dwordx4 v[232:235], v4, s[20:23], s66 offen sc1
    s_add_u32 s66, s66, 4096
    v_smfmac_f32_32x32x32_bf16 v[116:131], v[60:63], v[84:91], v24
    v_exp_f32 v96, v96
    v_exp_f32 v97, v97
    v_exp_f32 v98, v98
    v_exp_f32 v99, v99
    s_waitcnt lgkmcnt(0)
    v_mfma_f32_32x32x8_bf16 v[68:83], v[48:49], v[44:45], 0
    v_exp_f32 v100, v100
    v_exp_f32 v101, v101
    v_exp_f32 v102, v102
    v_exp_f32 v103, v103
    buffer_load_dwordx4 v[236:239], v4, s[20:23], s66 offen sc1
    s_add_u32 s66, s66, 4096
    v_mfma_f32_32x32x16_bf16 v[68:83], v[52:55], v[36:39], v[68:83]
    v_exp_f32 v104, v104
    v_exp_f32 v105, v105
    v_exp_f32 v106, v106
    v_exp_f32 v107, v107
    v_smfmac_f32_32x32x32_bf16 v[116:131], v[64:67], v[92:99], v24
    v_exp_f32 v108, v108
    v_exp_f32 v109, v109
    v_exp_f32 v110, v110
    v_exp_f32 v111, v111
    buffer_load_dwordx4 v[240:243], v4, s[20:23], s66 offen sc1
    s_add_u32 s66, s66, 4096
    v_smfmac_f32_32x32x32_bf16 v[132:147], v[60:63], v[100:107], v24
    v_exp_f32 v112, v112
    v_exp_f32 v113, v113
    v_exp_f32 v114, v114
    v_exp_f32 v115, v115
    v_mfma_f32_32x32x8_bf16 v[84:99], v[48:49], v[46:47], 0
    ds_read_b64 v[48:49], v29 offset:6144
    v_exp_f32 v68, v68
    v_exp_f32 v69, v69
    v_exp_f32 v70, v70
    v_exp_f32 v71, v71
    v_mfma_f32_32x32x16_bf16 v[84:99], v[52:55], v[40:43], v[84:99]
    ds_read_b128 v[52:55], v27 offset:25600
    v_exp_f32 v72, v72
    v_exp_f32 v73, v73
    ds_read_b128 v[60:63], v31 offset:6400
    v_exp_f32 v74, v74
    v_exp_f32 v75, v75
    v_smfmac_f32_32x32x32_bf16 v[132:147], v[64:67], v[108:115], v24
    ds_read_b128 v[64:67], v31 offset:7040
    v_exp_f32 v76, v76
    v_exp_f32 v77, v77
    v_exp_f32 v78, v78
    v_exp_f32 v79, v79
    buffer_load_dwordx4 v[244:247], v4, s[20:23], s66 offen sc1
    s_add_u32 s66, s66, 4096
    v_smfmac_f32_32x32x32_bf16 v[116:131], v[56:59], v[68:75], v24
    v_exp_f32 v80, v80
    v_exp_f32 v81, v81
    v_exp_f32 v82, v82
    v_exp_f32 v83, v83
    s_setprio 2
    s_waitcnt lgkmcnt(0)
    v_mfma_f32_32x32x8_bf16 v[100:115], v[48:49], v[44:45], 0
    v_exp_f32 v84, v84
    v_exp_f32 v85, v85
    v_exp_f32 v86, v86
    v_exp_f32 v87, v87
    buffer_load_dwordx4 v[248:251], v4, s[20:23], s66 offen sc1
    v_mfma_f32_32x32x16_bf16 v[100:115], v[52:55], v[36:39], v[100:115]
    v_exp_f32 v88, v88
    v_exp_f32 v89, v89
    v_exp_f32 v90, v90
    v_exp_f32 v91, v91
    v_smfmac_f32_32x32x32_bf16 v[116:131], v[64:67], v[76:83], v24
    v_exp_f32 v92, v92
    v_exp_f32 v93, v93
    v_exp_f32 v94, v94
    v_exp_f32 v95, v95
    v_smfmac_f32_32x32x32_bf16 v[132:147], v[56:59], v[84:91], v24
    v_exp_f32 v96, v96
    v_exp_f32 v97, v97
    v_exp_f32 v98, v98
    v_exp_f32 v99, v99
    s_setprio 1
    v_mfma_f32_32x32x8_bf16 v[68:83], v[48:49], v[46:47], 0
    v_exp_f32 v100, v100
    v_exp_f32 v101, v101
    v_exp_f32 v102, v102
    v_exp_f32 v103, v103
    v_mfma_f32_32x32x16_bf16 v[68:83], v[52:55], v[40:43], v[68:83]
    v_exp_f32 v104, v104
    v_exp_f32 v105, v105
    v_exp_f32 v106, v106
    v_exp_f32 v107, v107
    v_smfmac_f32_32x32x32_bf16 v[132:147], v[64:67], v[92:99], v24
    ds_read_b128 v[64:67], v31 offset:9600
    v_exp_f32 v108, v108
    v_exp_f32 v109, v109
    v_exp_f32 v110, v110
    v_exp_f32 v111, v111
    v_smfmac_f32_32x32x32_bf16 v[116:131], v[60:63], v[100:107], v24
    v_exp_f32 v112, v112
    v_exp_f32 v113, v113
    v_exp_f32 v114, v114
    v_exp_f32 v115, v115
    s_setprio 0
    s_waitcnt lgkmcnt(0)
    v_exp_f32 v68, v68
    v_exp_f32 v69, v69
    v_exp_f32 v70, v70
    v_exp_f32 v71, v71
    v_exp_f32 v72, v72
    v_exp_f32 v73, v73
    v_exp_f32 v74, v74
    v_exp_f32 v75, v75
    v_smfmac_f32_32x32x32_bf16 v[116:131], v[64:67], v[108:115], v24
    v_exp_f32 v76, v76
    v_exp_f32 v77, v77
    v_exp_f32 v78, v78
    v_exp_f32 v79, v79
    v_smfmac_f32_32x32x32_bf16 v[132:147], v[60:63], v[68:75], v24
    v_exp_f32 v80, v80
    v_exp_f32 v81, v81
    v_exp_f32 v82, v82
    v_exp_f32 v83, v83
    buffer_store_dword v23, v22, s[20:23], 0 offen sc1
    s_nop 0
    v_smfmac_f32_32x32x32_bf16 v[132:147], v[64:67], v[76:83], v24
    ds_write_b128 v6, v[124:127] offset:52480
    ds_write_b128 v5, v[116:119]
    ds_write_b128 v5, v[120:123] offset:1024
    s_waitcnt lgkmcnt(0)
    s_barrier
    ds_read_b128 v[92:95], v8 offset:52480
    ds_read_b128 v[84:87], v7
    ds_read_b128 v[88:91], v7 offset:1024
    s_nop 0
    s_nop 1
    s_waitcnt lgkmcnt(2)
    v_pk_add_f32 v[140:141], v[140:141], v[92:93]
    v_pk_add_f32 v[142:143], v[142:143], v[94:95]
    v_mov_b32 v7, v140
    v_mov_b32 v8, v140
    s_waitcnt lgkmcnt(0)
    v_pk_add_f32 v[132:133], v[132:133], v[84:85]
    v_permlane32_swap_b32 v7, v8
    v_pk_add_f32 v[134:135], v[134:135], v[86:87]
    v_rcp_f32 v100, v8
    v_pk_add_f32 v[136:137], v[136:137], v[88:89]
    v_pk_add_f32 v[138:139], v[138:139], v[90:91]
    v_pk_mul_f32 v[102:103], v[132:133], 0 op_sel_hi:[1,0]
    v_pk_fma_f32 v[102:103], v[134:135], 0, v[102:103] op_sel_hi:[1,0,1]
    v_pk_fma_f32 v[102:103], v[136:137], 0, v[102:103] op_sel_hi:[1,0,1]
    v_pk_fma_f32 v[102:103], v[138:139], 0, v[102:103] op_sel_hi:[1,0,1]
    v_pk_fma_f32 v[102:103], v[140:141], 0, v[102:103] op_sel_hi:[1,0,1]
    v_pk_fma_f32 v[102:103], v[142:143], 0, v[102:103] op_sel_hi:[1,0,1]
    v_add_f32 v5, v102, v103
    v_add_f32 v5, v5, v8
    v_cmp_gt_f32 vcc, 0x5d800000, v5
    s_mov_b64 s[38:39], vcc
    v_cmp_lt_f32 vcc, 0x21800000, v5
    s_and_b64 vcc, vcc, s[38:39]
    s_cmp_eq_u64 vcc, -1
    s_cbranch_scc0 Lp2_slow
    v_pk_mul_f32 v[132:133], v[132:133], v[100:101] op_sel_hi:[1,0]
    v_pk_mul_f32 v[134:135], v[134:135], v[100:101] op_sel_hi:[1,0]
    v_pk_mul_f32 v[136:137], v[136:137], v[100:101] op_sel_hi:[1,0]
    v_pk_mul_f32 v[138:139], v[138:139], v[100:101] op_sel_hi:[1,0]
    v_pk_mul_f32 v[140:141], v[140:141], v[100:101] op_sel_hi:[1,0]
    v_pk_mul_f32 v[142:143], v[142:143], v[100:101] op_sel_hi:[1,0]
    v_cvt_pk_bf16_f32 v104, v132, v133
    v_min_u32 v104, -2, v104
    v_cvt_pk_bf16_f32 v105, v134, v135
    v_min_u32 v105, -2, v105
    v_cvt_pk_bf16_f32 v106, v136, v137
    v_min_u32 v106, -2, v106
    v_cvt_pk_bf16_f32 v107, v138, v139
    v_min_u32 v107, -2, v107
    buffer_store_dwordx4 v[104:107], v4, s[20:23], s67 offen sc1
    v_cvt_pk_bf16_f32 v108, v140, v141
    v_min_u32 v108, -2, v108
    v_cvt_pk_bf16_f32 v109, v142, v143
    v_min_u32 v109, -2, v109
    s_mov_b64 exec, 0xffffffff
    buffer_store_dwordx2 v[108:109], v32, s[20:23], s68 offen sc1
    s_mov_b64 exec, -1
Lp2_fin:
    s_and_b32 s40, s2, 7
    s_lshl_b32 s40, s40, 2
    s_bfe_u32 s34, s2, 0x20003
    s_add_u32 s40, s40, s34
    s_lshr_b32 s41, s2, 5
    s_lshl_b32 s42, s40, 2
    s_add_u32 s42, s42, s33
    s_cmp_ge_u32 s32, 4
    s_waitcnt vmcnt(2)
    s_barrier
    s_cbranch_scc1 Lld3
    s_setprio 2
    s_lshl_b32 s34, s33, 10
    s_add_u32 s34, s34, 20480
    v_add_u32 v49, s34, v4
    ds_write_b128 v49, v[152:155] offset:0
    s_mov_b32 s43, 0xffff0000
    v_bfe_u32 v20, v0, 4, 2
    ds_write_b128 v49, v[156:159] offset:4096
    v_and_b32 v21, 15, v0
    s_and_b32 s34, s2, 7
    ds_write_b128 v49, v[160:163] offset:8192
    s_lshl_b32 s34, s34, 10
    s_add_u32 s34, s34, 25640960
    ds_write_b128 v49, v[164:167] offset:12288
    v_bfe_u32 v5, v0, 1, 3
    v_lshlrev_b32 v5, 7, v5
    ds_write_b128 v49, v[168:171] offset:16384
    v_lshl_add_u32 v5, v20, 13, v5
    v_add_u32 v48, s34, v5
    ds_write_b128 v49, v[172:175] offset:20480
    s_and_b32 s34, s33, 1
    s_lshl_b32 s34, s34, 4
    ds_write_b128 v49, v[176:179] offset:24576
    v_add_u32 v5, s34, v21
    v_lshlrev_b32 v6, 9, v20
    ds_write_b128 v49, v[180:183] offset:28672
    v_lshl_add_u32 v22, v5, 4, v6
    v_lshl_add_u32 v23, v5, 3, v6
    ds_write_b128 v49, v[184:187] offset:32768
    v_add_u32 v24, 61440, v4
    v_add_u32 v25, 112640, v4
    ds_write_b128 v49, v[188:191] offset:36864
    s_mov_b32 s50, 0
    v_mov_b32 v7, 0
    buffer_load_dword v8, v48, s[20:23], 0 offen sc1
    v_mov_b32 v120, 0x3f803f80
    v_mov_b32 v121, 0x3f803f80
    v_mov_b32 v122, 0x3f803f80
    v_mov_b32 v123, 0x3f803f80
    s_lshl_b32 s36, s32, 9
    s_add_u32 s36, s36, 1024
    v_mfma_f32_16x16x32_bf16 v[124:127], v[120:123], v[152:155], 0
    v_mfma_f32_16x16x32_bf16 v[128:131], v[120:123], v[156:159], 0
    v_mfma_f32_16x16x32_bf16 v[132:135], v[120:123], v[160:163], 0
    v_mfma_f32_16x16x32_bf16 v[136:139], v[120:123], v[164:167], 0
    v_mfma_f32_16x16x32_bf16 v[140:143], v[120:123], v[168:171], 0
    v_mfma_f32_16x16x32_bf16 v[144:147], v[120:123], v[172:175], 0
    v_mfma_f32_16x16x32_bf16 v[148:151], v[120:123], v[176:179], 0
    v_mfma_f32_16x16x32_bf16 v[124:127], v[120:123], v[180:183], v[124:127]
    v_mfma_f32_16x16x32_bf16 v[128:131], v[120:123], v[184:187], v[128:131]
    v_mfma_f32_16x16x32_bf16 v[132:135], v[120:123], v[188:191], v[132:135]
    v_mfma_f32_16x16x32_bf16 v[136:139], v[120:123], v[192:195], v[136:139]
    v_mfma_f32_16x16x32_bf16 v[140:143], v[120:123], v[196:199], v[140:143]
    v_mfma_f32_16x16x32_bf16 v[144:147], v[120:123], v[200:203], v[144:147]
    v_mfma_f32_16x16x32_bf16 v[148:151], v[120:123], v[204:207], v[148:151]
    v_mfma_f32_16x16x32_bf16 v[124:127], v[120:123], v[208:211], v[124:127]
    v_mfma_f32_16x16x32_bf16 v[128:131], v[120:123], v[212:215], v[128:131]
    v_mfma_f32_16x16x32_bf16 v[132:135], v[120:123], v[216:219], v[132:135]
    v_mfma_f32_16x16x32_bf16 v[136:139], v[120:123], v[220:223], v[136:139]
    v_mfma_f32_16x16x32_bf16 v[140:143], v[120:123], v[224:227], v[140:143]
    v_mfma_f32_16x16x32_bf16 v[144:147], v[120:123], v[228:231], v[144:147]
    v_mfma_f32_16x16x32_bf16 v[148:151], v[120:123], v[232:235], v[148:151]
    v_mfma_f32_16x16x32_bf16 v[124:127], v[120:123], v[236:239], v[124:127]
    v_mfma_f32_16x16x32_bf16 v[128:131], v[120:123], v[240:243], v[128:131]
    v_mfma_f32_16x16x32_bf16 v[132:135], v[120:123], v[244:247], v[132:135]
    v_mfma_f32_16x16x32_bf16 v[136:139], v[120:123], v[248:251], v[136:139]
    v_and_b32 v6, 15, v0
    v_lshl_add_u32 v6, v6, 2, s36
    s_waitcnt lgkmcnt(8)
    ds_write_b32 v6, v140 offset:128
    ds_write_b32 v6, v144 offset:384
    ds_write_b32 v6, v148 offset:192
    ds_write_b32 v6, v124 offset:0
    ds_write_b32 v6, v128 offset:256
    ds_write_b32 v6, v132 offset:64
    ds_write_b32 v6, v136 offset:320
    ds_read_b32 v7, v7 offset:4
    s_mov_b32 s37, 0
Lpoll_35:
    s_waitcnt vmcnt(0)
    v_cmp_gt_u32 vcc, 768, v8
    s_and_b64 exec, exec, vcc
    s_cbranch_scc0 Lpolle_36
    buffer_load_dword v8, v48, s[20:23], 0 offen sc1
    s_add_u32 s37, s37, 1
    s_cmp_lt_u32 s37, 0x200000
    s_cbranch_scc1 Lpoll_35
Lpolle_36:
    s_mov_b64 exec, -1
Lp3_redo:
    s_lshr_b32 s34, s42, 1
    s_lshl_b32 s45, s34, 15
    s_add_u32 s45, s45, 7864320
    s_lshl_b32 s46, s34, 13
    s_add_u32 s46, s46, 9961472
    buffer_load_dwordx4 v[56:59], v22, s[20:23], s45 offen offset:0 sc1
    buffer_load_dwordx4 v[60:63], v22, s[20:23], s45 offen offset:2048 sc1
    s_add_u32 s45, s45, 4096
    buffer_load_dwordx4 v[64:67], v22, s[20:23], s45 offen offset:0 sc1
    buffer_load_dwordx4 v[68:71], v22, s[20:23], s45 offen offset:2048 sc1
    s_waitcnt lgkmcnt(0)
    v_readfirstlane_b32 s44, v7
    ds_read_b128 v[120:123], v24 offset:0
    ds_read_b128 v[124:127], v24 offset:1024
    ds_read_b128 v[128:131], v24 offset:2048
    ds_read_b128 v[132:135], v24 offset:3072
    ds_read_b128 v[136:139], v24 offset:4096
    ds_read_b128 v[140:143], v24 offset:5120
    ds_read_b128 v[144:147], v24 offset:6144
    ds_read_b128 v[148:151], v24 offset:7168
    ds_read_b128 v[152:155], v24 offset:8192
    ds_read_b128 v[156:159], v24 offset:9216
    s_add_u32 s45, s45, 4096
    buffer_load_dwordx4 v[72:75], v22, s[20:23], s45 offen offset:0 sc1
    buffer_load_dwordx4 v[76:79], v22, s[20:23], s45 offen offset:2048 sc1
    s_add_u32 s45, s45, 4096
    buffer_load_dwordx4 v[80:83], v22, s[20:23], s45 offen offset:0 sc1
    buffer_load_dwordx4 v[84:87], v22, s[20:23], s45 offen offset:2048 sc1
    s_add_u32 s45, s45, 4096
    buffer_load_dwordx4 v[88:91], v22, s[20:23], s45 offen offset:0 sc1
    buffer_load_dwordx4 v[92:95], v22, s[20:23], s45 offen offset:2048 sc1
    s_add_u32 s45, s45, 4096
    buffer_load_dwordx4 v[96:99], v22, s[20:23], s45 offen offset:0 sc1
    buffer_load_dwordx4 v[100:103], v22, s[20:23], s45 offen offset:2048 sc1
    s_add_u32 s45, s45, 4096
    buffer_load_dwordx4 v[104:107], v22, s[20:23], s45 offen offset:0 sc1
    buffer_load_dwordx4 v[108:111], v22, s[20:23], s45 offen offset:2048 sc1
    s_mul_i32 s47, s42, 20
    s_lshr_b32 s34, s41, 1
    s_mul_i32 s35, s34, 5
    s_add_u32 s47, s47, s35
    s_lshl_b32 s47, s47, 10
    s_add_u32 s47, s47, 10485760
    s_and_b32 s35, s41, 1
    s_lshl_b32 s48, s35, 9
    s_add_u32 s48, s48, s47
    s_add_u32 s48, s48, 4096
    s_lshl_b32 s37, s35, 11
    s_add_u32 s47, s47, s37
    s_lshl_b32 s49, s42, 10
    s_lshl_b32 s34, s34, 8
    s_add_u32 s49, s49, s34
    s_lshl_b32 s35, s35, 3
    s_add_u32 s49, s49, s35
    s_add_u32 s49, s49, 13107200
    v_lshlrev_b32 v26, 4, v21
    v_lshl_add_u32 v26, v3, 2, v26
    v_lshlrev_b32 v28, 16, v10
    v_and_b32 v29, s43, v10
    v_lshlrev_b32 v30, 16, v11
    v_and_b32 v31, s43, v11
    v_lshlrev_b32 v32, 16, v12
    v_and_b32 v33, s43, v12
    v_lshlrev_b32 v34, 16, v13
    v_and_b32 v35, s43, v13
    v_lshlrev_b32 v36, 16, v14
    v_and_b32 v37, s43, v14
    v_lshlrev_b32 v38, 16, v15
    v_and_b32 v39, s43, v15
    v_lshlrev_b32 v40, 16, v16
    v_and_b32 v41, s43, v16
    v_lshlrev_b32 v42, 16, v17
    v_and_b32 v43, s43, v17
    v_lshlrev_b32 v44, 16, v18
    v_and_b32 v45, s43, v18
    v_lshlrev_b32 v46, 16, v19
    v_and_b32 v47, s43, v19
    s_waitcnt vmcnt(13) lgkmcnt(5)
    v_mfma_f32_16x16x32_bf16 v[28:31], v[120:123], v[56:59], v[28:31]
    ds_read_b128 v[160:163], v24 offset:10240
    v_max3_u32 v50, v56, v57, 0
    v_mfma_f32_16x16x32_bf16 v[32:35], v[124:127], v[56:59], v[32:35]
    ds_read_b128 v[164:167], v24 offset:11264
    v_mfma_f32_16x16x32_bf16 v[36:39], v[128:131], v[56:59], v[36:39]
    ds_read_b128 v[168:171], v24 offset:12288
    s_add_u32 s45, s45, 4096
    buffer_load_dwordx4 v[112:115], v22, s[20:23], s45 offen offset:0 sc1
    v_mfma_f32_16x16x32_bf16 v[40:43], v[132:135], v[56:59], v[40:43]
    ds_read_b128 v[172:175], v24 offset:13312
    v_max3_u32 v50, v58, v59, v50
    v_mfma_f32_16x16x32_bf16 v[44:47], v[136:139], v[56:59], v[44:47]
    ds_read_b128 v[176:179], v24 offset:14336
    s_waitcnt vmcnt(13) lgkmcnt(5)
    v_mfma_f32_16x16x32_bf16 v[28:31], v[140:143], v[60:63], v[28:31]
    ds_read_b128 v[120:123], v24 offset:15360
    v_max3_u32 v50, v60, v61, v50
    v_mfma_f32_16x16x32_bf16 v[32:35], v[144:147], v[60:63], v[32:35]
    ds_read_b128 v[124:127], v24 offset:16384
    v_mfma_f32_16x16x32_bf16 v[36:39], v[148:151], v[60:63], v[36:39]
    ds_read_b128 v[128:131], v24 offset:17408
    buffer_load_dwordx4 v[116:119], v22, s[20:23], s45 offen offset:2048 sc1
    v_mfma_f32_16x16x32_bf16 v[40:43], v[152:155], v[60:63], v[40:43]
    ds_read_b128 v[132:135], v24 offset:18432
    v_max3_u32 v50, v62, v63, v50
    v_mfma_f32_16x16x32_bf16 v[44:47], v[156:159], v[60:63], v[44:47]
    ds_read_b128 v[136:139], v24 offset:19456
    s_waitcnt vmcnt(13) lgkmcnt(5)
    v_mfma_f32_16x16x32_bf16 v[28:31], v[160:163], v[64:67], v[28:31]
    ds_read_b128 v[140:143], v24 offset:20480
    v_max3_u32 v50, v64, v65, v50
    v_mfma_f32_16x16x32_bf16 v[32:35], v[164:167], v[64:67], v[32:35]
    ds_read_b128 v[144:147], v24 offset:21504
    v_mfma_f32_16x16x32_bf16 v[36:39], v[168:171], v[64:67], v[36:39]
    ds_read_b128 v[148:151], v24 offset:22528
    buffer_load_dwordx2 v[56:57], v23, s[20:23], s46 offen offset:0 sc1
    v_mfma_f32_16x16x32_bf16 v[40:43], v[172:175], v[64:67], v[40:43]
    ds_read_b128 v[152:155], v24 offset:23552
    v_max3_u32 v50, v66, v67, v50
    v_mfma_f32_16x16x32_bf16 v[44:47], v[176:179], v[64:67], v[44:47]
    ds_read_b128 v[156:159], v24 offset:24576
    s_waitcnt vmcnt(13) lgkmcnt(5)
    v_mfma_f32_16x16x32_bf16 v[28:31], v[120:123], v[68:71], v[28:31]
    ds_read_b128 v[160:163], v24 offset:25600
    v_max3_u32 v50, v68, v69, v50
    v_mfma_f32_16x16x32_bf16 v[32:35], v[124:127], v[68:71], v[32:35]
    ds_read_b128 v[164:167], v24 offset:26624
    v_mfma_f32_16x16x32_bf16 v[36:39], v[128:131], v[68:71], v[36:39]
    ds_read_b128 v[168:171], v24 offset:27648
    buffer_load_dwordx2 v[58:59], v23, s[20:23], s46 offen offset:256 sc1
    v_mfma_f32_16x16x32_bf16 v[40:43], v[132:135], v[68:71], v[40:43]
    ds_read_b128 v[172:175], v24 offset:28672
    v_max3_u32 v50, v70, v71, v50
    v_mfma_f32_16x16x32_bf16 v[44:47], v[136:139], v[68:71], v[44:47]
    ds_read_b128 v[176:179], v24 offset:29696
    s_waitcnt vmcnt(13) lgkmcnt(5)
    v_mfma_f32_16x16x32_bf16 v[28:31], v[140:143], v[72:75], v[28:31]
    ds_read_b128 v[120:123], v24 offset:30720
    v_max3_u32 v50, v72, v73, v50
    v_mfma_f32_16x16x32_bf16 v[32:35], v[144:147], v[72:75], v[32:35]
    ds_read_b128 v[124:127], v24 offset:31744
    v_mfma_f32_16x16x32_bf16 v[36:39], v[148:151], v[72:75], v[36:39]
    ds_read_b128 v[128:131], v24 offset:32768
    buffer_load_dwordx2 v[60:61], v23, s[20:23], s46 offen offset:2048 sc1
    v_mfma_f32_16x16x32_bf16 v[40:43], v[152:155], v[72:75], v[40:43]
    ds_read_b128 v[132:135], v24 offset:33792
    v_max3_u32 v50, v74, v75, v50
    v_mfma_f32_16x16x32_bf16 v[44:47], v[156:159], v[72:75], v[44:47]
    ds_read_b128 v[136:139], v24 offset:34816
    s_waitcnt vmcnt(13) lgkmcnt(5)
    v_mfma_f32_16x16x32_bf16 v[28:31], v[160:163], v[76:79], v[28:31]
    ds_read_b128 v[140:143], v24 offset:35840
    v_max3_u32 v50, v76, v77, v50
    v_mfma_f32_16x16x32_bf16 v[32:35], v[164:167], v[76:79], v[32:35]
    ds_read_b128 v[144:147], v24 offset:36864
    v_mfma_f32_16x16x32_bf16 v[36:39], v[168:171], v[76:79], v[36:39]
    ds_read_b128 v[148:151], v24 offset:37888
    buffer_load_dwordx2 v[62:63], v23, s[20:23], s46 offen offset:2304 sc1
    v_mfma_f32_16x16x32_bf16 v[40:43], v[172:175], v[76:79], v[40:43]
    ds_read_b128 v[152:155], v24 offset:38912
    v_max3_u32 v50, v78, v79, v50
    v_mfma_f32_16x16x32_bf16 v[44:47], v[176:179], v[76:79], v[44:47]
    ds_read_b128 v[156:159], v24 offset:39936
    s_waitcnt vmcnt(13) lgkmcnt(5)
    v_mfma_f32_16x16x32_bf16 v[28:31], v[120:123], v[80:83], v[28:31]
    ds_read_b128 v[160:163], v24 offset:40960
    v_max3_u32 v50, v80, v81, v50
    v_mfma_f32_16x16x32_bf16 v[32:35], v[124:127], v[80:83], v[32:35]
    ds_read_b128 v[164:167], v24 offset:41984
    v_mfma_f32_16x16x32_bf16 v[36:39], v[128:131], v[80:83], v[36:39]
    ds_read_b128 v[168:171], v24 offset:43008
    s_add_u32 s46, s46, 4096
    buffer_load_dwordx2 v[64:65], v23, s[20:23], s46 offen offset:0 sc1
    v_mfma_f32_16x16x32_bf16 v[40:43], v[132:135], v[80:83], v[40:43]
    ds_read_b128 v[172:175], v24 offset:44032
    v_max3_u32 v50, v82, v83, v50
    v_mfma_f32_16x16x32_bf16 v[44:47], v[136:139], v[80:83], v[44:47]
    ds_read_b128 v[176:179], v24 offset:45056
    s_waitcnt vmcnt(13) lgkmcnt(5)
    v_mfma_f32_16x16x32_bf16 v[28:31], v[140:143], v[84:87], v[28:31]
    ds_read_b128 v[120:123], v24 offset:46080
    v_max3_u32 v50, v84, v85, v50
    v_mfma_f32_16x16x32_bf16 v[32:35], v[144:147], v[84:87], v[32:35]
    ds_read_b128 v[124:127], v24 offset:47104
    v_mfma_f32_16x16x32_bf16 v[36:39], v[148:151], v[84:87], v[36:39]
    ds_read_b128 v[128:131], v24 offset:48128
    buffer_load_dwordx2 v[66:67], v23, s[20:23], s46 offen offset:256 sc1
    v_mfma_f32_16x16x32_bf16 v[40:43], v[152:155], v[84:87], v[40:43]
    ds_read_b128 v[132:135], v24 offset:49152
    v_max3_u32 v50, v86, v87, v50
    v_mfma_f32_16x16x32_bf16 v[44:47], v[156:159], v[84:87], v[44:47]
    ds_read_b128 v[136:139], v24 offset:50176
    s_waitcnt vmcnt(13) lgkmcnt(5)
    v_mfma_f32_16x16x32_bf16 v[28:31], v[160:163], v[88:91], v[28:31]
    ds_read_b128 v[140:143], v25 offset:0
    v_max3_u32 v50, v88, v89, v50
    v_mfma_f32_16x16x32_bf16 v[32:35], v[164:167], v[88:91], v[32:35]
    ds_read_b128 v[144:147], v25 offset:1024
    v_mfma_f32_16x16x32_bf16 v[36:39], v[168:171], v[88:91], v[36:39]
    ds_read_b128 v[148:151], v25 offset:2048
    buffer_load_dwordx2 v[68:69], v23, s[20:23], s46 offen offset:2048 sc1
    v_mfma_f32_16x16x32_bf16 v[40:43], v[172:175], v[88:91], v[40:43]
    ds_read_b128 v[152:155], v25 offset:3072
    v_max3_u32 v50, v90, v91, v50
    v_mfma_f32_16x16x32_bf16 v[44:47], v[176:179], v[88:91], v[44:47]
    ds_read_b128 v[156:159], v25 offset:4096
    s_waitcnt vmcnt(13) lgkmcnt(5)
    v_mfma_f32_16x16x32_bf16 v[28:31], v[120:123], v[92:95], v[28:31]
    ds_read_b128 v[160:163], v25 offset:5120
    v_max3_u32 v50, v92, v93, v50
    v_mfma_f32_16x16x32_bf16 v[32:35], v[124:127], v[92:95], v[32:35]
    ds_read_b128 v[164:167], v25 offset:6144
    v_mfma_f32_16x16x32_bf16 v[36:39], v[128:131], v[92:95], v[36:39]
    ds_read_b128 v[168:171], v25 offset:7168
    buffer_load_dwordx2 v[70:71], v23, s[20:23], s46 offen offset:2304 sc1
    v_mfma_f32_16x16x32_bf16 v[40:43], v[132:135], v[92:95], v[40:43]
    ds_read_b128 v[172:175], v25 offset:8192
    v_max3_u32 v50, v94, v95, v50
    v_mfma_f32_16x16x32_bf16 v[44:47], v[136:139], v[92:95], v[44:47]
    ds_read_b128 v[176:179], v25 offset:9216
    s_waitcnt vmcnt(13) lgkmcnt(5)
    v_mfma_f32_16x16x32_bf16 v[28:31], v[140:143], v[96:99], v[28:31]
    ds_read_b128 v[120:123], v25 offset:10240
    v_max3_u32 v50, v96, v97, v50
    v_mfma_f32_16x16x32_bf16 v[32:35], v[144:147], v[96:99], v[32:35]
    ds_read_b128 v[124:127], v25 offset:11264
    v_mfma_f32_16x16x32_bf16 v[36:39], v[148:151], v[96:99], v[36:39]
    ds_read_b128 v[128:131], v25 offset:12288
    v_mfma_f32_16x16x32_bf16 v[40:43], v[152:155], v[96:99], v[40:43]
    ds_read_b128 v[132:135], v25 offset:13312
    v_max3_u32 v50, v98, v99, v50
    v_mfma_f32_16x16x32_bf16 v[44:47], v[156:159], v[96:99], v[44:47]
    ds_read_b128 v[136:139], v25 offset:14336
    s_waitcnt vmcnt(12) lgkmcnt(5)
    v_mfma_f32_16x16x32_bf16 v[28:31], v[160:163], v[100:103], v[28:31]
    ds_read_b128 v[140:143], v25 offset:15360
    v_max3_u32 v50, v100, v101, v50
    v_mfma_f32_16x16x32_bf16 v[32:35], v[164:167], v[100:103], v[32:35]
    ds_read_b128 v[144:147], v25 offset:16384
    v_mfma_f32_16x16x32_bf16 v[36:39], v[168:171], v[100:103], v[36:39]
    ds_read_b128 v[148:151], v25 offset:17408
    v_mfma_f32_16x16x32_bf16 v[40:43], v[172:175], v[100:103], v[40:43]
    ds_read_b128 v[152:155], v25 offset:18432
    v_max3_u32 v50, v102, v103, v50
    v_mfma_f32_16x16x32_bf16 v[44:47], v[176:179], v[100:103], v[44:47]
    ds_read_b128 v[156:159], v25 offset:19456
    s_waitcnt vmcnt(11) lgkmcnt(5)
    v_mfma_f32_16x16x32_bf16 v[28:31], v[120:123], v[104:107], v[28:31]
    ds_read_b128 v[160:163], v25 offset:20480
    v_max3_u32 v50, v104, v105, v50
    v_mfma_f32_16x16x32_bf16 v[32:35], v[124:127], v[104:107], v[32:35]
    ds_read_b128 v[164:167], v25 offset:21504
    v_mfma_f32_16x16x32_bf16 v[36:39], v[128:131], v[104:107], v[36:39]
    ds_read_b128 v[168:171], v25 offset:22528
    v_mfma_f32_16x16x32_bf16 v[40:43], v[132:135], v[104:107], v[40:43]
    ds_read_b128 v[172:175], v25 offset:23552
    v_max3_u32 v50, v106, v107, v50
    v_mfma_f32_16x16x32_bf16 v[44:47], v[136:139], v[104:107], v[44:47]
    ds_read_b128 v[176:179], v25 offset:24576
    s_waitcnt vmcnt(10) lgkmcnt(5)
    v_mfma_f32_16x16x32_bf16 v[28:31], v[140:143], v[108:111], v[28:31]
    ds_read_b128 v[120:123], v25 offset:25600
    v_max3_u32 v50, v108, v109, v50
    v_mfma_f32_16x16x32_bf16 v[32:35], v[144:147], v[108:111], v[32:35]
    ds_read_b128 v[124:127], v25 offset:26624
    v_mfma_f32_16x16x32_bf16 v[36:39], v[148:151], v[108:111], v[36:39]
    ds_read_b128 v[128:131], v25 offset:27648
    v_mfma_f32_16x16x32_bf16 v[40:43], v[152:155], v[108:111], v[40:43]
    ds_read_b128 v[132:135], v25 offset:28672
    v_max3_u32 v50, v110, v111, v50
    v_mfma_f32_16x16x32_bf16 v[44:47], v[156:159], v[108:111], v[44:47]
    ds_read_b128 v[136:139], v25 offset:29696
    s_waitcnt vmcnt(9) lgkmcnt(5)
    v_mfma_f32_16x16x32_bf16 v[28:31], v[160:163], v[112:115], v[28:31]
    ds_read_b128 v[140:143], v25 offset:30720
    s_branch Lpg7s
Lpg7:
    s_setpc_b64 s[38:39]
Lpg7s:
    v_max3_u32 v50, v112, v113, v50
    v_mfma_f32_16x16x32_bf16 v[32:35], v[164:167], v[112:115], v[32:35]
    ds_read_b128 v[144:147], v25 offset:31744
    v_mfma_f32_16x16x32_bf16 v[36:39], v[168:171], v[112:115], v[36:39]
    ds_read_b128 v[148:151], v25 offset:32768
    v_mfma_f32_16x16x32_bf16 v[40:43], v[172:175], v[112:115], v[40:43]
    ds_read_b128 v[152:155], v25 offset:33792
    v_max3_u32 v50, v114, v115, v50
    v_mfma_f32_16x16x32_bf16 v[44:47], v[176:179], v[112:115], v[44:47]
    ds_read_b128 v[156:159], v25 offset:34816
    s_waitcnt vmcnt(8) lgkmcnt(5)
    v_mfma_f32_16x16x32_bf16 v[28:31], v[120:123], v[116:119], v[28:31]
    ds_read_b128 v[160:163], v25 offset:35840
    v_max3_u32 v50, v116, v117, v50
    v_mfma_f32_16x16x32_bf16 v[32:35], v[124:127], v[116:119], v[32:35]
    ds_read_b128 v[164:167], v25 offset:36864
    v_mfma_f32_16x16x32_bf16 v[36:39], v[128:131], v[116:119], v[36:39]
    ds_read_b128 v[168:171], v25 offset:37888
    v_mfma_f32_16x16x32_bf16 v[40:43], v[132:135], v[116:119], v[40:43]
    ds_read_b128 v[172:175], v25 offset:38912
    v_max3_u32 v50, v118, v119, v50
    v_mfma_f32_16x16x32_bf16 v[44:47], v[136:139], v[116:119], v[44:47]
    ds_read_b128 v[176:179], v25 offset:39936
    s_waitcnt vmcnt(6) lgkmcnt(5)
    v_mfma_f32_16x16x32_bf16 v[28:31], v[140:143], v[56:59], v[28:31]
    ds_read_b128 v[120:123], v25 offset:40960
    v_max3_u32 v50, v56, v57, v50
    v_mfma_f32_16x16x32_bf16 v[32:35], v[144:147], v[56:59], v[32:35]
    ds_read_b128 v[124:127], v25 offset:41984
    v_mfma_f32_16x16x32_bf16 v[36:39], v[148:151], v[56:59], v[36:39]
    ds_read_b128 v[128:131], v25 offset:43008
    v_mfma_f32_16x16x32_bf16 v[40:43], v[152:155], v[56:59], v[40:43]
    ds_read_b128 v[132:135], v25 offset:44032
    v_max3_u32 v50, v58, v59, v50
    v_mfma_f32_16x16x32_bf16 v[44:47], v[156:159], v[56:59], v[44:47]
    ds_read_b128 v[136:139], v25 offset:45056
    s_waitcnt vmcnt(4) lgkmcnt(5)
    v_mfma_f32_16x16x32_bf16 v[28:31], v[160:163], v[60:63], v[28:31]
    ds_read_b128 v[140:143], v25 offset:46080
    v_max3_u32 v50, v60, v61, v50
    v_mfma_f32_16x16x32_bf16 v[32:35], v[164:167], v[60:63], v[32:35]
    ds_read_b128 v[144:147], v25 offset:47104
    v_mfma_f32_16x16x32_bf16 v[36:39], v[168:171], v[60:63], v[36:39]
    ds_read_b128 v[148:151], v25 offset:48128
    v_mfma_f32_16x16x32_bf16 v[40:43], v[172:175], v[60:63], v[40:43]
    ds_read_b128 v[152:155], v25 offset:49152
    v_max3_u32 v50, v62, v63, v50
    v_mfma_f32_16x16x32_bf16 v[44:47], v[176:179], v[60:63], v[44:47]
    ds_read_b128 v[156:159], v25 offset:50176
    s_waitcnt vmcnt(2) lgkmcnt(5)
    v_mfma_f32_16x16x32_bf16 v[28:31], v[120:123], v[64:67], v[28:31]
    v_max3_u32 v50, v64, v65, v50
    v_mfma_f32_16x16x32_bf16 v[32:35], v[124:127], v[64:67], v[32:35]
    v_mfma_f32_16x16x32_bf16 v[36:39], v[128:131], v[64:67], v[36:39]
    v_mfma_f32_16x16x32_bf16 v[40:43], v[132:135], v[64:67], v[40:43]
    v_max3_u32 v50, v66, v67, v50
    v_mfma_f32_16x16x32_bf16 v[44:47], v[136:139], v[64:67], v[44:47]
    s_waitcnt vmcnt(0) lgkmcnt(0)
    v_mfma_f32_16x16x32_bf16 v[28:31], v[140:143], v[68:71], v[28:31]
    v_max3_u32 v50, v68, v69, v50
    v_mfma_f32_16x16x32_bf16 v[32:35], v[144:147], v[68:71], v[32:35]
    v_mfma_f32_16x16x32_bf16 v[36:39], v[148:151], v[68:71], v[36:39]
    v_mfma_f32_16x16x32_bf16 v[40:43], v[152:155], v[68:71], v[40:43]
    v_max3_u32 v50, v70, v71, v50
    v_mfma_f32_16x16x32_bf16 v[44:47], v[156:159], v[68:71], v[44:47]
    v_cmp_eq_u32 vcc, -1, v50
    s_cmp_lg_u64 vcc, 0
    s_cbranch_scc1 Lp3_again
Lp3_ok:
    s_barrier
    s_cmp_lg_u32 s44, 0
    s_nop 1
    v_cvt_pk_bf16_f32 v10, v28, v29
    v_cvt_pk_bf16_f32 v11, v30, v31
    v_cvt_pk_bf16_f32 v12, v32, v33
    v_cvt_pk_bf16_f32 v13, v34, v35
    s_cbranch_scc1 Lw_37
    buffer_store_dwordx4 v[10:13], v4, s[20:23], s47 offen offset:0
Lw_37b:
    v_cvt_pk_bf16_f32 v14, v36, v37
    v_cvt_pk_bf16_f32 v15, v38, v39
    v_cvt_pk_bf16_f32 v16, v40, v41
    v_cvt_pk_bf16_f32 v17, v42, v43
    s_cbranch_scc1 Lw_38
    buffer_store_dwordx4 v[14:17], v4, s[20:23], s47 offen offset:1024
Lw_38b:
    v_cvt_pk_bf16_f32 v18, v44, v45
    v_cvt_pk_bf16_f32 v19, v46, v47
    v_mov_b32 v48, v18
    v_mov_b32 v49, v19
    v_mov_b32 v50, v18
    v_mov_b32 v51, v19
    v_pk_mul_f32 v[52:53], v[28:29], v[28:29]
    v_pk_add_f32 v[54:55], v[28:29], v[30:31]
    v_permlane32_swap_b32 v48, v50
    v_permlane32_swap_b32 v49, v51
    s_mov_b64 exec, 0xffffffff
    s_cbranch_scc1 Lw_39
    buffer_store_dwordx4 v[48:51], v4, s[20:23], s48 offen
Lw_39b:
    s_mov_b64 exec, -1
    v_pk_fma_f32 v[52:53], v[30:31], v[30:31], v[52:53]
    v_pk_fma_f32 v[52:53], v[32:33], v[32:33], v[52:53]
    v_pk_add_f32 v[54:55], v[54:55], v[32:33]
    v_pk_fma_f32 v[52:53], v[34:35], v[34:35], v[52:53]
    v_pk_add_f32 v[54:55], v[54:55], v[34:35]
    v_pk_fma_f32 v[52:53], v[36:37], v[36:37], v[52:53]
    v_pk_add_f32 v[54:55], v[54:55], v[36:37]
    v_pk_fma_f32 v[52:53], v[38:39], v[38:39], v[52:53]
    v_pk_add_f32 v[54:55], v[54:55], v[38:39]
    v_pk_fma_f32 v[52:53], v[40:41], v[40:41], v[52:53]
    v_pk_add_f32 v[54:55], v[54:55], v[40:41]
    v_pk_fma_f32 v[52:53], v[42:43], v[42:43], v[52:53]
    v_pk_add_f32 v[54:55], v[54:55], v[42:43]
    v_pk_fma_f32 v[52:53], v[44:45], v[44:45], v[52:53]
    v_pk_add_f32 v[54:55], v[54:55], v[44:45]
    v_pk_fma_f32 v[52:53], v[46:47], v[46:47], v[52:53]
    v_pk_add_f32 v[54:55], v[54:55], v[46:47]
    v_add_f32 v52, v52, v53
    v_add_f32 v54, v54, v55
    s_nop 1
    v_permlane32_swap_b32 v54, v52
    v_add_f32 v52, v52, v54
    v_mov_b32 v53, v52
    s_nop 1
    v_permlane16_swap_b32 v52, v53
    v_add_f32 v52, v52, v53
    s_mov_b32 exec_lo, 0xffff
    s_mov_b32 exec_hi, 0xffff
    s_cbranch_scc1 Lw_40
    buffer_store_dword v52, v26, s[20:23], s49 offen
Lw_40b:
    s_mov_b64 exec, -1
    s_lshl_b32 s34, s42, 6
    s_and_b32 s35, s42, 1
    s_lshl_b32 s35, s35, 5
    s_sub_u32 s34, s34, s35
    s_lshl_b32 s35, s41, 2
    s_add_u32 s34, s34, s35
    s_add_u32 s38, s34, 25690112
    s_lshr_b32 s45, s40, 1
    s_lshl_b32 s46, s41, 1
    s_and_b32 s34, s40, 1
    s_add_u32 s46, s46, s34
    s_lshl_b32 s34, s45, 3
    s_lshl_b32 s35, s33, 1
    s_add_u32 s36, s34, s35
    s_mul_i32 s47, s36, 20480
    s_add_u32 s47, s47, 10485760
    s_add_u32 s48, s47, 20480
    s_lshl_b32 s57, s36, 10
    s_add_u32 s57, s57, 13107200
    s_lshl_b32 s55, s36, 6
    s_add_u32 s55, s55, 25690112
    v_lshl_add_u32 v5, v21, 2, s55
    v_add_u32 v22, 20480, v4
    v_add_u32 v23, 84992, v4
    v_add_u32 v24, 149504, v4
    ds_read_b128 v[108:111], v22 offset:0
    ds_read_b128 v[112:115], v22 offset:1024
    ds_read_b128 v[116:119], v22 offset:2048
    ds_read_b128 v[120:123], v22 offset:3072
    ds_read_b128 v[124:127], v22 offset:4096
    ds_read_b128 v[128:131], v22 offset:5120
    s_lshl_b32 s34, s33, 10
    s_add_u32 s34, s34, 61440
    v_add_u32 v7, s34, v4
    ds_write_b128 v7, v[192:195] offset:0
    ds_write_b128 v7, v[196:199] offset:4096
    ds_write_b128 v7, v[200:203] offset:8192
    ds_write_b128 v7, v[204:207] offset:12288
    ds_write_b128 v7, v[208:211] offset:16384
    v_mov_b32 v6, 1
    s_cmp_lg_u32 s44, 0
    s_mov_b64 exec, 1
    s_waitcnt vmcnt(0)
    s_cbranch_scc1 Lw_41
    buffer_store_dword v6, v4, s[20:23], s38 offen
Lw_41b:
    s_mov_b64 exec, -1
    buffer_load_dword v8, v5, s[20:23], 0 offen sc1
    s_waitcnt lgkmcnt(4)
    ds_write_b128 v7, v[212:215] offset:20480
    ds_write_b128 v7, v[216:219] offset:24576
    ds_write_b128 v7, v[220:223] offset:28672
    ds_write_b128 v7, v[224:227] offset:32768
    ds_write_b128 v7, v[228:231] offset:36864
    ds_write_b128 v7, v[232:235] offset:40960
    s_mov_b32 s37, 0
Lpoll_42:
    s_waitcnt vmcnt(0)
    v_cmp_gt_u32 vcc, 1, v8
    s_and_b64 exec, exec, vcc
    s_cbranch_scc0 Lpolle_43
    buffer_load_dword v8, v5, s[20:23], 0 offen sc1
    s_add_u32 s37, s37, 1
    s_cmp_lt_u32 s37, 0x200000
    s_cbranch_scc1 Lpoll_42
Lpolle_43:
    s_mov_b64 exec, -1
    buffer_load_dwordx4 v[28:31], v4, s[20:23], s47 offen offset:0 sc1
    buffer_load_dwordx4 v[32:35], v4, s[20:23], s48 offen offset:0 sc1
    buffer_load_dwordx4 v[36:39], v4, s[20:23], s47 offen offset:1024 sc1
    buffer_load_dwordx4 v[40:43], v4, s[20:23], s48 offen offset:1024 sc1
    buffer_load_dwordx4 v[44:47], v4, s[20:23], s47 offen offset:2048 sc1
    buffer_load_dwordx4 v[48:51], v4, s[20:23], s48 offen offset:2048 sc1
    buffer_load_dwordx4 v[52:55], v4, s[20:23], s47 offen offset:3072 sc1
    buffer_load_dwordx4 v[56:59], v4, s[20:23], s48 offen offset:3072 sc1
    ds_write_b128 v7, v[236:239] offset:45056
    ds_write_b128 v7, v[240:243] offset:49152
    ds_write_b128 v7, v[244:247] offset:53248
    ds_write_b128 v7, v[248:251] offset:57344
    s_lshl_b32 s34, s46, 2
    s_add_u32 s55, s55, s34
    s_add_u32 s55, s55, 64
    s_lshl_b32 s56, s45, 6
    s_add_u32 s56, s56, s34
    s_add_u32 s56, s56, s33
    s_mul_i32 s56, s56, 6912
    s_add_u32 s56, s56, 13238272
    s_lshr_b32 s34, s46, 1
    s_min_u32 s35, s34, 6
    s_mul_i32 s52, s46, 3
    s_add_u32 s52, s52, s35
    s_mul_i32 s36, s36, 54
    s_add_u32 s52, s52, s36
    s_lshl_b32 s52, s52, 10
    s_add_u32 s52, s52, 13238272
    s_add_u32 s53, s52, 55296
    s_mul_i32 s34, s34, 7
    s_add_u32 s34, s34, s36
    s_lshl_b32 s34, s34, 10
    s_and_b32 s35, s46, 1
    s_lshl_b32 s35, s35, 9
    s_add_u32 s34, s34, s35
    s_add_u32 s54, s34, 13244416
    v_lshlrev_b32 v26, 4, v20
    v_mul_u32_u24 v25, 55296, v3
    v_lshl_add_u32 v25, v2, 4, v25
    s_waitcnt lgkmcnt(0)
    v_mov_b32 v232, 0xbfb8aa3b
    s_waitcnt vmcnt(6) lgkmcnt(4)
    v_mfma_f32_16x16x32_bf16 v[136:139], v[108:111], v[28:31], 0
    ds_read_b128 v[132:135], v22 offset:6144
    v_mfma_f32_16x16x32_bf16 v[164:167], v[108:111], v[32:35], 0
    buffer_load_dwordx4 v[220:223], v4, s[20:23], s57 offen offset:0 sc1
    v_mfma_f32_16x16x32_bf16 v[140:143], v[112:115], v[28:31], 0
    ds_read_b128 v[108:111], v22 offset:7168
    v_mfma_f32_16x16x32_bf16 v[168:171], v[112:115], v[32:35], 0
    s_waitcnt lgkmcnt(4)
    v_mfma_f32_16x16x32_bf16 v[144:147], v[116:119], v[28:31], 0
    ds_read_b128 v[112:115], v22 offset:8192
    v_mfma_f32_16x16x32_bf16 v[172:175], v[116:119], v[32:35], 0
    buffer_load_dwordx4 v[224:227], v4, s[20:23], s57 offen offset:1024 sc1
    v_mfma_f32_16x16x32_bf16 v[148:151], v[120:123], v[28:31], 0
    ds_read_b128 v[116:119], v22 offset:9216
    v_mfma_f32_16x16x32_bf16 v[176:179], v[120:123], v[32:35], 0
    s_waitcnt lgkmcnt(4)
    v_mfma_f32_16x16x32_bf16 v[152:155], v[124:127], v[28:31], 0
    ds_read_b128 v[120:123], v22 offset:10240
    v_mfma_f32_16x16x32_bf16 v[180:183], v[124:127], v[32:35], 0
    s_add_u32 s47, s47, 4096
    buffer_load_dwordx4 v[60:63], v4, s[20:23], s47 offen offset:0 sc1
    v_mfma_f32_16x16x32_bf16 v[156:159], v[128:131], v[28:31], 0
    ds_read_b128 v[124:127], v22 offset:11264
    v_mfma_f32_16x16x32_bf16 v[184:187], v[128:131], v[32:35], 0
    s_waitcnt lgkmcnt(4)
    v_mfma_f32_16x16x32_bf16 v[160:163], v[132:135], v[28:31], 0
    ds_read_b128 v[128:131], v22 offset:12288
    v_mfma_f32_16x16x32_bf16 v[188:191], v[132:135], v[32:35], 0
    s_waitcnt vmcnt(7) lgkmcnt(4)
    v_mfma_f32_16x16x32_bf16 v[136:139], v[108:111], v[36:39], v[136:139]
    ds_read_b128 v[132:135], v22 offset:13312
    v_mfma_f32_16x16x32_bf16 v[164:167], v[108:111], v[40:43], v[164:167]
    s_add_u32 s48, s48, 4096
    buffer_load_dwordx4 v[64:67], v4, s[20:23], s48 offen offset:0 sc1
    v_mfma_f32_16x16x32_bf16 v[140:143], v[112:115], v[36:39], v[140:143]
    ds_read_b128 v[108:111], v22 offset:14336
    v_mfma_f32_16x16x32_bf16 v[168:171], v[112:115], v[40:43], v[168:171]
    s_waitcnt lgkmcnt(4)
    v_mfma_f32_16x16x32_bf16 v[144:147], v[116:119], v[36:39], v[144:147]
    ds_read_b128 v[112:115], v22 offset:15360
    v_mfma_f32_16x16x32_bf16 v[172:175], v[116:119], v[40:43], v[172:175]
    buffer_load_dwordx4 v[68:71], v4, s[20:23], s47 offen offset:1024 sc1
    v_mfma_f32_16x16x32_bf16 v[148:151], v[120:123], v[36:39], v[148:151]
    ds_read_b128 v[116:119], v22 offset:16384
    v_mfma_f32_16x16x32_bf16 v[176:179], v[120:123], v[40:43], v[176:179]
    s_waitcnt lgkmcnt(4)
    v_mfma_f32_16x16x32_bf16 v[152:155], v[124:127], v[36:39], v[152:155]
    ds_read_b128 v[120:123], v22 offset:17408
    v_mfma_f32_16x16x32_bf16 v[180:183], v[124:127], v[40:43], v[180:183]
    buffer_load_dwordx4 v[72:75], v4, s[20:23], s48 offen offset:1024 sc1
    v_mfma_f32_16x16x32_bf16 v[156:159], v[128:131], v[36:39], v[156:159]
    ds_read_b128 v[124:127], v22 offset:18432
    v_mfma_f32_16x16x32_bf16 v[184:187], v[128:131], v[40:43], v[184:187]
    s_waitcnt lgkmcnt(4)
    v_mfma_f32_16x16x32_bf16 v[160:163], v[132:135], v[36:39], v[160:163]
    ds_read_b128 v[128:131], v22 offset:19456
    v_mfma_f32_16x16x32_bf16 v[188:191], v[132:135], v[40:43], v[188:191]
    s_waitcnt vmcnt(8) lgkmcnt(4)
    v_mfma_f32_16x16x32_bf16 v[136:139], v[108:111], v[44:47], v[136:139]
    ds_read_b128 v[132:135], v22 offset:20480
    v_mfma_f32_16x16x32_bf16 v[164:167], v[108:111], v[48:51], v[164:167]
    buffer_load_dwordx4 v[76:79], v4, s[20:23], s47 offen offset:2048 sc1
    v_mfma_f32_16x16x32_bf16 v[140:143], v[112:115], v[44:47], v[140:143]
    ds_read_b128 v[108:111], v22 offset:21504
    v_mfma_f32_16x16x32_bf16 v[168:171], v[112:115], v[48:51], v[168:171]
    s_waitcnt lgkmcnt(4)
    v_mfma_f32_16x16x32_bf16 v[144:147], v[116:119], v[44:47], v[144:147]
    ds_read_b128 v[112:115], v22 offset:22528
    v_mfma_f32_16x16x32_bf16 v[172:175], v[116:119], v[48:51], v[172:175]
    buffer_load_dwordx4 v[80:83], v4, s[20:23], s48 offen offset:2048 sc1
    v_mfma_f32_16x16x32_bf16 v[148:151], v[120:123], v[44:47], v[148:151]
    ds_read_b128 v[116:119], v22 offset:23552
    v_mfma_f32_16x16x32_bf16 v[176:179], v[120:123], v[48:51], v[176:179]
    s_waitcnt lgkmcnt(4)
    v_mfma_f32_16x16x32_bf16 v[152:155], v[124:127], v[44:47], v[152:155]
    ds_read_b128 v[120:123], v22 offset:24576
    v_mfma_f32_16x16x32_bf16 v[180:183], v[124:127], v[48:51], v[180:183]
    buffer_load_dwordx4 v[84:87], v4, s[20:23], s47 offen offset:3072 sc1
    v_mfma_f32_16x16x32_bf16 v[156:159], v[128:131], v[44:47], v[156:159]
    ds_read_b128 v[124:127], v22 offset:25600
    v_mfma_f32_16x16x32_bf16 v[184:187], v[128:131], v[48:51], v[184:187]
    s_waitcnt lgkmcnt(4)
    v_mfma_f32_16x16x32_bf16 v[160:163], v[132:135], v[44:47], v[160:163]
    ds_read_b128 v[128:131], v22 offset:26624
    v_mfma_f32_16x16x32_bf16 v[188:191], v[132:135], v[48:51], v[188:191]
    s_waitcnt vmcnt(9) lgkmcnt(4)
    v_mfma_f32_16x16x32_bf16 v[136:139], v[108:111], v[52:55], v[136:139]
    ds_read_b128 v[132:135], v22 offset:27648
    v_mfma_f32_16x16x32_bf16 v[164:167], v[108:111], v[56:59], v[164:167]
    buffer_load_dwordx4 v[88:91], v4, s[20:23], s48 offen offset:3072 sc1
    v_mfma_f32_16x16x32_bf16 v[140:143], v[112:115], v[52:55], v[140:143]
    ds_read_b128 v[108:111], v22 offset:28672
    v_mfma_f32_16x16x32_bf16 v[168:171], v[112:115], v[56:59], v[168:171]
    s_waitcnt lgkmcnt(4)
    v_mfma_f32_16x16x32_bf16 v[144:147], v[116:119], v[52:55], v[144:147]
    ds_read_b128 v[112:115], v22 offset:29696
    v_mfma_f32_16x16x32_bf16 v[172:175], v[116:119], v[56:59], v[172:175]
    s_add_u32 s47, s47, 4096
    buffer_load_dwordx4 v[92:95], v4, s[20:23], s47 offen offset:0 sc1
    v_mfma_f32_16x16x32_bf16 v[148:151], v[120:123], v[52:55], v[148:151]
    ds_read_b128 v[116:119], v22 offset:30720
    v_mfma_f32_16x16x32_bf16 v[176:179], v[120:123], v[56:59], v[176:179]
    s_waitcnt lgkmcnt(4)
    v_mfma_f32_16x16x32_bf16 v[152:155], v[124:127], v[52:55], v[152:155]
    ds_read_b128 v[120:123], v22 offset:31744
    v_mfma_f32_16x16x32_bf16 v[180:183], v[124:127], v[56:59], v[180:183]
    s_add_u32 s48, s48, 4096
    buffer_load_dwordx4 v[96:99], v4, s[20:23], s48 offen offset:0 sc1
    v_mfma_f32_16x16x32_bf16 v[156:159], v[128:131], v[52:55], v[156:159]
    ds_read_b128 v[124:127], v22 offset:32768
    v_mfma_f32_16x16x32_bf16 v[184:187], v[128:131], v[56:59], v[184:187]
    s_waitcnt lgkmcnt(4)
    v_mfma_f32_16x16x32_bf16 v[160:163], v[132:135], v[52:55], v[160:163]
    ds_read_b128 v[128:131], v22 offset:33792
    v_mfma_f32_16x16x32_bf16 v[188:191], v[132:135], v[56:59], v[188:191]
    s_barrier
    s_waitcnt vmcnt(8) lgkmcnt(4)
    v_mfma_f32_16x16x32_bf16 v[136:139], v[108:111], v[60:63], v[136:139]
    ds_read_b128 v[132:135], v22 offset:34816
    v_mfma_f32_16x16x32_bf16 v[164:167], v[108:111], v[64:67], v[164:167]
    buffer_load_dwordx4 v[100:103], v4, s[20:23], s47 offen offset:1024 sc1
    v_mfma_f32_16x16x32_bf16 v[140:143], v[112:115], v[60:63], v[140:143]
    ds_read_b128 v[108:111], v22 offset:35840
    v_mfma_f32_16x16x32_bf16 v[168:171], v[112:115], v[64:67], v[168:171]
    s_waitcnt lgkmcnt(4)
    v_mfma_f32_16x16x32_bf16 v[144:147], v[116:119], v[60:63], v[144:147]
    ds_read_b128 v[112:115], v22 offset:36864
    v_mfma_f32_16x16x32_bf16 v[172:175], v[116:119], v[64:67], v[172:175]
    buffer_load_dwordx4 v[104:107], v4, s[20:23], s48 offen offset:1024 sc1
    v_mfma_f32_16x16x32_bf16 v[148:151], v[120:123], v[60:63], v[148:151]
    ds_read_b128 v[116:119], v22 offset:37888
    v_mfma_f32_16x16x32_bf16 v[176:179], v[120:123], v[64:67], v[176:179]
    s_waitcnt lgkmcnt(4)
    v_mfma_f32_16x16x32_bf16 v[152:155], v[124:127], v[60:63], v[152:155]
    ds_read_b128 v[120:123], v22 offset:38912
    v_mfma_f32_16x16x32_bf16 v[180:183], v[124:127], v[64:67], v[180:183]
    buffer_load_dwordx4 v[28:31], v4, s[20:23], s47 offen offset:2048 sc1
    v_mfma_f32_16x16x32_bf16 v[156:159], v[128:131], v[60:63], v[156:159]
    ds_read_b128 v[124:127], v22 offset:39936
    v_mfma_f32_16x16x32_bf16 v[184:187], v[128:131], v[64:67], v[184:187]
    s_waitcnt lgkmcnt(4)
    v_mfma_f32_16x16x32_bf16 v[160:163], v[132:135], v[60:63], v[160:163]
    ds_read_b128 v[128:131], v22 offset:40960
    v_mfma_f32_16x16x32_bf16 v[188:191], v[132:135], v[64:67], v[188:191]
    s_waitcnt vmcnt(9) lgkmcnt(4)
    v_mfma_f32_16x16x32_bf16 v[136:139], v[108:111], v[68:71], v[136:139]
    ds_read_b128 v[132:135], v22 offset:41984
    v_mfma_f32_16x16x32_bf16 v[164:167], v[108:111], v[72:75], v[164:167]
    buffer_load_dwordx4 v[32:35], v4, s[20:23], s48 offen offset:2048 sc1
    v_mfma_f32_16x16x32_bf16 v[140:143], v[112:115], v[68:71], v[140:143]
    ds_read_b128 v[108:111], v22 offset:43008
    v_mfma_f32_16x16x32_bf16 v[168:171], v[112:115], v[72:75], v[168:171]
    s_waitcnt lgkmcnt(4)
    v_mfma_f32_16x16x32_bf16 v[144:147], v[116:119], v[68:71], v[144:147]
    ds_read_b128 v[112:115], v22 offset:44032
    v_mfma_f32_16x16x32_bf16 v[172:175], v[116:119], v[72:75], v[172:175]
    buffer_load_dwordx4 v[36:39], v4, s[20:23], s47 offen offset:3072 sc1
    v_mfma_f32_16x16x32_bf16 v[148:151], v[120:123], v[68:71], v[148:151]
    ds_read_b128 v[116:119], v22 offset:45056
    v_mfma_f32_16x16x32_bf16 v[176:179], v[120:123], v[72:75], v[176:179]
    s_waitcnt lgkmcnt(4)
    v_mfma_f32_16x16x32_bf16 v[152:155], v[124:127], v[68:71], v[152:155]
    ds_read_b128 v[120:123], v22 offset:46080
    v_mfma_f32_16x16x32_bf16 v[180:183], v[124:127], v[72:75], v[180:183]
    buffer_load_dwordx4 v[40:43], v4, s[20:23], s48 offen offset:3072 sc1
    v_mfma_f32_16x16x32_bf16 v[156:159], v[128:131], v[68:71], v[156:159]
    ds_read_b128 v[124:127], v22 offset:47104
    v_mfma_f32_16x16x32_bf16 v[184:187], v[128:131], v[72:75], v[184:187]
    s_waitcnt lgkmcnt(4)
    v_mfma_f32_16x16x32_bf16 v[160:163], v[132:135], v[68:71], v[160:163]
    ds_read_b128 v[128:131], v22 offset:48128
    v_mfma_f32_16x16x32_bf16 v[188:191], v[132:135], v[72:75], v[188:191]
    s_waitcnt vmcnt(10) lgkmcnt(4)
    v_mfma_f32_16x16x32_bf16 v[136:139], v[108:111], v[76:79], v[136:139]
    ds_read_b128 v[132:135], v22 offset:49152
    v_mfma_f32_16x16x32_bf16 v[164:167], v[108:111], v[80:83], v[164:167]
    s_add_u32 s47, s47, 4096
    buffer_load_dwordx4 v[44:47], v4, s[20:23], s47 offen offset:0 sc1
    v_mfma_f32_16x16x32_bf16 v[140:143], v[112:115], v[76:79], v[140:143]
    ds_read_b128 v[108:111], v22 offset:50176
    v_mfma_f32_16x16x32_bf16 v[168:171], v[112:115], v[80:83], v[168:171]
    s_waitcnt lgkmcnt(4)
    v_mfma_f32_16x16x32_bf16 v[144:147], v[116:119], v[76:79], v[144:147]
    ds_read_b128 v[112:115], v22 offset:51200
    v_mfma_f32_16x16x32_bf16 v[172:175], v[116:119], v[80:83], v[172:175]
    s_add_u32 s48, s48, 4096
    buffer_load_dwordx4 v[48:51], v4, s[20:23], s48 offen offset:0 sc1
    v_mfma_f32_16x16x32_bf16 v[148:151], v[120:123], v[76:79], v[148:151]
    ds_read_b128 v[116:119], v22 offset:52224
    v_mfma_f32_16x16x32_bf16 v[176:179], v[120:123], v[80:83], v[176:179]
    s_waitcnt lgkmcnt(4)
    v_mfma_f32_16x16x32_bf16 v[152:155], v[124:127], v[76:79], v[152:155]
    ds_read_b128 v[120:123], v22 offset:53248
    v_mfma_f32_16x16x32_bf16 v[180:183], v[124:127], v[80:83], v[180:183]
    buffer_load_dwordx4 v[52:55], v4, s[20:23], s47 offen offset:1024 sc1
    v_mfma_f32_16x16x32_bf16 v[156:159], v[128:131], v[76:79], v[156:159]
    ds_read_b128 v[124:127], v22 offset:54272
    v_mfma_f32_16x16x32_bf16 v[184:187], v[128:131], v[80:83], v[184:187]
    s_waitcnt lgkmcnt(4)
    v_mfma_f32_16x16x32_bf16 v[160:163], v[132:135], v[76:79], v[160:163]
    ds_read_b128 v[128:131], v22 offset:55296
    v_mfma_f32_16x16x32_bf16 v[188:191], v[132:135], v[80:83], v[188:191]
    s_waitcnt vmcnt(11) lgkmcnt(4)
    v_mfma_f32_16x16x32_bf16 v[136:139], v[108:111], v[84:87], v[136:139]
    ds_read_b128 v[132:135], v22 offset:56320
    v_mfma_f32_16x16x32_bf16 v[164:167], v[108:111], v[88:91], v[164:167]
    buffer_load_dwordx4 v[56:59], v4, s[20:23], s48 offen offset:1024 sc1
    v_mfma_f32_16x16x32_bf16 v[140:143], v[112:115], v[84:87], v[140:143]
    ds_read_b128 v[108:111], v22 offset:57344
    v_mfma_f32_16x16x32_bf16 v[168:171], v[112:115], v[88:91], v[168:171]
    s_waitcnt lgkmcnt(4)
    v_mfma_f32_16x16x32_bf16 v[144:147], v[116:119], v[84:87], v[144:147]
    ds_read_b128 v[112:115], v22 offset:58368
    v_mfma_f32_16x16x32_bf16 v[172:175], v[116:119], v[88:91], v[172:175]
    buffer_load_dwordx4 v[60:63], v4, s[20:23], s47 offen offset:2048 sc1
    v_mfma_f32_16x16x32_bf16 v[148:151], v[120:123], v[84:87], v[148:151]
    ds_read_b128 v[116:119], v22 offset:59392
    v_mfma_f32_16x16x32_bf16 v[176:179], v[120:123], v[88:91], v[176:179]
    s_waitcnt lgkmcnt(4)
    v_mfma_f32_16x16x32_bf16 v[152:155], v[124:127], v[84:87], v[152:155]
    ds_read_b128 v[120:123], v22 offset:60416
    v_mfma_f32_16x16x32_bf16 v[180:183], v[124:127], v[88:91], v[180:183]
    buffer_load_dwordx4 v[64:67], v4, s[20:23], s48 offen offset:2048 sc1
    v_mfma_f32_16x16x32_bf16 v[156:159], v[128:131], v[84:87], v[156:159]
    ds_read_b128 v[124:127], v22 offset:61440
    v_mfma_f32_16x16x32_bf16 v[184:187], v[128:131], v[88:91], v[184:187]
    s_waitcnt lgkmcnt(4)
    v_mfma_f32_16x16x32_bf16 v[160:163], v[132:135], v[84:87], v[160:163]
    ds_read_b128 v[128:131], v22 offset:62464
    v_mfma_f32_16x16x32_bf16 v[188:191], v[132:135], v[88:91], v[188:191]
    s_waitcnt vmcnt(12) lgkmcnt(4)
    v_mfma_f32_16x16x32_bf16 v[136:139], v[108:111], v[92:95], v[136:139]
    ds_read_b128 v[132:135], v22 offset:63488
    v_mfma_f32_16x16x32_bf16 v[164:167], v[108:111], v[96:99], v[164:167]
    buffer_load_dwordx4 v[68:71], v4, s[20:23], s47 offen offset:3072 sc1
    v_mfma_f32_16x16x32_bf16 v[140:143], v[112:115], v[92:95], v[140:143]
    ds_read_b128 v[108:111], v23 offset:0
    v_mfma_f32_16x16x32_bf16 v[168:171], v[112:115], v[96:99], v[168:171]
    s_waitcnt lgkmcnt(4)
    v_mfma_f32_16x16x32_bf16 v[144:147], v[116:119], v[92:95], v[144:147]
    ds_read_b128 v[112:115], v23 offset:1024
    v_mfma_f32_16x16x32_bf16 v[172:175], v[116:119], v[96:99], v[172:175]
    buffer_load_dwordx4 v[72:75], v4, s[20:23], s48 offen offset:3072 sc1
    v_mfma_f32_16x16x32_bf16 v[148:151], v[120:123], v[92:95], v[148:151]
    ds_read_b128 v[116:119], v23 offset:2048
    v_mfma_f32_16x16x32_bf16 v[176:179], v[120:123], v[96:99], v[176:179]
    s_waitcnt lgkmcnt(4)
    v_mfma_f32_16x16x32_bf16 v[152:155], v[124:127], v[92:95], v[152:155]
    ds_read_b128 v[120:123], v23 offset:3072
    v_mfma_f32_16x16x32_bf16 v[180:183], v[124:127], v[96:99], v[180:183]
    s_add_u32 s47, s47, 4096
    buffer_load_dwordx4 v[76:79], v4, s[20:23], s47 offen offset:0 sc1
    v_mfma_f32_16x16x32_bf16 v[156:159], v[128:131], v[92:95], v[156:159]
    ds_read_b128 v[124:127], v23 offset:4096
    v_mfma_f32_16x16x32_bf16 v[184:187], v[128:131], v[96:99], v[184:187]
    s_waitcnt lgkmcnt(4)
    v_mfma_f32_16x16x32_bf16 v[160:163], v[132:135], v[92:95], v[160:163]
    ds_read_b128 v[128:131], v23 offset:5120
    v_mfma_f32_16x16x32_bf16 v[188:191], v[132:135], v[96:99], v[188:191]
    s_barrier
    s_waitcnt vmcnt(13) lgkmcnt(4)
    v_mfma_f32_16x16x32_bf16 v[136:139], v[108:111], v[100:103], v[136:139]
    ds_read_b128 v[132:135], v23 offset:6144
    v_mfma_f32_16x16x32_bf16 v[164:167], v[108:111], v[104:107], v[164:167]
    s_add_u32 s48, s48, 4096
    buffer_load_dwordx4 v[80:83], v4, s[20:23], s48 offen offset:0 sc1
    v_mfma_f32_16x16x32_bf16 v[140:143], v[112:115], v[100:103], v[140:143]
    ds_read_b128 v[108:111], v23 offset:7168
    v_mfma_f32_16x16x32_bf16 v[168:171], v[112:115], v[104:107], v[168:171]
    s_waitcnt lgkmcnt(4)
    v_mfma_f32_16x16x32_bf16 v[144:147], v[116:119], v[100:103], v[144:147]
    ds_read_b128 v[112:115], v23 offset:8192
    v_mfma_f32_16x16x32_bf16 v[172:175], v[116:119], v[104:107], v[172:175]
    buffer_load_dwordx4 v[84:87], v4, s[20:23], s47 offen offset:1024 sc1
    v_mfma_f32_16x16x32_bf16 v[148:151], v[120:123], v[100:103], v[148:151]
    ds_read_b128 v[116:119], v23 offset:9216
    v_mfma_f32_16x16x32_bf16 v[176:179], v[120:123], v[104:107], v[176:179]
    s_waitcnt lgkmcnt(4)
    v_mfma_f32_16x16x32_bf16 v[152:155], v[124:127], v[100:103], v[152:155]
    ds_read_b128 v[120:123], v23 offset:10240
    v_mfma_f32_16x16x32_bf16 v[180:183], v[124:127], v[104:107], v[180:183]
    buffer_load_dwordx4 v[88:91], v4, s[20:23], s48 offen offset:1024 sc1
    v_mfma_f32_16x16x32_bf16 v[156:159], v[128:131], v[100:103], v[156:159]
    ds_read_b128 v[124:127], v23 offset:11264
    v_mfma_f32_16x16x32_bf16 v[184:187], v[128:131], v[104:107], v[184:187]
    s_waitcnt lgkmcnt(4)
    v_mfma_f32_16x16x32_bf16 v[160:163], v[132:135], v[100:103], v[160:163]
    ds_read_b128 v[128:131], v23 offset:12288
    v_mfma_f32_16x16x32_bf16 v[188:191], v[132:135], v[104:107], v[188:191]
    s_waitcnt vmcnt(14) lgkmcnt(4)
    v_mfma_f32_16x16x32_bf16 v[136:139], v[108:111], v[28:31], v[136:139]
    ds_read_b128 v[132:135], v23 offset:13312
    v_mfma_f32_16x16x32_bf16 v[164:167], v[108:111], v[32:35], v[164:167]
    buffer_load_dwordx4 v[92:95], v4, s[20:23], s47 offen offset:2048 sc1
    v_mfma_f32_16x16x32_bf16 v[140:143], v[112:115], v[28:31], v[140:143]
    ds_read_b128 v[108:111], v23 offset:14336
    v_mfma_f32_16x16x32_bf16 v[168:171], v[112:115], v[32:35], v[168:171]
    s_waitcnt lgkmcnt(4)
    v_mfma_f32_16x16x32_bf16 v[144:147], v[116:119], v[28:31], v[144:147]
    ds_read_b128 v[112:115], v23 offset:15360
    v_mfma_f32_16x16x32_bf16 v[172:175], v[116:119], v[32:35], v[172:175]
    buffer_load_dwordx4 v[96:99], v4, s[20:23], s48 offen offset:2048 sc1
    v_mfma_f32_16x16x32_bf16 v[148:151], v[120:123], v[28:31], v[148:151]
    ds_read_b128 v[116:119], v23 offset:16384
    v_mfma_f32_16x16x32_bf16 v[176:179], v[120:123], v[32:35], v[176:179]
    s_waitcnt lgkmcnt(4)
    v_mfma_f32_16x16x32_bf16 v[152:155], v[124:127], v[28:31], v[152:155]
    ds_read_b128 v[120:123], v23 offset:17408
    v_mfma_f32_16x16x32_bf16 v[180:183], v[124:127], v[32:35], v[180:183]
    buffer_load_dwordx4 v[100:103], v4, s[20:23], s47 offen offset:3072 sc1
    v_mfma_f32_16x16x32_bf16 v[156:159], v[128:131], v[28:31], v[156:159]
    ds_read_b128 v[124:127], v23 offset:18432
    v_mfma_f32_16x16x32_bf16 v[184:187], v[128:131], v[32:35], v[184:187]
    s_waitcnt lgkmcnt(4)
    v_mfma_f32_16x16x32_bf16 v[160:163], v[132:135], v[28:31], v[160:163]
    ds_read_b128 v[128:131], v23 offset:19456
    v_mfma_f32_16x16x32_bf16 v[188:191], v[132:135], v[32:35], v[188:191]
    s_waitcnt vmcnt(15) lgkmcnt(4)
    v_mfma_f32_16x16x32_bf16 v[136:139], v[108:111], v[36:39], v[136:139]
    ds_read_b128 v[132:135], v23 offset:20480
    v_add_f32 v236, v220, v222
    v_mfma_f32_16x16x32_bf16 v[164:167], v[108:111], v[40:43], v[164:167]
    buffer_load_dwordx4 v[104:107], v4, s[20:23], s48 offen offset:3072 sc1
    v_mfma_f32_16x16x32_bf16 v[140:143], v[112:115], v[36:39], v[140:143]
    ds_read_b128 v[108:111], v23 offset:21504
    v_add_f32 v240, v224, v226
    v_mfma_f32_16x16x32_bf16 v[168:171], v[112:115], v[40:43], v[168:171]
    s_waitcnt lgkmcnt(4)
    v_mfma_f32_16x16x32_bf16 v[144:147], v[116:119], v[36:39], v[144:147]
    ds_read_b128 v[112:115], v23 offset:22528
    v_add_f32 v237, v221, v223
    v_mfma_f32_16x16x32_bf16 v[172:175], v[116:119], v[40:43], v[172:175]
    v_mfma_f32_16x16x32_bf16 v[148:151], v[120:123], v[36:39], v[148:151]
    ds_read_b128 v[116:119], v23 offset:23552
    v_add_f32 v241, v225, v227
    v_mfma_f32_16x16x32_bf16 v[176:179], v[120:123], v[40:43], v[176:179]
    s_waitcnt lgkmcnt(4)
    v_mfma_f32_16x16x32_bf16 v[152:155], v[124:127], v[36:39], v[152:155]
    ds_read_b128 v[120:123], v23 offset:24576
    v_mov_b32 v238, v236
    v_mfma_f32_16x16x32_bf16 v[180:183], v[124:127], v[40:43], v[180:183]
    v_mfma_f32_16x16x32_bf16 v[156:159], v[128:131], v[36:39], v[156:159]
    ds_read_b128 v[124:127], v23 offset:25600
    v_mov_b32 v242, v240
    v_mfma_f32_16x16x32_bf16 v[184:187], v[128:131], v[40:43], v[184:187]
    s_waitcnt lgkmcnt(4)
    v_mfma_f32_16x16x32_bf16 v[160:163], v[132:135], v[36:39], v[160:163]
    s_branch Lpg8s
    s_nop 0
Lpg8:
    s_setpc_b64 s[38:39]
Lpg8s:
    ds_read_b128 v[128:131], v23 offset:26624
    v_mfma_f32_16x16x32_bf16 v[188:191], v[132:135], v[40:43], v[188:191]
    s_waitcnt vmcnt(14) lgkmcnt(4)
    v_mfma_f32_16x16x32_bf16 v[136:139], v[108:111], v[44:47], v[136:139]
    ds_read_b128 v[132:135], v23 offset:27648
    v_mov_b32 v239, v237
    v_mfma_f32_16x16x32_bf16 v[164:167], v[108:111], v[48:51], v[164:167]
    v_mfma_f32_16x16x32_bf16 v[140:143], v[112:115], v[44:47], v[140:143]
    ds_read_b128 v[108:111], v23 offset:28672
    v_mov_b32 v243, v241
    v_mfma_f32_16x16x32_bf16 v[168:171], v[112:115], v[48:51], v[168:171]
    s_waitcnt lgkmcnt(4)
    v_mfma_f32_16x16x32_bf16 v[144:147], v[116:119], v[44:47], v[144:147]
    ds_read_b128 v[112:115], v23 offset:29696
    v_permlane32_swap_b32 v236, v238
    v_mfma_f32_16x16x32_bf16 v[172:175], v[116:119], v[48:51], v[172:175]
    v_mfma_f32_16x16x32_bf16 v[148:151], v[120:123], v[44:47], v[148:151]
    ds_read_b128 v[116:119], v23 offset:30720
    v_permlane32_swap_b32 v240, v242
    v_mfma_f32_16x16x32_bf16 v[176:179], v[120:123], v[48:51], v[176:179]
    s_waitcnt lgkmcnt(4)
    v_mfma_f32_16x16x32_bf16 v[152:155], v[124:127], v[44:47], v[152:155]
    ds_read_b128 v[120:123], v23 offset:31744
    v_permlane32_swap_b32 v237, v239
    v_mfma_f32_16x16x32_bf16 v[180:183], v[124:127], v[48:51], v[180:183]
    v_mfma_f32_16x16x32_bf16 v[156:159], v[128:131], v[44:47], v[156:159]
    ds_read_b128 v[124:127], v23 offset:32768
    v_permlane32_swap_b32 v241, v243
    v_mfma_f32_16x16x32_bf16 v[184:187], v[128:131], v[48:51], v[184:187]
    s_waitcnt lgkmcnt(4)
    v_mfma_f32_16x16x32_bf16 v[160:163], v[132:135], v[44:47], v[160:163]
    ds_read_b128 v[128:131], v23 offset:33792
    ds_read_b128 v[192:195], v26 offset:256
    v_mfma_f32_16x16x32_bf16 v[188:191], v[132:135], v[48:51], v[188:191]
    s_waitcnt vmcnt(12) lgkmcnt(4)
    v_mfma_f32_16x16x32_bf16 v[136:139], v[108:111], v[52:55], v[136:139]
    ds_read_b128 v[132:135], v23 offset:34816
    v_add_f32 v236, v236, v238
    v_mfma_f32_16x16x32_bf16 v[164:167], v[108:111], v[56:59], v[164:167]
    v_mfma_f32_16x16x32_bf16 v[140:143], v[112:115], v[52:55], v[140:143]
    ds_read_b128 v[108:111], v23 offset:35840
    v_add_f32 v240, v240, v242
    v_mfma_f32_16x16x32_bf16 v[168:171], v[112:115], v[56:59], v[168:171]
    s_waitcnt lgkmcnt(4)
    v_mfma_f32_16x16x32_bf16 v[144:147], v[116:119], v[52:55], v[144:147]
    ds_read_b128 v[112:115], v23 offset:36864
    v_add_f32 v237, v237, v239
    v_mfma_f32_16x16x32_bf16 v[172:175], v[116:119], v[56:59], v[172:175]
    v_mfma_f32_16x16x32_bf16 v[148:151], v[120:123], v[52:55], v[148:151]
    ds_read_b128 v[116:119], v23 offset:37888
    v_add_f32 v241, v241, v243
    v_mfma_f32_16x16x32_bf16 v[176:179], v[120:123], v[56:59], v[176:179]
    s_waitcnt lgkmcnt(4)
    v_mfma_f32_16x16x32_bf16 v[152:155], v[124:127], v[52:55], v[152:155]
    ds_read_b128 v[120:123], v23 offset:38912
    v_mov_b32 v238, v236
    v_mfma_f32_16x16x32_bf16 v[180:183], v[124:127], v[56:59], v[180:183]
    v_mfma_f32_16x16x32_bf16 v[156:159], v[128:131], v[52:55], v[156:159]
    ds_read_b128 v[124:127], v23 offset:39936
    v_mov_b32 v242, v240
    v_mfma_f32_16x16x32_bf16 v[184:187], v[128:131], v[56:59], v[184:187]
    s_waitcnt lgkmcnt(4)
    v_mfma_f32_16x16x32_bf16 v[160:163], v[132:135], v[52:55], v[160:163]
    ds_read_b128 v[128:131], v23 offset:40960
    ds_read_b128 v[196:199], v26 offset:320
    v_mfma_f32_16x16x32_bf16 v[188:191], v[132:135], v[56:59], v[188:191]
    s_waitcnt vmcnt(10) lgkmcnt(4)
    v_mfma_f32_16x16x32_bf16 v[136:139], v[108:111], v[60:63], v[136:139]
    ds_read_b128 v[132:135], v23 offset:41984
    v_mov_b32 v239, v237
    v_mfma_f32_16x16x32_bf16 v[164:167], v[108:111], v[64:67], v[164:167]
    v_mfma_f32_16x16x32_bf16 v[140:143], v[112:115], v[60:63], v[140:143]
    ds_read_b128 v[108:111], v23 offset:43008
    v_mov_b32 v243, v241
    v_mfma_f32_16x16x32_bf16 v[168:171], v[112:115], v[64:67], v[168:171]
    s_waitcnt lgkmcnt(4)
    v_mfma_f32_16x16x32_bf16 v[144:147], v[116:119], v[60:63], v[144:147]
    ds_read_b128 v[112:115], v23 offset:44032
    v_permlane16_swap_b32 v236, v238
    v_mfma_f32_16x16x32_bf16 v[172:175], v[116:119], v[64:67], v[172:175]
    v_mfma_f32_16x16x32_bf16 v[148:151], v[120:123], v[60:63], v[148:151]
    ds_read_b128 v[116:119], v23 offset:45056
    v_permlane16_swap_b32 v240, v242
    v_mfma_f32_16x16x32_bf16 v[176:179], v[120:123], v[64:67], v[176:179]
    s_waitcnt lgkmcnt(4)
    v_mfma_f32_16x16x32_bf16 v[152:155], v[124:127], v[60:63], v[152:155]
    ds_read_b128 v[120:123], v23 offset:46080
    v_permlane16_swap_b32 v237, v239
    v_mfma_f32_16x16x32_bf16 v[180:183], v[124:127], v[64:67], v[180:183]
    v_mfma_f32_16x16x32_bf16 v[156:159], v[128:131], v[60:63], v[156:159]
    ds_read_b128 v[124:127], v23 offset:47104
    v_permlane16_swap_b32 v241, v243
    v_mfma_f32_16x16x32_bf16 v[184:187], v[128:131], v[64:67], v[184:187]
    s_waitcnt lgkmcnt(4)
    v_mfma_f32_16x16x32_bf16 v[160:163], v[132:135], v[60:63], v[160:163]
    ds_read_b128 v[128:131], v23 offset:48128
    ds_read_b128 v[200:203], v26 offset:384
    v_mfma_f32_16x16x32_bf16 v[188:191], v[132:135], v[64:67], v[188:191]
    s_waitcnt vmcnt(8) lgkmcnt(4)
    v_mfma_f32_16x16x32_bf16 v[136:139], v[108:111], v[68:71], v[136:139]
    ds_read_b128 v[132:135], v23 offset:49152
    v_add_f32 v236, v236, v238
    v_mfma_f32_16x16x32_bf16 v[164:167], v[108:111], v[72:75], v[164:167]
    v_mfma_f32_16x16x32_bf16 v[140:143], v[112:115], v[68:71], v[140:143]
    ds_read_b128 v[108:111], v23 offset:50176
    v_add_f32 v240, v240, v242
    v_mfma_f32_16x16x32_bf16 v[168:171], v[112:115], v[72:75], v[168:171]
    s_waitcnt lgkmcnt(4)
    v_mfma_f32_16x16x32_bf16 v[144:147], v[116:119], v[68:71], v[144:147]
    ds_read_b128 v[112:115], v23 offset:51200
    v_add_f32 v237, v237, v239
    v_mfma_f32_16x16x32_bf16 v[172:175], v[116:119], v[72:75], v[172:175]
    v_mfma_f32_16x16x32_bf16 v[148:151], v[120:123], v[68:71], v[148:151]
    ds_read_b128 v[116:119], v23 offset:52224
    v_add_f32 v241, v241, v243
    v_mfma_f32_16x16x32_bf16 v[176:179], v[120:123], v[72:75], v[176:179]
    s_waitcnt lgkmcnt(4)
    v_mfma_f32_16x16x32_bf16 v[152:155], v[124:127], v[68:71], v[152:155]
    ds_read_b128 v[120:123], v23 offset:53248
    v_mul_f32 v228, 0x3acccccd, v236
    v_mfma_f32_16x16x32_bf16 v[180:183], v[124:127], v[72:75], v[180:183]
    v_mfma_f32_16x16x32_bf16 v[156:159], v[128:131], v[68:71], v[156:159]
    ds_read_b128 v[124:127], v23 offset:54272
    v_mul_f32 v229, 0x3acccccd, v240
    v_mfma_f32_16x16x32_bf16 v[184:187], v[128:131], v[72:75], v[184:187]
    s_waitcnt lgkmcnt(4)
    v_mfma_f32_16x16x32_bf16 v[160:163], v[132:135], v[68:71], v[160:163]
    ds_read_b128 v[128:131], v23 offset:55296
    ds_read_b128 v[204:207], v26 offset:448
    v_mfma_f32_16x16x32_bf16 v[188:191], v[132:135], v[72:75], v[188:191]
    s_barrier
    s_waitcnt vmcnt(6) lgkmcnt(4)
    v_mfma_f32_16x16x32_bf16 v[136:139], v[108:111], v[76:79], v[136:139]
    ds_read_b128 v[132:135], v23 offset:56320
    v_mul_f32 v237, 0x3acccccd, v237
    v_mfma_f32_16x16x32_bf16 v[164:167], v[108:111], v[80:83], v[164:167]
    v_mfma_f32_16x16x32_bf16 v[140:143], v[112:115], v[76:79], v[140:143]
    ds_read_b128 v[108:111], v23 offset:57344
    v_mul_f32 v241, 0x3acccccd, v241
    v_mfma_f32_16x16x32_bf16 v[168:171], v[112:115], v[80:83], v[168:171]
    s_waitcnt lgkmcnt(4)
    v_mfma_f32_16x16x32_bf16 v[144:147], v[116:119], v[76:79], v[144:147]
    ds_read_b128 v[112:115], v23 offset:58368
    v_fma_f32 v237, -v228, v228, v237
    v_mfma_f32_16x16x32_bf16 v[172:175], v[116:119], v[80:83], v[172:175]
    v_mfma_f32_16x16x32_bf16 v[148:151], v[120:123], v[76:79], v[148:151]
    ds_read_b128 v[116:119], v23 offset:59392
    v_fma_f32 v241, -v229, v229, v241
    v_mfma_f32_16x16x32_bf16 v[176:179], v[120:123], v[80:83], v[176:179]
    s_waitcnt lgkmcnt(4)
    v_mfma_f32_16x16x32_bf16 v[152:155], v[124:127], v[76:79], v[152:155]
    ds_read_b128 v[120:123], v23 offset:60416
    v_max_f32 v237, 0, v237
    v_mfma_f32_16x16x32_bf16 v[180:183], v[124:127], v[80:83], v[180:183]
    v_mfma_f32_16x16x32_bf16 v[156:159], v[128:131], v[76:79], v[156:159]
    ds_read_b128 v[124:127], v23 offset:61440
    v_max_f32 v241, 0, v241
    v_mfma_f32_16x16x32_bf16 v[184:187], v[128:131], v[80:83], v[184:187]
    s_waitcnt lgkmcnt(4)
    v_mfma_f32_16x16x32_bf16 v[160:163], v[132:135], v[76:79], v[160:163]
    ds_read_b128 v[128:131], v23 offset:62464
    ds_read_b128 v[208:211], v26 offset:512
    v_mfma_f32_16x16x32_bf16 v[188:191], v[132:135], v[80:83], v[188:191]
    s_waitcnt vmcnt(4) lgkmcnt(4)
    v_mfma_f32_16x16x32_bf16 v[136:139], v[108:111], v[84:87], v[136:139]
    ds_read_b128 v[132:135], v23 offset:63488
    v_add_f32 v237, 0x3727c5ac, v237
    v_mfma_f32_16x16x32_bf16 v[164:167], v[108:111], v[88:91], v[164:167]
    v_mfma_f32_16x16x32_bf16 v[140:143], v[112:115], v[84:87], v[140:143]
    ds_read_b128 v[108:111], v24 offset:0
    v_add_f32 v241, 0x3727c5ac, v241
    v_mfma_f32_16x16x32_bf16 v[168:171], v[112:115], v[88:91], v[168:171]
    s_waitcnt lgkmcnt(4)
    v_mfma_f32_16x16x32_bf16 v[144:147], v[116:119], v[84:87], v[144:147]
    ds_read_b128 v[112:115], v24 offset:1024
    v_rsq_f32 v237, v237
    v_mfma_f32_16x16x32_bf16 v[172:175], v[116:119], v[88:91], v[172:175]
    v_mfma_f32_16x16x32_bf16 v[148:151], v[120:123], v[84:87], v[148:151]
    ds_read_b128 v[116:119], v24 offset:2048
    v_rsq_f32 v241, v241
    v_mfma_f32_16x16x32_bf16 v[176:179], v[120:123], v[88:91], v[176:179]
    s_waitcnt lgkmcnt(4)
    v_mfma_f32_16x16x32_bf16 v[152:155], v[124:127], v[84:87], v[152:155]
    ds_read_b128 v[120:123], v24 offset:3072
    v_mul_f32 v230, v232, v237
    v_mfma_f32_16x16x32_bf16 v[180:183], v[124:127], v[88:91], v[180:183]
    v_mfma_f32_16x16x32_bf16 v[156:159], v[128:131], v[84:87], v[156:159]
    ds_read_b128 v[124:127], v24 offset:4096
    v_mul_f32 v231, v232, v241
    v_mfma_f32_16x16x32_bf16 v[184:187], v[128:131], v[88:91], v[184:187]
    s_waitcnt lgkmcnt(4)
    v_mfma_f32_16x16x32_bf16 v[160:163], v[132:135], v[84:87], v[160:163]
    ds_read_b128 v[128:131], v24 offset:5120
    ds_read_b128 v[212:215], v26 offset:576
    v_mfma_f32_16x16x32_bf16 v[188:191], v[132:135], v[88:91], v[188:191]
    s_waitcnt vmcnt(2) lgkmcnt(4)
    v_mfma_f32_16x16x32_bf16 v[136:139], v[108:111], v[92:95], v[136:139]
    ds_read_b128 v[132:135], v24 offset:6144
    v_mfma_f32_16x16x32_bf16 v[164:167], v[108:111], v[96:99], v[164:167]
    v_mfma_f32_16x16x32_bf16 v[140:143], v[112:115], v[92:95], v[140:143]
    ds_read_b128 v[108:111], v24 offset:7168
    v_mfma_f32_16x16x32_bf16 v[168:171], v[112:115], v[96:99], v[168:171]
    s_waitcnt lgkmcnt(4)
    v_mfma_f32_16x16x32_bf16 v[144:147], v[116:119], v[92:95], v[144:147]
    ds_read_b128 v[112:115], v24 offset:8192
    v_mfma_f32_16x16x32_bf16 v[172:175], v[116:119], v[96:99], v[172:175]
    v_mfma_f32_16x16x32_bf16 v[148:151], v[120:123], v[92:95], v[148:151]
    ds_read_b128 v[116:119], v24 offset:9216
    v_mfma_f32_16x16x32_bf16 v[176:179], v[120:123], v[96:99], v[176:179]
    s_waitcnt lgkmcnt(4)
    v_mfma_f32_16x16x32_bf16 v[152:155], v[124:127], v[92:95], v[152:155]
    ds_read_b128 v[120:123], v24 offset:10240
    v_mfma_f32_16x16x32_bf16 v[180:183], v[124:127], v[96:99], v[180:183]
    v_mfma_f32_16x16x32_bf16 v[156:159], v[128:131], v[92:95], v[156:159]
    ds_read_b128 v[124:127], v24 offset:11264
    v_mfma_f32_16x16x32_bf16 v[184:187], v[128:131], v[96:99], v[184:187]
    s_waitcnt lgkmcnt(4)
    v_mfma_f32_16x16x32_bf16 v[160:163], v[132:135], v[92:95], v[160:163]
    ds_read_b128 v[128:131], v24 offset:12288
    ds_read_b128 v[216:219], v26 offset:640
    v_mfma_f32_16x16x32_bf16 v[188:191], v[132:135], v[96:99], v[188:191]
    s_waitcnt vmcnt(0) lgkmcnt(4)
    v_mfma_f32_16x16x32_bf16 v[136:139], v[108:111], v[100:103], v[136:139]
    ds_read_b128 v[132:135], v24 offset:13312
    v_mfma_f32_16x16x32_bf16 v[164:167], v[108:111], v[104:107], v[164:167]
    v_mfma_f32_16x16x32_bf16 v[140:143], v[112:115], v[100:103], v[140:143]
    v_mfma_f32_16x16x32_bf16 v[168:171], v[112:115], v[104:107], v[168:171]
    s_waitcnt lgkmcnt(3)
    v_mfma_f32_16x16x32_bf16 v[144:147], v[116:119], v[100:103], v[144:147]
    v_mfma_f32_16x16x32_bf16 v[172:175], v[116:119], v[104:107], v[172:175]
    v_mfma_f32_16x16x32_bf16 v[148:151], v[120:123], v[100:103], v[148:151]
    v_mfma_f32_16x16x32_bf16 v[176:179], v[120:123], v[104:107], v[176:179]
    s_waitcnt lgkmcnt(1)
    v_mfma_f32_16x16x32_bf16 v[152:155], v[124:127], v[100:103], v[152:155]
    v_mfma_f32_16x16x32_bf16 v[180:183], v[124:127], v[104:107], v[180:183]
    v_mfma_f32_16x16x32_bf16 v[156:159], v[128:131], v[100:103], v[156:159]
    v_mfma_f32_16x16x32_bf16 v[184:187], v[128:131], v[104:107], v[184:187]
    s_waitcnt lgkmcnt(0)
    v_mfma_f32_16x16x32_bf16 v[160:163], v[132:135], v[100:103], v[160:163]
    v_mfma_f32_16x16x32_bf16 v[188:191], v[132:135], v[104:107], v[188:191]
    s_cmp_lg_u32 s44, 0
    s_barrier
    v_pk_fma_f32 v[136:137], v[228:229], v[192:193], v[136:137] op_sel:[0,0,0] op_sel_hi:[0,1,1] neg_lo:[1,0,0] neg_hi:[1,0,0]
    v_pk_fma_f32 v[138:139], v[228:229], v[194:195], v[138:139] op_sel:[0,0,0] op_sel_hi:[0,1,1] neg_lo:[1,0,0] neg_hi:[1,0,0]
    v_pk_fma_f32 v[140:141], v[228:229], v[196:197], v[140:141] op_sel:[0,0,0] op_sel_hi:[0,1,1] neg_lo:[1,0,0] neg_hi:[1,0,0]
    v_pk_fma_f32 v[142:143], v[228:229], v[198:199], v[142:143] op_sel:[0,0,0] op_sel_hi:[0,1,1] neg_lo:[1,0,0] neg_hi:[1,0,0]
    v_pk_mul_f32 v[136:137], v[230:231], v[136:137] op_sel:[0,0] op_sel_hi:[0,1]
    v_pk_mul_f32 v[138:139], v[230:231], v[138:139] op_sel:[0,0] op_sel_hi:[0,1]
    v_pk_mul_f32 v[140:141], v[230:231], v[140:141] op_sel:[0,0] op_sel_hi:[0,1]
    v_pk_mul_f32 v[142:143], v[230:231], v[142:143] op_sel:[0,0] op_sel_hi:[0,1]
    v_exp_f32 v236, v136
    v_exp_f32 v237, v137
    v_exp_f32 v238, v138
    v_exp_f32 v239, v139
    v_exp_f32 v240, v140
    v_exp_f32 v241, v141
    v_exp_f32 v242, v142
    v_exp_f32 v243, v143
    v_pk_fma_f32 v[236:237], v[236:237], v[232:233], v[232:233] op_sel_hi:[1,0,0]
    v_pk_fma_f32 v[238:239], v[238:239], v[232:233], v[232:233] op_sel_hi:[1,0,0]
    v_pk_fma_f32 v[240:241], v[240:241], v[232:233], v[232:233] op_sel_hi:[1,0,0]
    v_pk_fma_f32 v[242:243], v[242:243], v[232:233], v[232:233] op_sel_hi:[1,0,0]
    v_rcp_f32 v236, v236
    v_rcp_f32 v237, v237
    v_rcp_f32 v238, v238
    v_rcp_f32 v239, v239
    v_rcp_f32 v240, v240
    v_rcp_f32 v241, v241
    v_rcp_f32 v242, v242
    v_rcp_f32 v243, v243
    v_pk_mul_f32 v[136:137], v[136:137], v[236:237]
    v_pk_mul_f32 v[138:139], v[138:139], v[238:239]
    v_pk_mul_f32 v[140:141], v[140:141], v[240:241]
    v_pk_mul_f32 v[142:143], v[142:143], v[242:243]
    v_cvt_pk_bf16_f32 v136, v136, v137
    v_cvt_pk_bf16_f32 v137, v138, v139
    v_cvt_pk_bf16_f32 v138, v140, v141
    v_cvt_pk_bf16_f32 v139, v142, v143
    buffer_store_dwordx4 v[136:139], v4, s[20:23], s52 offen offset:0 sc1
    v_pk_fma_f32 v[164:165], v[228:229], v[192:193], v[164:165] op_sel:[1,0,0] op_sel_hi:[1,1,1] neg_lo:[1,0,0] neg_hi:[1,0,0]
    v_pk_fma_f32 v[166:167], v[228:229], v[194:195], v[166:167] op_sel:[1,0,0] op_sel_hi:[1,1,1] neg_lo:[1,0,0] neg_hi:[1,0,0]
    v_pk_fma_f32 v[168:169], v[228:229], v[196:197], v[168:169] op_sel:[1,0,0] op_sel_hi:[1,1,1] neg_lo:[1,0,0] neg_hi:[1,0,0]
    v_pk_fma_f32 v[170:171], v[228:229], v[198:199], v[170:171] op_sel:[1,0,0] op_sel_hi:[1,1,1] neg_lo:[1,0,0] neg_hi:[1,0,0]
    v_pk_mul_f32 v[164:165], v[230:231], v[164:165] op_sel:[1,0] op_sel_hi:[1,1]
    v_pk_mul_f32 v[166:167], v[230:231], v[166:167] op_sel:[1,0] op_sel_hi:[1,1]
    v_pk_mul_f32 v[168:169], v[230:231], v[168:169] op_sel:[1,0] op_sel_hi:[1,1]
    v_pk_mul_f32 v[170:171], v[230:231], v[170:171] op_sel:[1,0] op_sel_hi:[1,1]
    v_exp_f32 v236, v164
    v_exp_f32 v237, v165
    v_exp_f32 v238, v166
    v_exp_f32 v239, v167
    v_exp_f32 v240, v168
    v_exp_f32 v241, v169
    v_exp_f32 v242, v170
    v_exp_f32 v243, v171
    v_pk_fma_f32 v[236:237], v[236:237], v[232:233], v[232:233] op_sel_hi:[1,0,0]
    v_pk_fma_f32 v[238:239], v[238:239], v[232:233], v[232:233] op_sel_hi:[1,0,0]
    v_pk_fma_f32 v[240:241], v[240:241], v[232:233], v[232:233] op_sel_hi:[1,0,0]
    v_pk_fma_f32 v[242:243], v[242:243], v[232:233], v[232:233] op_sel_hi:[1,0,0]
    v_rcp_f32 v236, v236
    v_rcp_f32 v237, v237
    v_rcp_f32 v238, v238
    v_rcp_f32 v239, v239
    v_rcp_f32 v240, v240
    v_rcp_f32 v241, v241
    v_rcp_f32 v242, v242
    v_rcp_f32 v243, v243
    v_pk_mul_f32 v[164:165], v[164:165], v[236:237]
    v_pk_mul_f32 v[166:167], v[166:167], v[238:239]
    v_pk_mul_f32 v[168:169], v[168:169], v[240:241]
    v_pk_mul_f32 v[170:171], v[170:171], v[242:243]
    v_cvt_pk_bf16_f32 v164, v164, v165
    v_cvt_pk_bf16_f32 v165, v166, v167
    v_cvt_pk_bf16_f32 v166, v168, v169
    v_cvt_pk_bf16_f32 v167, v170, v171
    buffer_store_dwordx4 v[164:167], v4, s[20:23], s53 offen offset:0 sc1
    v_pk_fma_f32 v[144:145], v[228:229], v[200:201], v[144:145] op_sel:[0,0,0] op_sel_hi:[0,1,1] neg_lo:[1,0,0] neg_hi:[1,0,0]
    v_pk_fma_f32 v[146:147], v[228:229], v[202:203], v[146:147] op_sel:[0,0,0] op_sel_hi:[0,1,1] neg_lo:[1,0,0] neg_hi:[1,0,0]
    v_pk_fma_f32 v[148:149], v[228:229], v[204:205], v[148:149] op_sel:[0,0,0] op_sel_hi:[0,1,1] neg_lo:[1,0,0] neg_hi:[1,0,0]
    v_pk_fma_f32 v[150:151], v[228:229], v[206:207], v[150:151] op_sel:[0,0,0] op_sel_hi:[0,1,1] neg_lo:[1,0,0] neg_hi:[1,0,0]
    v_pk_mul_f32 v[144:145], v[230:231], v[144:145] op_sel:[0,0] op_sel_hi:[0,1]
    v_pk_mul_f32 v[146:147], v[230:231], v[146:147] op_sel:[0,0] op_sel_hi:[0,1]
    v_pk_mul_f32 v[148:149], v[230:231], v[148:149] op_sel:[0,0] op_sel_hi:[0,1]
    v_pk_mul_f32 v[150:151], v[230:231], v[150:151] op_sel:[0,0] op_sel_hi:[0,1]
    v_exp_f32 v236, v144
    v_exp_f32 v237, v145
    v_exp_f32 v238, v146
    v_exp_f32 v239, v147
    v_exp_f32 v240, v148
    v_exp_f32 v241, v149
    v_exp_f32 v242, v150
    v_exp_f32 v243, v151
    v_pk_fma_f32 v[236:237], v[236:237], v[232:233], v[232:233] op_sel_hi:[1,0,0]
    v_pk_fma_f32 v[238:239], v[238:239], v[232:233], v[232:233] op_sel_hi:[1,0,0]
    v_pk_fma_f32 v[240:241], v[240:241], v[232:233], v[232:233] op_sel_hi:[1,0,0]
    v_pk_fma_f32 v[242:243], v[242:243], v[232:233], v[232:233] op_sel_hi:[1,0,0]
    v_rcp_f32 v236, v236
    v_rcp_f32 v237, v237
    v_rcp_f32 v238, v238
    v_rcp_f32 v239, v239
    v_rcp_f32 v240, v240
    v_rcp_f32 v241, v241
    v_rcp_f32 v242, v242
    v_rcp_f32 v243, v243
    v_pk_mul_f32 v[144:145], v[144:145], v[236:237]
    v_pk_mul_f32 v[146:147], v[146:147], v[238:239]
    v_pk_mul_f32 v[148:149], v[148:149], v[240:241]
    v_pk_mul_f32 v[150:151], v[150:151], v[242:243]
    v_cvt_pk_bf16_f32 v144, v144, v145
    v_cvt_pk_bf16_f32 v145, v146, v147
    v_cvt_pk_bf16_f32 v146, v148, v149
    v_cvt_pk_bf16_f32 v147, v150, v151
    buffer_store_dwordx4 v[144:147], v4, s[20:23], s52 offen offset:1024 sc1
    v_pk_fma_f32 v[172:173], v[228:229], v[200:201], v[172:173] op_sel:[1,0,0] op_sel_hi:[1,1,1] neg_lo:[1,0,0] neg_hi:[1,0,0]
    v_pk_fma_f32 v[174:175], v[228:229], v[202:203], v[174:175] op_sel:[1,0,0] op_sel_hi:[1,1,1] neg_lo:[1,0,0] neg_hi:[1,0,0]
    v_pk_fma_f32 v[176:177], v[228:229], v[204:205], v[176:177] op_sel:[1,0,0] op_sel_hi:[1,1,1] neg_lo:[1,0,0] neg_hi:[1,0,0]
    v_pk_fma_f32 v[178:179], v[228:229], v[206:207], v[178:179] op_sel:[1,0,0] op_sel_hi:[1,1,1] neg_lo:[1,0,0] neg_hi:[1,0,0]
    v_pk_mul_f32 v[172:173], v[230:231], v[172:173] op_sel:[1,0] op_sel_hi:[1,1]
    v_pk_mul_f32 v[174:175], v[230:231], v[174:175] op_sel:[1,0] op_sel_hi:[1,1]
    v_pk_mul_f32 v[176:177], v[230:231], v[176:177] op_sel:[1,0] op_sel_hi:[1,1]
    v_pk_mul_f32 v[178:179], v[230:231], v[178:179] op_sel:[1,0] op_sel_hi:[1,1]
    v_exp_f32 v236, v172
    v_exp_f32 v237, v173
    v_exp_f32 v238, v174
    v_exp_f32 v239, v175
    v_exp_f32 v240, v176
    v_exp_f32 v241, v177
    v_exp_f32 v242, v178
    v_exp_f32 v243, v179
    v_pk_fma_f32 v[236:237], v[236:237], v[232:233], v[232:233] op_sel_hi:[1,0,0]
    v_pk_fma_f32 v[238:239], v[238:239], v[232:233], v[232:233] op_sel_hi:[1,0,0]
    v_pk_fma_f32 v[240:241], v[240:241], v[232:233], v[232:233] op_sel_hi:[1,0,0]
    v_pk_fma_f32 v[242:243], v[242:243], v[232:233], v[232:233] op_sel_hi:[1,0,0]
    v_rcp_f32 v236, v236
    v_rcp_f32 v237, v237
    v_rcp_f32 v238, v238
    v_rcp_f32 v239, v239
    v_rcp_f32 v240, v240
    v_rcp_f32 v241, v241
    v_rcp_f32 v242, v242
    v_rcp_f32 v243, v243
    v_pk_mul_f32 v[172:173], v[172:173], v[236:237]
    v_pk_mul_f32 v[174:175], v[174:175], v[238:239]
    v_pk_mul_f32 v[176:177], v[176:177], v[240:241]
    v_pk_mul_f32 v[178:179], v[178:179], v[242:243]
    v_cvt_pk_bf16_f32 v172, v172, v173
    v_cvt_pk_bf16_f32 v173, v174, v175
    v_cvt_pk_bf16_f32 v174, v176, v177
    v_cvt_pk_bf16_f32 v175, v178, v179
    buffer_store_dwordx4 v[172:175], v4, s[20:23], s53 offen offset:1024 sc1
    v_pk_fma_f32 v[152:153], v[228:229], v[208:209], v[152:153] op_sel:[0,0,0] op_sel_hi:[0,1,1] neg_lo:[1,0,0] neg_hi:[1,0,0]
    v_pk_fma_f32 v[154:155], v[228:229], v[210:211], v[154:155] op_sel:[0,0,0] op_sel_hi:[0,1,1] neg_lo:[1,0,0] neg_hi:[1,0,0]
    v_pk_fma_f32 v[156:157], v[228:229], v[212:213], v[156:157] op_sel:[0,0,0] op_sel_hi:[0,1,1] neg_lo:[1,0,0] neg_hi:[1,0,0]
    v_pk_fma_f32 v[158:159], v[228:229], v[214:215], v[158:159] op_sel:[0,0,0] op_sel_hi:[0,1,1] neg_lo:[1,0,0] neg_hi:[1,0,0]
    v_pk_mul_f32 v[152:153], v[230:231], v[152:153] op_sel:[0,0] op_sel_hi:[0,1]
    v_pk_mul_f32 v[154:155], v[230:231], v[154:155] op_sel:[0,0] op_sel_hi:[0,1]
    v_pk_mul_f32 v[156:157], v[230:231], v[156:157] op_sel:[0,0] op_sel_hi:[0,1]
    v_pk_mul_f32 v[158:159], v[230:231], v[158:159] op_sel:[0,0] op_sel_hi:[0,1]
    v_exp_f32 v236, v152
    v_exp_f32 v237, v153
    v_exp_f32 v238, v154
    v_exp_f32 v239, v155
    v_exp_f32 v240, v156
    v_exp_f32 v241, v157
    v_exp_f32 v242, v158
    v_exp_f32 v243, v159
    v_pk_fma_f32 v[236:237], v[236:237], v[232:233], v[232:233] op_sel_hi:[1,0,0]
    v_pk_fma_f32 v[238:239], v[238:239], v[232:233], v[232:233] op_sel_hi:[1,0,0]
    v_pk_fma_f32 v[240:241], v[240:241], v[232:233], v[232:233] op_sel_hi:[1,0,0]
    v_pk_fma_f32 v[242:243], v[242:243], v[232:233], v[232:233] op_sel_hi:[1,0,0]
    v_rcp_f32 v236, v236
    v_rcp_f32 v237, v237
    v_rcp_f32 v238, v238
    v_rcp_f32 v239, v239
    v_rcp_f32 v240, v240
    v_rcp_f32 v241, v241
    v_rcp_f32 v242, v242
    v_rcp_f32 v243, v243
    v_pk_mul_f32 v[152:153], v[152:153], v[236:237]
    v_pk_mul_f32 v[154:155], v[154:155], v[238:239]
    v_pk_mul_f32 v[156:157], v[156:157], v[240:241]
    v_pk_mul_f32 v[158:159], v[158:159], v[242:243]
    v_cvt_pk_bf16_f32 v152, v152, v153
    v_cvt_pk_bf16_f32 v153, v154, v155
    v_cvt_pk_bf16_f32 v154, v156, v157
    v_cvt_pk_bf16_f32 v155, v158, v159
    buffer_store_dwordx4 v[152:155], v4, s[20:23], s52 offen offset:2048 sc1
    v_pk_fma_f32 v[180:181], v[228:229], v[208:209], v[180:181] op_sel:[1,0,0] op_sel_hi:[1,1,1] neg_lo:[1,0,0] neg_hi:[1,0,0]
    v_pk_fma_f32 v[182:183], v[228:229], v[210:211], v[182:183] op_sel:[1,0,0] op_sel_hi:[1,1,1] neg_lo:[1,0,0] neg_hi:[1,0,0]
    v_pk_fma_f32 v[184:185], v[228:229], v[212:213], v[184:185] op_sel:[1,0,0] op_sel_hi:[1,1,1] neg_lo:[1,0,0] neg_hi:[1,0,0]
    v_pk_fma_f32 v[186:187], v[228:229], v[214:215], v[186:187] op_sel:[1,0,0] op_sel_hi:[1,1,1] neg_lo:[1,0,0] neg_hi:[1,0,0]
    v_pk_mul_f32 v[180:181], v[230:231], v[180:181] op_sel:[1,0] op_sel_hi:[1,1]
    v_pk_mul_f32 v[182:183], v[230:231], v[182:183] op_sel:[1,0] op_sel_hi:[1,1]
    v_pk_mul_f32 v[184:185], v[230:231], v[184:185] op_sel:[1,0] op_sel_hi:[1,1]
    v_pk_mul_f32 v[186:187], v[230:231], v[186:187] op_sel:[1,0] op_sel_hi:[1,1]
    v_exp_f32 v236, v180
    v_exp_f32 v237, v181
    v_exp_f32 v238, v182
    v_exp_f32 v239, v183
    v_exp_f32 v240, v184
    v_exp_f32 v241, v185
    v_exp_f32 v242, v186
    v_exp_f32 v243, v187
    v_pk_fma_f32 v[236:237], v[236:237], v[232:233], v[232:233] op_sel_hi:[1,0,0]
    v_pk_fma_f32 v[238:239], v[238:239], v[232:233], v[232:233] op_sel_hi:[1,0,0]
    v_pk_fma_f32 v[240:241], v[240:241], v[232:233], v[232:233] op_sel_hi:[1,0,0]
    v_pk_fma_f32 v[242:243], v[242:243], v[232:233], v[232:233] op_sel_hi:[1,0,0]
    v_rcp_f32 v236, v236
    v_rcp_f32 v237, v237
    v_rcp_f32 v238, v238
    v_rcp_f32 v239, v239
    v_rcp_f32 v240, v240
    v_rcp_f32 v241, v241
    v_rcp_f32 v242, v242
    v_rcp_f32 v243, v243
    v_pk_mul_f32 v[180:181], v[180:181], v[236:237]
    v_pk_mul_f32 v[182:183], v[182:183], v[238:239]
    v_pk_mul_f32 v[184:185], v[184:185], v[240:241]
    v_pk_mul_f32 v[186:187], v[186:187], v[242:243]
    v_cvt_pk_bf16_f32 v180, v180, v181
    v_cvt_pk_bf16_f32 v181, v182, v183
    v_cvt_pk_bf16_f32 v182, v184, v185
    v_cvt_pk_bf16_f32 v183, v186, v187
    buffer_store_dwordx4 v[180:183], v4, s[20:23], s53 offen offset:2048 sc1
    s_cmp_ge_u32 s46, 12
    s_cbranch_scc1 Lp4_done
    v_pk_fma_f32 v[160:161], v[228:229], v[216:217], v[160:161] op_sel:[0,0,0] op_sel_hi:[0,1,1] neg_lo:[1,0,0] neg_hi:[1,0,0]
    v_pk_fma_f32 v[162:163], v[228:229], v[218:219], v[162:163] op_sel:[0,0,0] op_sel_hi:[0,1,1] neg_lo:[1,0,0] neg_hi:[1,0,0]
    v_pk_fma_f32 v[188:189], v[228:229], v[216:217], v[188:189] op_sel:[1,0,0] op_sel_hi:[1,1,1] neg_lo:[1,0,0] neg_hi:[1,0,0]
    v_pk_fma_f32 v[190:191], v[228:229], v[218:219], v[190:191] op_sel:[1,0,0] op_sel_hi:[1,1,1] neg_lo:[1,0,0] neg_hi:[1,0,0]
    v_pk_mul_f32 v[160:161], v[230:231], v[160:161] op_sel:[0,0] op_sel_hi:[0,1]
    v_pk_mul_f32 v[162:163], v[230:231], v[162:163] op_sel:[0,0] op_sel_hi:[0,1]
    v_pk_mul_f32 v[188:189], v[230:231], v[188:189] op_sel:[1,0] op_sel_hi:[1,1]
    v_pk_mul_f32 v[190:191], v[230:231], v[190:191] op_sel:[1,0] op_sel_hi:[1,1]
    v_exp_f32 v236, v160
    v_exp_f32 v237, v161
    v_exp_f32 v238, v162
    v_exp_f32 v239, v163
    v_exp_f32 v240, v188
    v_exp_f32 v241, v189
    v_exp_f32 v242, v190
    v_exp_f32 v243, v191
    v_pk_fma_f32 v[236:237], v[236:237], v[232:233], v[232:233] op_sel_hi:[1,0,0]
    v_pk_fma_f32 v[238:239], v[238:239], v[232:233], v[232:233] op_sel_hi:[1,0,0]
    v_pk_fma_f32 v[240:241], v[240:241], v[232:233], v[232:233] op_sel_hi:[1,0,0]
    v_pk_fma_f32 v[242:243], v[242:243], v[232:233], v[232:233] op_sel_hi:[1,0,0]
    v_rcp_f32 v236, v236
    v_rcp_f32 v237, v237
    v_rcp_f32 v238, v238
    v_rcp_f32 v239, v239
    v_rcp_f32 v240, v240
    v_rcp_f32 v241, v241
    v_rcp_f32 v242, v242
    v_rcp_f32 v243, v243
    v_pk_mul_f32 v[160:161], v[160:161], v[236:237]
    v_pk_mul_f32 v[162:163], v[162:163], v[238:239]
    v_pk_mul_f32 v[188:189], v[188:189], v[240:241]
    v_pk_mul_f32 v[190:191], v[190:191], v[242:243]
    v_cvt_pk_bf16_f32 v160, v160, v161
    v_cvt_pk_bf16_f32 v161, v162, v163
    v_cvt_pk_bf16_f32 v162, v188, v189
    v_cvt_pk_bf16_f32 v163, v190, v191
    s_cmp_lg_u32 s44, 0
    s_nop 0
    v_permlane32_swap_b32 v160, v162
    v_permlane32_swap_b32 v161, v163
    buffer_store_dwordx4 v[160:163], v25, s[20:23], s54 offen sc1
Lp4_done:
    s_mov_b32 s38, s55
    s_lshr_b32 s34, s42, 1
    s_lshl_b32 s34, s34, 7
    s_add_u32 s34, s34, 25690176
    v_lshl_add_u32 v5, v21, 2, s34
    s_and_b32 s35, s33, 1
    s_mul_i32 s45, s42, 54
    s_xor_b32 s34, s42, 1
    s_mul_i32 s46, s34, 54
    s_add_u32 s45, s45, s35
    s_add_u32 s46, s46, s35
    s_lshl_b32 s45, s45, 10
    s_lshl_b32 s46, s46, 10
    s_add_u32 s45, s45, 13238272
    s_add_u32 s46, s46, 13238272
    s_mul_i32 s35, s35, 5120
    s_add_u32 s35, s35, 10240
    v_add_u32 v22, s35, v4
    v_add_u32 v23, 61440, v22
    v_add_u32 v24, 61440, v23
    v_lshlrev_b32 v148, 16, v10
    v_and_b32 v149, s43, v10
    v_lshlrev_b32 v150, 16, v11
    v_and_b32 v151, s43, v11
    v_lshlrev_b32 v152, 16, v12
    v_and_b32 v153, s43, v12
    v_lshlrev_b32 v154, 16, v13
    v_and_b32 v155, s43, v13
    v_lshlrev_b32 v156, 16, v14
    v_and_b32 v157, s43, v14
    v_lshlrev_b32 v158, 16, v15
    v_and_b32 v159, s43, v15
    v_lshlrev_b32 v160, 16, v16
    v_and_b32 v161, s43, v16
    v_lshlrev_b32 v162, 16, v17
    v_and_b32 v163, s43, v17
    v_lshlrev_b32 v164, 16, v18
    v_and_b32 v165, s43, v18
    v_lshlrev_b32 v166, 16, v19
    v_and_b32 v167, s43, v19
    v_mov_b32 v6, 1
    s_cmp_lg_u32 s44, 0
    s_mov_b64 exec, 1
    s_waitcnt vmcnt(0)
    s_cbranch_scc1 Lw_44
    buffer_store_dword v6, v4, s[20:23], s38 offen
Lw_44b:
    s_mov_b64 exec, -1
    s_mov_b32 s37, 0
    buffer_load_dword v8, v5, s[20:23], 0 offen sc1
Lpoll_45:
    s_waitcnt vmcnt(0)
    v_cmp_gt_u32 vcc, 1, v8
    s_and_b64 exec, exec, vcc
    s_cbranch_scc0 Lpolle_46
    buffer_load_dword v8, v5, s[20:23], 0 offen sc1
    s_add_u32 s37, s37, 1
    s_cmp_lt_u32 s37, 0x200000
    s_cbranch_scc1 Lpoll_45
Lpolle_46:
    s_mov_b64 exec, -1
    buffer_load_dwordx4 v[32:35], v4, s[20:23], s45 offen offset:0 sc1
    buffer_load_dwordx4 v[36:39], v4, s[20:23], s46 offen offset:0 sc1
    buffer_load_dwordx4 v[40:43], v4, s[20:23], s45 offen offset:2048 sc1
    buffer_load_dwordx4 v[44:47], v4, s[20:23], s46 offen offset:2048 sc1
    s_add_u32 s45, s45, 4096
    buffer_load_dwordx4 v[48:51], v4, s[20:23], s45 offen offset:0 sc1
    s_add_u32 s46, s46, 4096
    buffer_load_dwordx4 v[52:55], v4, s[20:23], s46 offen offset:0 sc1
    s_barrier
    ds_read_b128 v[128:131], v22 offset:0
    ds_read_b128 v[132:135], v22 offset:1024
    ds_read_b128 v[136:139], v22 offset:2048
    ds_read_b128 v[140:143], v22 offset:3072
    buffer_load_dwordx4 v[56:59], v4, s[20:23], s45 offen offset:2048 sc1
    buffer_load_dwordx4 v[60:63], v4, s[20:23], s46 offen offset:2048 sc1
    s_add_u32 s45, s45, 4096
    buffer_load_dwordx4 v[64:67], v4, s[20:23], s45 offen offset:0 sc1
    s_add_u32 s46, s46, 4096
    buffer_load_dwordx4 v[68:71], v4, s[20:23], s46 offen offset:0 sc1
    buffer_load_dwordx4 v[72:75], v4, s[20:23], s45 offen offset:2048 sc1
    buffer_load_dwordx4 v[76:79], v4, s[20:23], s46 offen offset:2048 sc1
    s_add_u32 s45, s45, 4096
    buffer_load_dwordx4 v[80:83], v4, s[20:23], s45 offen offset:0 sc1
    s_add_u32 s46, s46, 4096
    buffer_load_dwordx4 v[84:87], v4, s[20:23], s46 offen offset:0 sc1
    buffer_load_dwordx4 v[88:91], v4, s[20:23], s45 offen offset:2048 sc1
    buffer_load_dwordx4 v[92:95], v4, s[20:23], s46 offen offset:2048 sc1
    s_waitcnt vmcnt(14) lgkmcnt(2)
    v_mfma_f32_16x16x32_bf16 v[168:171], v[128:131], v[36:39], 0
    ds_read_b128 v[144:147], v22 offset:4096
    v_mfma_f32_16x16x32_bf16 v[148:151], v[128:131], v[32:35], v[148:151]
    s_add_u32 s45, s45, 4096
    buffer_load_dwordx4 v[96:99], v4, s[20:23], s45 offen offset:0 sc1
    v_mfma_f32_16x16x32_bf16 v[172:175], v[132:135], v[36:39], 0
    ds_read_b128 v[128:131], v22 offset:10240
    v_mfma_f32_16x16x32_bf16 v[152:155], v[132:135], v[32:35], v[152:155]
    s_waitcnt lgkmcnt(2)
    v_mfma_f32_16x16x32_bf16 v[176:179], v[136:139], v[36:39], 0
    ds_read_b128 v[132:135], v22 offset:11264
    v_mfma_f32_16x16x32_bf16 v[156:159], v[136:139], v[32:35], v[156:159]
    s_add_u32 s46, s46, 4096
    buffer_load_dwordx4 v[100:103], v4, s[20:23], s46 offen offset:0 sc1
    v_mfma_f32_16x16x32_bf16 v[180:183], v[140:143], v[36:39], 0
    ds_read_b128 v[136:139], v22 offset:12288
    v_mfma_f32_16x16x32_bf16 v[160:163], v[140:143], v[32:35], v[160:163]
    s_waitcnt lgkmcnt(2)
    v_mfma_f32_16x16x32_bf16 v[184:187], v[144:147], v[36:39], 0
    ds_read_b128 v[140:143], v22 offset:13312
    v_mfma_f32_16x16x32_bf16 v[164:167], v[144:147], v[32:35], v[164:167]
    buffer_load_dwordx4 v[104:107], v4, s[20:23], s45 offen offset:2048 sc1
    s_waitcnt vmcnt(15) lgkmcnt(2)
    v_mfma_f32_16x16x32_bf16 v[168:171], v[128:131], v[44:47], v[168:171]
    ds_read_b128 v[144:147], v22 offset:14336
    v_mfma_f32_16x16x32_bf16 v[148:151], v[128:131], v[40:43], v[148:151]
    buffer_load_dwordx4 v[108:111], v4, s[20:23], s46 offen offset:2048 sc1
    v_mfma_f32_16x16x32_bf16 v[172:175], v[132:135], v[44:47], v[172:175]
    ds_read_b128 v[128:131], v22 offset:20480
    v_mfma_f32_16x16x32_bf16 v[152:155], v[132:135], v[40:43], v[152:155]
    s_waitcnt lgkmcnt(2)
    v_mfma_f32_16x16x32_bf16 v[176:179], v[136:139], v[44:47], v[176:179]
    ds_read_b128 v[132:135], v22 offset:21504
    v_mfma_f32_16x16x32_bf16 v[156:159], v[136:139], v[40:43], v[156:159]
    s_branch Lpg9s
    s_nop 0
Lpg9:
    s_setpc_b64 s[38:39]
Lpg9s:
    s_add_u32 s45, s45, 4096
    buffer_load_dwordx4 v[112:115], v4, s[20:23], s45 offen offset:0 sc1
    v_mfma_f32_16x16x32_bf16 v[180:183], v[140:143], v[44:47], v[180:183]
    ds_read_b128 v[136:139], v22 offset:22528
    v_mfma_f32_16x16x32_bf16 v[160:163], v[140:143], v[40:43], v[160:163]
    s_waitcnt lgkmcnt(2)
    v_mfma_f32_16x16x32_bf16 v[184:187], v[144:147], v[44:47], v[184:187]
    ds_read_b128 v[140:143], v22 offset:23552
    v_mfma_f32_16x16x32_bf16 v[164:167], v[144:147], v[40:43], v[164:167]
    s_add_u32 s46, s46, 4096
    buffer_load_dwordx4 v[116:119], v4, s[20:23], s46 offen offset:0 sc1
    s_waitcnt vmcnt(16) lgkmcnt(2)
    v_mfma_f32_16x16x32_bf16 v[168:171], v[128:131], v[52:55], v[168:171]
    ds_read_b128 v[144:147], v22 offset:24576
    v_mfma_f32_16x16x32_bf16 v[148:151], v[128:131], v[48:51], v[148:151]
    buffer_load_dwordx4 v[120:123], v4, s[20:23], s45 offen offset:2048 sc1
    v_mfma_f32_16x16x32_bf16 v[172:175], v[132:135], v[52:55], v[172:175]
    ds_read_b128 v[128:131], v22 offset:30720
    v_mfma_f32_16x16x32_bf16 v[152:155], v[132:135], v[48:51], v[152:155]
    s_waitcnt lgkmcnt(2)
    v_mfma_f32_16x16x32_bf16 v[176:179], v[136:139], v[52:55], v[176:179]
    ds_read_b128 v[132:135], v22 offset:31744
    v_mfma_f32_16x16x32_bf16 v[156:159], v[136:139], v[48:51], v[156:159]
    buffer_load_dwordx4 v[124:127], v4, s[20:23], s46 offen offset:2048 sc1
    v_mfma_f32_16x16x32_bf16 v[180:183], v[140:143], v[52:55], v[180:183]
    ds_read_b128 v[136:139], v22 offset:32768
    v_mfma_f32_16x16x32_bf16 v[160:163], v[140:143], v[48:51], v[160:163]
    s_waitcnt lgkmcnt(2)
    v_mfma_f32_16x16x32_bf16 v[184:187], v[144:147], v[52:55], v[184:187]
    ds_read_b128 v[140:143], v22 offset:33792
    v_mfma_f32_16x16x32_bf16 v[164:167], v[144:147], v[48:51], v[164:167]
    s_add_u32 s45, s45, 4096
    buffer_load_dwordx4 v[32:35], v4, s[20:23], s45 offen offset:0 sc1
    s_barrier
    s_waitcnt vmcnt(17) lgkmcnt(2)
    v_mfma_f32_16x16x32_bf16 v[168:171], v[128:131], v[60:63], v[168:171]
    ds_read_b128 v[144:147], v22 offset:34816
    v_mfma_f32_16x16x32_bf16 v[148:151], v[128:131], v[56:59], v[148:151]
    s_add_u32 s46, s46, 4096
    buffer_load_dwordx4 v[36:39], v4, s[20:23], s46 offen offset:0 sc1
    v_mfma_f32_16x16x32_bf16 v[172:175], v[132:135], v[60:63], v[172:175]
    ds_read_b128 v[128:131], v22 offset:40960
    v_mfma_f32_16x16x32_bf16 v[152:155], v[132:135], v[56:59], v[152:155]
    s_waitcnt lgkmcnt(2)
    v_mfma_f32_16x16x32_bf16 v[176:179], v[136:139], v[60:63], v[176:179]
    ds_read_b128 v[132:135], v22 offset:41984
    v_mfma_f32_16x16x32_bf16 v[156:159], v[136:139], v[56:59], v[156:159]
    buffer_load_dwordx4 v[40:43], v4, s[20:23], s45 offen offset:2048 sc1
    v_mfma_f32_16x16x32_bf16 v[180:183], v[140:143], v[60:63], v[180:183]
    ds_read_b128 v[136:139], v22 offset:43008
    v_mfma_f32_16x16x32_bf16 v[160:163], v[140:143], v[56:59], v[160:163]
    s_waitcnt lgkmcnt(2)
    v_mfma_f32_16x16x32_bf16 v[184:187], v[144:147], v[60:63], v[184:187]
    ds_read_b128 v[140:143], v22 offset:44032
    v_mfma_f32_16x16x32_bf16 v[164:167], v[144:147], v[56:59], v[164:167]
    buffer_load_dwordx4 v[44:47], v4, s[20:23], s46 offen offset:2048 sc1
    s_waitcnt vmcnt(18) lgkmcnt(2)
    v_mfma_f32_16x16x32_bf16 v[168:171], v[128:131], v[68:71], v[168:171]
    ds_read_b128 v[144:147], v22 offset:45056
    v_mfma_f32_16x16x32_bf16 v[148:151], v[128:131], v[64:67], v[148:151]
    s_add_u32 s45, s45, 4096
    buffer_load_dwordx4 v[48:51], v4, s[20:23], s45 offen offset:0 sc1
    v_mfma_f32_16x16x32_bf16 v[172:175], v[132:135], v[68:71], v[172:175]
    ds_read_b128 v[128:131], v22 offset:51200
    v_mfma_f32_16x16x32_bf16 v[152:155], v[132:135], v[64:67], v[152:155]
    s_waitcnt lgkmcnt(2)
    v_mfma_f32_16x16x32_bf16 v[176:179], v[136:139], v[68:71], v[176:179]
    ds_read_b128 v[132:135], v22 offset:52224
    v_mfma_f32_16x16x32_bf16 v[156:159], v[136:139], v[64:67], v[156:159]
    s_add_u32 s46, s46, 4096
    buffer_load_dwordx4 v[52:55], v4, s[20:23], s46 offen offset:0 sc1
    v_mfma_f32_16x16x32_bf16 v[180:183], v[140:143], v[68:71], v[180:183]
    ds_read_b128 v[136:139], v22 offset:53248
    v_mfma_f32_16x16x32_bf16 v[160:163], v[140:143], v[64:67], v[160:163]
    s_waitcnt lgkmcnt(2)
    v_mfma_f32_16x16x32_bf16 v[184:187], v[144:147], v[68:71], v[184:187]
    ds_read_b128 v[140:143], v22 offset:54272
    v_mfma_f32_16x16x32_bf16 v[164:167], v[144:147], v[64:67], v[164:167]
    buffer_load_dwordx4 v[56:59], v4, s[20:23], s45 offen offset:2048 sc1
    s_waitcnt vmcnt(19) lgkmcnt(2)
    v_mfma_f32_16x16x32_bf16 v[168:171], v[128:131], v[76:79], v[168:171]
    ds_read_b128 v[144:147], v22 offset:55296
    v_mfma_f32_16x16x32_bf16 v[148:151], v[128:131], v[72:75], v[148:151]
    buffer_load_dwordx4 v[60:63], v4, s[20:23], s46 offen offset:2048 sc1
    v_mfma_f32_16x16x32_bf16 v[172:175], v[132:135], v[76:79], v[172:175]
    ds_read_b128 v[128:131], v23 offset:0
    v_mfma_f32_16x16x32_bf16 v[152:155], v[132:135], v[72:75], v[152:155]
    s_waitcnt lgkmcnt(2)
    v_mfma_f32_16x16x32_bf16 v[176:179], v[136:139], v[76:79], v[176:179]
    ds_read_b128 v[132:135], v23 offset:1024
    v_mfma_f32_16x16x32_bf16 v[156:159], v[136:139], v[72:75], v[156:159]
    s_add_u32 s45, s45, 4096
    buffer_load_dwordx4 v[64:67], v4, s[20:23], s45 offen offset:0 sc1
    v_mfma_f32_16x16x32_bf16 v[180:183], v[140:143], v[76:79], v[180:183]
    ds_read_b128 v[136:139], v23 offset:2048
    v_mfma_f32_16x16x32_bf16 v[160:163], v[140:143], v[72:75], v[160:163]
    s_waitcnt lgkmcnt(2)
    v_mfma_f32_16x16x32_bf16 v[184:187], v[144:147], v[76:79], v[184:187]
    ds_read_b128 v[140:143], v23 offset:3072
    v_mfma_f32_16x16x32_bf16 v[164:167], v[144:147], v[72:75], v[164:167]
    s_add_u32 s46, s46, 4096
    buffer_load_dwordx4 v[68:71], v4, s[20:23], s46 offen offset:0 sc1
    s_barrier
    s_waitcnt vmcnt(20) lgkmcnt(2)
    v_mfma_f32_16x16x32_bf16 v[168:171], v[128:131], v[84:87], v[168:171]
    ds_read_b128 v[144:147], v23 offset:4096
    v_mfma_f32_16x16x32_bf16 v[148:151], v[128:131], v[80:83], v[148:151]
    buffer_load_dwordx4 v[72:75], v4, s[20:23], s45 offen offset:2048 sc1
    v_mfma_f32_16x16x32_bf16 v[172:175], v[132:135], v[84:87], v[172:175]
    ds_read_b128 v[128:131], v23 offset:10240
    v_mfma_f32_16x16x32_bf16 v[152:155], v[132:135], v[80:83], v[152:155]
    s_waitcnt lgkmcnt(2)
    v_mfma_f32_16x16x32_bf16 v[176:179], v[136:139], v[84:87], v[176:179]
    ds_read_b128 v[132:135], v23 offset:11264
    v_mfma_f32_16x16x32_bf16 v[156:159], v[136:139], v[80:83], v[156:159]
    buffer_load_dwordx4 v[76:79], v4, s[20:23], s46 offen offset:2048 sc1
    v_mfma_f32_16x16x32_bf16 v[180:183], v[140:143], v[84:87], v[180:183]
    ds_read_b128 v[136:139], v23 offset:12288
    v_mfma_f32_16x16x32_bf16 v[160:163], v[140:143], v[80:83], v[160:163]
    s_waitcnt lgkmcnt(2)
    v_mfma_f32_16x16x32_bf16 v[184:187], v[144:147], v[84:87], v[184:187]
    ds_read_b128 v[140:143], v23 offset:13312
    v_mfma_f32_16x16x32_bf16 v[164:167], v[144:147], v[80:83], v[164:167]
    s_waitcnt vmcnt(20) lgkmcnt(2)
    v_mfma_f32_16x16x32_bf16 v[168:171], v[128:131], v[92:95], v[168:171]
    ds_read_b128 v[144:147], v23 offset:14336
    v_mfma_f32_16x16x32_bf16 v[148:151], v[128:131], v[88:91], v[148:151]
    s_add_u32 s45, s45, 4096
    buffer_load_dwordx4 v[80:83], v4, s[20:23], s45 offen offset:0 sc1
    v_mfma_f32_16x16x32_bf16 v[172:175], v[132:135], v[92:95], v[172:175]
    ds_read_b128 v[128:131], v23 offset:20480
    v_mfma_f32_16x16x32_bf16 v[152:155], v[132:135], v[88:91], v[152:155]
    s_waitcnt lgkmcnt(2)
    v_mfma_f32_16x16x32_bf16 v[176:179], v[136:139], v[92:95], v[176:179]
    ds_read_b128 v[132:135], v23 offset:21504
    v_mfma_f32_16x16x32_bf16 v[156:159], v[136:139], v[88:91], v[156:159]
    s_add_u32 s46, s46, 4096
    buffer_load_dwordx4 v[84:87], v4, s[20:23], s46 offen offset:0 sc1
    v_mfma_f32_16x16x32_bf16 v[180:183], v[140:143], v[92:95], v[180:183]
    ds_read_b128 v[136:139], v23 offset:22528
    v_mfma_f32_16x16x32_bf16 v[160:163], v[140:143], v[88:91], v[160:163]
    s_waitcnt lgkmcnt(2)
    v_mfma_f32_16x16x32_bf16 v[184:187], v[144:147], v[92:95], v[184:187]
    ds_read_b128 v[140:143], v23 offset:23552
    v_mfma_f32_16x16x32_bf16 v[164:167], v[144:147], v[88:91], v[164:167]
    s_waitcnt vmcnt(20) lgkmcnt(2)
    v_mfma_f32_16x16x32_bf16 v[168:171], v[128:131], v[100:103], v[168:171]
    ds_read_b128 v[144:147], v23 offset:24576
    v_mfma_f32_16x16x32_bf16 v[148:151], v[128:131], v[96:99], v[148:151]
    buffer_load_dwordx4 v[88:91], v4, s[20:23], s45 offen offset:2048 sc1
    v_mfma_f32_16x16x32_bf16 v[172:175], v[132:135], v[100:103], v[172:175]
    ds_read_b128 v[128:131], v23 offset:30720
    v_mfma_f32_16x16x32_bf16 v[152:155], v[132:135], v[96:99], v[152:155]
    s_waitcnt lgkmcnt(2)
    v_mfma_f32_16x16x32_bf16 v[176:179], v[136:139], v[100:103], v[176:179]
    ds_read_b128 v[132:135], v23 offset:31744
    v_mfma_f32_16x16x32_bf16 v[156:159], v[136:139], v[96:99], v[156:159]
    buffer_load_dwordx4 v[92:95], v4, s[20:23], s46 offen offset:2048 sc1
    v_mfma_f32_16x16x32_bf16 v[180:183], v[140:143], v[100:103], v[180:183]
    ds_read_b128 v[136:139], v23 offset:32768
    v_mfma_f32_16x16x32_bf16 v[160:163], v[140:143], v[96:99], v[160:163]
    s_waitcnt lgkmcnt(2)
    v_mfma_f32_16x16x32_bf16 v[184:187], v[144:147], v[100:103], v[184:187]
    ds_read_b128 v[140:143], v23 offset:33792
    v_mfma_f32_16x16x32_bf16 v[164:167], v[144:147], v[96:99], v[164:167]
    s_barrier
    s_waitcnt vmcnt(20) lgkmcnt(2)
    v_mfma_f32_16x16x32_bf16 v[168:171], v[128:131], v[108:111], v[168:171]
    ds_read_b128 v[144:147], v23 offset:34816
    v_mfma_f32_16x16x32_bf16 v[148:151], v[128:131], v[104:107], v[148:151]
    s_add_u32 s45, s45, 4096
    buffer_load_dwordx4 v[96:99], v4, s[20:23], s45 offen offset:0 sc1
    v_mfma_f32_16x16x32_bf16 v[172:175], v[132:135], v[108:111], v[172:175]
    ds_read_b128 v[128:131], v23 offset:40960
    v_mfma_f32_16x16x32_bf16 v[152:155], v[132:135], v[104:107], v[152:155]
    s_waitcnt lgkmcnt(2)
    v_mfma_f32_16x16x32_bf16 v[176:179], v[136:139], v[108:111], v[176:179]
    ds_read_b128 v[132:135], v23 offset:41984
    v_mfma_f32_16x16x32_bf16 v[156:159], v[136:139], v[104:107], v[156:159]
    s_add_u32 s46, s46, 4096
    buffer_load_dwordx4 v[100:103], v4, s[20:23], s46 offen offset:0 sc1
    v_mfma_f32_16x16x32_bf16 v[180:183], v[140:143], v[108:111], v[180:183]
    ds_read_b128 v[136:139], v23 offset:43008
    v_mfma_f32_16x16x32_bf16 v[160:163], v[140:143], v[104:107], v[160:163]
    s_waitcnt lgkmcnt(2)
    v_mfma_f32_16x16x32_bf16 v[184:187], v[144:147], v[108:111], v[184:187]
    ds_read_b128 v[140:143], v23 offset:44032
    v_mfma_f32_16x16x32_bf16 v[164:167], v[144:147], v[104:107], v[164:167]
    s_waitcnt vmcnt(20) lgkmcnt(2)
    v_mfma_f32_16x16x32_bf16 v[168:171], v[128:131], v[116:119], v[168:171]
    ds_read_b128 v[144:147], v23 offset:45056
    v_mfma_f32_16x16x32_bf16 v[148:151], v[128:131], v[112:115], v[148:151]
    buffer_load_dwordx4 v[104:107], v4, s[20:23], s45 offen offset:2048 sc1
    v_mfma_f32_16x16x32_bf16 v[172:175], v[132:135], v[116:119], v[172:175]
    ds_read_b128 v[128:131], v23 offset:51200
    v_mfma_f32_16x16x32_bf16 v[152:155], v[132:135], v[112:115], v[152:155]
    s_waitcnt lgkmcnt(2)
    v_mfma_f32_16x16x32_bf16 v[176:179], v[136:139], v[116:119], v[176:179]
    ds_read_b128 v[132:135], v23 offset:52224
    v_mfma_f32_16x16x32_bf16 v[156:159], v[136:139], v[112:115], v[156:159]
    buffer_load_dwordx4 v[108:111], v4, s[20:23], s46 offen offset:2048 sc1
    v_mfma_f32_16x16x32_bf16 v[180:183], v[140:143], v[116:119], v[180:183]
    ds_read_b128 v[136:139], v23 offset:53248
    v_mfma_f32_16x16x32_bf16 v[160:163], v[140:143], v[112:115], v[160:163]
    s_waitcnt lgkmcnt(2)
    v_mfma_f32_16x16x32_bf16 v[184:187], v[144:147], v[116:119], v[184:187]
    ds_read_b128 v[140:143], v23 offset:54272
    v_mfma_f32_16x16x32_bf16 v[164:167], v[144:147], v[112:115], v[164:167]
    s_waitcnt vmcnt(20) lgkmcnt(2)
    v_mfma_f32_16x16x32_bf16 v[168:171], v[128:131], v[124:127], v[168:171]
    ds_read_b128 v[144:147], v23 offset:55296
    v_mfma_f32_16x16x32_bf16 v[148:151], v[128:131], v[120:123], v[148:151]
    s_add_u32 s45, s45, 4096
    buffer_load_dwordx4 v[112:115], v4, s[20:23], s45 offen offset:0 sc1
    v_mfma_f32_16x16x32_bf16 v[172:175], v[132:135], v[124:127], v[172:175]
    ds_read_b128 v[128:131], v24 offset:0
    v_mfma_f32_16x16x32_bf16 v[152:155], v[132:135], v[120:123], v[152:155]
    s_waitcnt lgkmcnt(2)
    v_mfma_f32_16x16x32_bf16 v[176:179], v[136:139], v[124:127], v[176:179]
    ds_read_b128 v[132:135], v24 offset:1024
    v_mfma_f32_16x16x32_bf16 v[156:159], v[136:139], v[120:123], v[156:159]
    s_add_u32 s46, s46, 4096
    buffer_load_dwordx4 v[116:119], v4, s[20:23], s46 offen offset:0 sc1
    v_mfma_f32_16x16x32_bf16 v[180:183], v[140:143], v[124:127], v[180:183]
    ds_read_b128 v[136:139], v24 offset:2048
    v_mfma_f32_16x16x32_bf16 v[160:163], v[140:143], v[120:123], v[160:163]
    s_waitcnt lgkmcnt(2)
    v_mfma_f32_16x16x32_bf16 v[184:187], v[144:147], v[124:127], v[184:187]
    ds_read_b128 v[140:143], v24 offset:3072
    v_mfma_f32_16x16x32_bf16 v[164:167], v[144:147], v[120:123], v[164:167]
    s_waitcnt vmcnt(20) lgkmcnt(2)
    v_mfma_f32_16x16x32_bf16 v[168:171], v[128:131], v[36:39], v[168:171]
    ds_read_b128 v[144:147], v24 offset:4096
    s_mov_b32 s28, s16
    v_mfma_f32_16x16x32_bf16 v[148:151], v[128:131], v[32:35], v[148:151]
    buffer_load_dwordx4 v[120:123], v4, s[20:23], s45 offen offset:2048 sc1
    v_mfma_f32_16x16x32_bf16 v[172:175], v[132:135], v[36:39], v[172:175]
    ds_read_b128 v[128:131], v24 offset:10240
    s_mov_b32 s29, s17
    v_mfma_f32_16x16x32_bf16 v[152:155], v[132:135], v[32:35], v[152:155]
    s_waitcnt lgkmcnt(2)
    v_mfma_f32_16x16x32_bf16 v[176:179], v[136:139], v[36:39], v[176:179]
    ds_read_b128 v[132:135], v24 offset:11264
    s_mov_b32 s30, 2621440
    v_mfma_f32_16x16x32_bf16 v[156:159], v[136:139], v[32:35], v[156:159]
    buffer_load_dwordx4 v[124:127], v4, s[20:23], s46 offen offset:2048 sc1
    v_mfma_f32_16x16x32_bf16 v[180:183], v[140:143], v[36:39], v[180:183]
    ds_read_b128 v[136:139], v24 offset:12288
    s_mov_b32 s31, 0x20000
    v_mfma_f32_16x16x32_bf16 v[160:163], v[140:143], v[32:35], v[160:163]
    s_waitcnt lgkmcnt(2)
    v_mfma_f32_16x16x32_bf16 v[184:187], v[144:147], v[36:39], v[184:187]
    ds_read_b128 v[140:143], v24 offset:13312
    v_mfma_f32_16x16x32_bf16 v[164:167], v[144:147], v[32:35], v[164:167]
    s_barrier
    s_waitcnt vmcnt(20) lgkmcnt(2)
    v_mfma_f32_16x16x32_bf16 v[168:171], v[128:131], v[44:47], v[168:171]
    ds_read_b128 v[144:147], v24 offset:14336
    v_add_u32 v5, 0, v1
    v_mfma_f32_16x16x32_bf16 v[148:151], v[128:131], v[40:43], v[148:151]
    s_add_u32 s45, s45, 4096
    buffer_load_dwordx4 v[32:35], v4, s[20:23], s45 offen offset:0 sc1
    v_mfma_f32_16x16x32_bf16 v[172:175], v[132:135], v[44:47], v[172:175]
    ds_read_b128 v[128:131], v24 offset:20480
    v_mul_u32_u24 v7, 6554, v5
    v_mfma_f32_16x16x32_bf16 v[152:155], v[132:135], v[40:43], v[152:155]
    s_waitcnt lgkmcnt(2)
    v_mfma_f32_16x16x32_bf16 v[176:179], v[136:139], v[44:47], v[176:179]
    ds_read_b128 v[132:135], v24 offset:21504
    v_lshrrev_b32 v7, 16, v7
    v_mfma_f32_16x16x32_bf16 v[156:159], v[136:139], v[40:43], v[156:159]
    s_add_u32 s46, s46, 4096
    buffer_load_dwordx4 v[36:39], v4, s[20:23], s46 offen offset:0 sc1
    v_mfma_f32_16x16x32_bf16 v[180:183], v[140:143], v[44:47], v[180:183]
    ds_read_b128 v[136:139], v24 offset:22528
    v_mul_u32_u24 v7, 1120, v7
    v_mfma_f32_16x16x32_bf16 v[160:163], v[140:143], v[40:43], v[160:163]
    s_waitcnt lgkmcnt(2)
    v_mfma_f32_16x16x32_bf16 v[184:187], v[144:147], v[44:47], v[184:187]
    ds_read_b128 v[140:143], v24 offset:23552
    v_mfma_f32_16x16x32_bf16 v[164:167], v[144:147], v[40:43], v[164:167]
    s_waitcnt vmcnt(20) lgkmcnt(2)
    v_mfma_f32_16x16x32_bf16 v[168:171], v[128:131], v[52:55], v[168:171]
    ds_read_b128 v[144:147], v24 offset:24576
    v_lshl_add_u32 v25, v5, 4, v7
    v_mfma_f32_16x16x32_bf16 v[148:151], v[128:131], v[48:51], v[148:151]
    buffer_load_dwordx4 v[40:43], v4, s[20:23], s45 offen offset:2048 sc1
    v_mfma_f32_16x16x32_bf16 v[172:175], v[132:135], v[52:55], v[172:175]
    ds_read_b128 v[128:131], v22 offset:0
    v_add_u32 v5, 64, v1
    v_mfma_f32_16x16x32_bf16 v[152:155], v[132:135], v[48:51], v[152:155]
    s_waitcnt lgkmcnt(2)
    v_mfma_f32_16x16x32_bf16 v[176:179], v[136:139], v[52:55], v[176:179]
    ds_read_b128 v[132:135], v22 offset:1024
    v_mul_u32_u24 v7, 6554, v5
    v_mfma_f32_16x16x32_bf16 v[156:159], v[136:139], v[48:51], v[156:159]
    buffer_load_dwordx4 v[44:47], v4, s[20:23], s46 offen offset:2048 sc1
    v_mfma_f32_16x16x32_bf16 v[180:183], v[140:143], v[52:55], v[180:183]
    ds_read_b128 v[136:139], v22 offset:2048
    v_lshrrev_b32 v7, 16, v7
    v_mfma_f32_16x16x32_bf16 v[160:163], v[140:143], v[48:51], v[160:163]
    s_waitcnt lgkmcnt(2)
    v_mfma_f32_16x16x32_bf16 v[184:187], v[144:147], v[52:55], v[184:187]
    ds_read_b128 v[140:143], v22 offset:3072
    v_mfma_f32_16x16x32_bf16 v[164:167], v[144:147], v[48:51], v[164:167]
    s_waitcnt vmcnt(20) lgkmcnt(2)
    v_mfma_f32_16x16x32_bf16 v[168:171], v[128:131], v[60:63], v[168:171]
    ds_read_b128 v[144:147], v22 offset:4096
    v_mul_u32_u24 v7, 1120, v7
    v_mfma_f32_16x16x32_bf16 v[148:151], v[128:131], v[56:59], v[148:151]
    s_add_u32 s45, s45, 4096
    buffer_load_dwordx4 v[48:51], v4, s[20:23], s45 offen offset:0 sc1
    v_mfma_f32_16x16x32_bf16 v[172:175], v[132:135], v[60:63], v[172:175]
    ds_read_b128 v[128:131], v22 offset:10240
    v_lshl_add_u32 v26, v5, 4, v7
    v_mfma_f32_16x16x32_bf16 v[152:155], v[132:135], v[56:59], v[152:155]
    s_waitcnt lgkmcnt(2)
    v_mfma_f32_16x16x32_bf16 v[176:179], v[136:139], v[60:63], v[176:179]
    ds_read_b128 v[132:135], v22 offset:11264
    v_add_u32 v5, 128, v1
    v_mfma_f32_16x16x32_bf16 v[156:159], v[136:139], v[56:59], v[156:159]
    s_add_u32 s46, s46, 4096
    buffer_load_dwordx4 v[52:55], v4, s[20:23], s46 offen offset:0 sc1
    v_mfma_f32_16x16x32_bf16 v[180:183], v[140:143], v[60:63], v[180:183]
    ds_read_b128 v[136:139], v22 offset:12288
    v_mul_u32_u24 v7, 6554, v5
    v_mfma_f32_16x16x32_bf16 v[160:163], v[140:143], v[56:59], v[160:163]
    s_waitcnt lgkmcnt(2)
    v_mfma_f32_16x16x32_bf16 v[184:187], v[144:147], v[60:63], v[184:187]
    ds_read_b128 v[140:143], v22 offset:13312
    v_mfma_f32_16x16x32_bf16 v[164:167], v[144:147], v[56:59], v[164:167]
    s_waitcnt vmcnt(20) lgkmcnt(2)
    v_mfma_f32_16x16x32_bf16 v[168:171], v[128:131], v[68:71], v[168:171]
    ds_read_b128 v[144:147], v22 offset:14336
    v_lshrrev_b32 v7, 16, v7
    v_mfma_f32_16x16x32_bf16 v[148:151], v[128:131], v[64:67], v[148:151]
    v_mfma_f32_16x16x32_bf16 v[172:175], v[132:135], v[68:71], v[172:175]
    ds_read_b128 v[128:131], v22 offset:20480
    v_mul_u32_u24 v7, 1120, v7
    v_mfma_f32_16x16x32_bf16 v[152:155], v[132:135], v[64:67], v[152:155]
    s_waitcnt lgkmcnt(2)
    v_mfma_f32_16x16x32_bf16 v[176:179], v[136:139], v[68:71], v[176:179]
    ds_read_b128 v[132:135], v22 offset:21504
    v_lshl_add_u32 v27, v5, 4, v7
    v_mfma_f32_16x16x32_bf16 v[156:159], v[136:139], v[64:67], v[156:159]
    v_mfma_f32_16x16x32_bf16 v[180:183], v[140:143], v[68:71], v[180:183]
    ds_read_b128 v[136:139], v22 offset:22528
    v_cmp_gt_u32 vcc, 32, v1
    v_mfma_f32_16x16x32_bf16 v[160:163], v[140:143], v[64:67], v[160:163]
    s_waitcnt lgkmcnt(2)
    v_mfma_f32_16x16x32_bf16 v[184:187], v[144:147], v[68:71], v[184:187]
    ds_read_b128 v[140:143], v22 offset:23552
    v_mfma_f32_16x16x32_bf16 v[164:167], v[144:147], v[64:67], v[164:167]
    s_barrier
    s_waitcnt vmcnt(18) lgkmcnt(2)
    v_mfma_f32_16x16x32_bf16 v[168:171], v[128:131], v[76:79], v[168:171]
    ds_read_b128 v[144:147], v22 offset:24576
    v_mov_b32 v5, 0x7f000000
    v_mfma_f32_16x16x32_bf16 v[148:151], v[128:131], v[72:75], v[148:151]
    v_mfma_f32_16x16x32_bf16 v[172:175], v[132:135], v[76:79], v[172:175]
    ds_read_b128 v[128:131], v22 offset:30720
    v_mul_u32_u24 v28, 160, v21
    v_mfma_f32_16x16x32_bf16 v[152:155], v[132:135], v[72:75], v[152:155]
    s_waitcnt lgkmcnt(2)
    v_mfma_f32_16x16x32_bf16 v[176:179], v[136:139], v[76:79], v[176:179]
    ds_read_b128 v[132:135], v22 offset:31744
    v_cndmask_b32 v27, v5, v27, vcc
    v_mfma_f32_16x16x32_bf16 v[156:159], v[136:139], v[72:75], v[156:159]
    v_mfma_f32_16x16x32_bf16 v[180:183], v[140:143], v[76:79], v[180:183]
    ds_read_b128 v[136:139], v22 offset:32768
    v_lshl_add_u32 v28, v20, 3, v28
    v_mfma_f32_16x16x32_bf16 v[160:163], v[140:143], v[72:75], v[160:163]
    s_waitcnt lgkmcnt(2)
    v_mfma_f32_16x16x32_bf16 v[184:187], v[144:147], v[76:79], v[184:187]
    ds_read_b128 v[140:143], v22 offset:33792
    v_mfma_f32_16x16x32_bf16 v[164:167], v[144:147], v[72:75], v[164:167]
    s_waitcnt vmcnt(16) lgkmcnt(2)
    v_mfma_f32_16x16x32_bf16 v[168:171], v[128:131], v[84:87], v[168:171]
    ds_read_b128 v[144:147], v22 offset:34816
    s_mul_i32 s34, s33, 2560
    v_mfma_f32_16x16x32_bf16 v[148:151], v[128:131], v[80:83], v[148:151]
    v_mfma_f32_16x16x32_bf16 v[172:175], v[132:135], v[84:87], v[172:175]
    ds_read_b128 v[128:131], v22 offset:40960
    s_add_u32 s34, s34, 153600
    v_mfma_f32_16x16x32_bf16 v[152:155], v[132:135], v[80:83], v[152:155]
    s_waitcnt lgkmcnt(2)
    v_mfma_f32_16x16x32_bf16 v[176:179], v[136:139], v[84:87], v[176:179]
    ds_read_b128 v[132:135], v22 offset:41984
    v_add_u32 v28, s34, v28
    v_mfma_f32_16x16x32_bf16 v[156:159], v[136:139], v[80:83], v[156:159]
    v_mfma_f32_16x16x32_bf16 v[180:183], v[140:143], v[84:87], v[180:183]
    ds_read_b128 v[136:139], v22 offset:43008
    v_add_u32 v29, s34, v4
    v_mfma_f32_16x16x32_bf16 v[160:163], v[140:143], v[80:83], v[160:163]
    s_waitcnt lgkmcnt(2)
    v_mfma_f32_16x16x32_bf16 v[184:187], v[144:147], v[84:87], v[184:187]
    ds_read_b128 v[140:143], v22 offset:44032
    v_mfma_f32_16x16x32_bf16 v[164:167], v[144:147], v[80:83], v[164:167]
    s_waitcnt vmcnt(14) lgkmcnt(2)
    v_mfma_f32_16x16x32_bf16 v[168:171], v[128:131], v[92:95], v[168:171]
    ds_read_b128 v[144:147], v22 offset:45056
    s_mul_i32 s34, s33, 5120
    v_mfma_f32_16x16x32_bf16 v[148:151], v[128:131], v[88:91], v[148:151]
    v_mfma_f32_16x16x32_bf16 v[172:175], v[132:135], v[92:95], v[172:175]
    ds_read_b128 v[128:131], v22 offset:51200
    s_add_u32 s34, s34, 133120
    v_mfma_f32_16x16x32_bf16 v[152:155], v[132:135], v[88:91], v[152:155]
    s_waitcnt lgkmcnt(2)
    v_mfma_f32_16x16x32_bf16 v[176:179], v[136:139], v[92:95], v[176:179]
    ds_read_b128 v[132:135], v22 offset:52224
    v_add_u32 v30, s34, v4
    v_mfma_f32_16x16x32_bf16 v[156:159], v[136:139], v[88:91], v[156:159]
    v_mfma_f32_16x16x32_bf16 v[180:183], v[140:143], v[92:95], v[180:183]
    ds_read_b128 v[136:139], v22 offset:53248
    s_xor_b32 s34, s33, 1
    v_mfma_f32_16x16x32_bf16 v[160:163], v[140:143], v[88:91], v[160:163]
    s_waitcnt lgkmcnt(2)
    v_mfma_f32_16x16x32_bf16 v[184:187], v[144:147], v[92:95], v[184:187]
    ds_read_b128 v[140:143], v22 offset:54272
    v_mfma_f32_16x16x32_bf16 v[164:167], v[144:147], v[88:91], v[164:167]
    s_barrier
    s_waitcnt vmcnt(12) lgkmcnt(2)
    v_mfma_f32_16x16x32_bf16 v[168:171], v[128:131], v[100:103], v[168:171]
    ds_read_b128 v[144:147], v22 offset:55296
    s_mul_i32 s34, s34, 5120
    v_mfma_f32_16x16x32_bf16 v[148:151], v[128:131], v[96:99], v[148:151]
    v_mfma_f32_16x16x32_bf16 v[172:175], v[132:135], v[100:103], v[172:175]
    ds_read_b128 v[128:131], v23 offset:0
    s_add_u32 s34, s34, 133120
    v_mfma_f32_16x16x32_bf16 v[152:155], v[132:135], v[96:99], v[152:155]
    s_waitcnt lgkmcnt(2)
    v_mfma_f32_16x16x32_bf16 v[176:179], v[136:139], v[100:103], v[176:179]
    ds_read_b128 v[132:135], v23 offset:1024
    v_add_u32 v31, s34, v4
    v_mfma_f32_16x16x32_bf16 v[156:159], v[136:139], v[96:99], v[156:159]
    v_mfma_f32_16x16x32_bf16 v[180:183], v[140:143], v[100:103], v[180:183]
    ds_read_b128 v[136:139], v23 offset:2048
    s_mul_i32 s47, s42, 20480
    v_mfma_f32_16x16x32_bf16 v[160:163], v[140:143], v[96:99], v[160:163]
    s_waitcnt lgkmcnt(2)
    v_mfma_f32_16x16x32_bf16 v[184:187], v[144:147], v[100:103], v[184:187]
    ds_read_b128 v[140:143], v23 offset:3072
    v_mfma_f32_16x16x32_bf16 v[164:167], v[144:147], v[96:99], v[164:167]
    s_waitcnt vmcnt(10) lgkmcnt(2)
    v_mfma_f32_16x16x32_bf16 v[168:171], v[128:131], v[108:111], v[168:171]
    ds_read_b128 v[144:147], v23 offset:4096
    s_mul_i32 s34, s41, 160
    v_mfma_f32_16x16x32_bf16 v[148:151], v[128:131], v[104:107], v[148:151]
    v_mfma_f32_16x16x32_bf16 v[172:175], v[132:135], v[108:111], v[172:175]
    ds_read_b128 v[128:131], v23 offset:10240
    s_add_u32 s47, s47, s34
    v_mfma_f32_16x16x32_bf16 v[152:155], v[132:135], v[104:107], v[152:155]
    s_waitcnt lgkmcnt(2)
    v_mfma_f32_16x16x32_bf16 v[176:179], v[136:139], v[108:111], v[176:179]
    ds_read_b128 v[132:135], v23 offset:11264
    v_mfma_f32_16x16x32_bf16 v[156:159], v[136:139], v[104:107], v[156:159]
    v_mfma_f32_16x16x32_bf16 v[180:183], v[140:143], v[108:111], v[180:183]
    ds_read_b128 v[136:139], v23 offset:12288
    v_mfma_f32_16x16x32_bf16 v[160:163], v[140:143], v[104:107], v[160:163]
    s_waitcnt lgkmcnt(2)
    v_mfma_f32_16x16x32_bf16 v[184:187], v[144:147], v[108:111], v[184:187]
    ds_read_b128 v[140:143], v23 offset:13312
    v_mfma_f32_16x16x32_bf16 v[164:167], v[144:147], v[104:107], v[164:167]
    s_waitcnt vmcnt(8) lgkmcnt(2)
    v_mfma_f32_16x16x32_bf16 v[168:171], v[128:131], v[116:119], v[168:171]
    ds_read_b128 v[144:147], v23 offset:14336
    v_mfma_f32_16x16x32_bf16 v[148:151], v[128:131], v[112:115], v[148:151]
    v_mfma_f32_16x16x32_bf16 v[172:175], v[132:135], v[116:119], v[172:175]
    ds_read_b128 v[128:131], v23 offset:20480
    v_mfma_f32_16x16x32_bf16 v[152:155], v[132:135], v[112:115], v[152:155]
    s_waitcnt lgkmcnt(2)
    v_mfma_f32_16x16x32_bf16 v[176:179], v[136:139], v[116:119], v[176:179]
    ds_read_b128 v[132:135], v23 offset:21504
    v_mfma_f32_16x16x32_bf16 v[156:159], v[136:139], v[112:115], v[156:159]
    v_mfma_f32_16x16x32_bf16 v[180:183], v[140:143], v[116:119], v[180:183]
    ds_read_b128 v[136:139], v23 offset:22528
    v_mfma_f32_16x16x32_bf16 v[160:163], v[140:143], v[112:115], v[160:163]
    s_waitcnt lgkmcnt(2)
    v_mfma_f32_16x16x32_bf16 v[184:187], v[144:147], v[116:119], v[184:187]
    ds_read_b128 v[140:143], v23 offset:23552
    v_mfma_f32_16x16x32_bf16 v[164:167], v[144:147], v[112:115], v[164:167]
    s_barrier
    s_waitcnt vmcnt(6) lgkmcnt(2)
    v_mfma_f32_16x16x32_bf16 v[168:171], v[128:131], v[124:127], v[168:171]
    ds_read_b128 v[144:147], v23 offset:24576
    v_mfma_f32_16x16x32_bf16 v[148:151], v[128:131], v[120:123], v[148:151]
    v_mfma_f32_16x16x32_bf16 v[172:175], v[132:135], v[124:127], v[172:175]
    ds_read_b128 v[128:131], v23 offset:30720
    v_mfma_f32_16x16x32_bf16 v[152:155], v[132:135], v[120:123], v[152:155]
    s_waitcnt lgkmcnt(2)
    v_mfma_f32_16x16x32_bf16 v[176:179], v[136:139], v[124:127], v[176:179]
    ds_read_b128 v[132:135], v23 offset:31744
    v_mfma_f32_16x16x32_bf16 v[156:159], v[136:139], v[120:123], v[156:159]
    v_mfma_f32_16x16x32_bf16 v[180:183], v[140:143], v[124:127], v[180:183]
    ds_read_b128 v[136:139], v23 offset:32768
    v_mfma_f32_16x16x32_bf16 v[160:163], v[140:143], v[120:123], v[160:163]
    s_waitcnt lgkmcnt(2)
    v_mfma_f32_16x16x32_bf16 v[184:187], v[144:147], v[124:127], v[184:187]
    ds_read_b128 v[140:143], v23 offset:33792
    v_mfma_f32_16x16x32_bf16 v[164:167], v[144:147], v[120:123], v[164:167]
    s_waitcnt vmcnt(4) lgkmcnt(2)
    v_mfma_f32_16x16x32_bf16 v[168:171], v[128:131], v[36:39], v[168:171]
    ds_read_b128 v[144:147], v23 offset:34816
    v_mfma_f32_16x16x32_bf16 v[148:151], v[128:131], v[32:35], v[148:151]
    v_mfma_f32_16x16x32_bf16 v[172:175], v[132:135], v[36:39], v[172:175]
    ds_read_b128 v[128:131], v23 offset:40960
    v_mfma_f32_16x16x32_bf16 v[152:155], v[132:135], v[32:35], v[152:155]
    s_waitcnt lgkmcnt(2)
    v_mfma_f32_16x16x32_bf16 v[176:179], v[136:139], v[36:39], v[176:179]
    ds_read_b128 v[132:135], v23 offset:41984
    v_mfma_f32_16x16x32_bf16 v[156:159], v[136:139], v[32:35], v[156:159]
    v_mfma_f32_16x16x32_bf16 v[180:183], v[140:143], v[36:39], v[180:183]
    ds_read_b128 v[136:139], v23 offset:43008
    v_mfma_f32_16x16x32_bf16 v[160:163], v[140:143], v[32:35], v[160:163]
    s_waitcnt lgkmcnt(2)
    v_mfma_f32_16x16x32_bf16 v[184:187], v[144:147], v[36:39], v[184:187]
    ds_read_b128 v[140:143], v23 offset:44032
    v_mfma_f32_16x16x32_bf16 v[164:167], v[144:147], v[32:35], v[164:167]
    s_waitcnt vmcnt(2) lgkmcnt(2)
    v_mfma_f32_16x16x32_bf16 v[168:171], v[128:131], v[44:47], v[168:171]
    ds_read_b128 v[144:147], v23 offset:45056
    v_mfma_f32_16x16x32_bf16 v[148:151], v[128:131], v[40:43], v[148:151]
    v_mfma_f32_16x16x32_bf16 v[172:175], v[132:135], v[44:47], v[172:175]
    ds_read_b128 v[128:131], v23 offset:51200
    v_mfma_f32_16x16x32_bf16 v[152:155], v[132:135], v[40:43], v[152:155]
    s_waitcnt lgkmcnt(2)
    v_mfma_f32_16x16x32_bf16 v[176:179], v[136:139], v[44:47], v[176:179]
    ds_read_b128 v[132:135], v23 offset:52224
    v_mfma_f32_16x16x32_bf16 v[156:159], v[136:139], v[40:43], v[156:159]
    v_mfma_f32_16x16x32_bf16 v[180:183], v[140:143], v[44:47], v[180:183]
    ds_read_b128 v[136:139], v23 offset:53248
    v_mfma_f32_16x16x32_bf16 v[160:163], v[140:143], v[40:43], v[160:163]
    s_waitcnt lgkmcnt(2)
    v_mfma_f32_16x16x32_bf16 v[184:187], v[144:147], v[44:47], v[184:187]
    ds_read_b128 v[140:143], v23 offset:54272
    v_mfma_f32_16x16x32_bf16 v[164:167], v[144:147], v[40:43], v[164:167]
    s_waitcnt vmcnt(0) lgkmcnt(2)
    v_mfma_f32_16x16x32_bf16 v[168:171], v[128:131], v[52:55], v[168:171]
    ds_read_b128 v[144:147], v23 offset:55296
    v_mfma_f32_16x16x32_bf16 v[172:175], v[132:135], v[52:55], v[172:175]
    s_waitcnt lgkmcnt(1)
    v_mfma_f32_16x16x32_bf16 v[176:179], v[136:139], v[52:55], v[176:179]
    v_mfma_f32_16x16x32_bf16 v[180:183], v[140:143], v[52:55], v[180:183]
    v_mfma_f32_16x16x32_bf16 v[148:151], v[128:131], v[48:51], v[148:151]
    v_mfma_f32_16x16x32_bf16 v[152:155], v[132:135], v[48:51], v[152:155]
    s_waitcnt lgkmcnt(0)
    v_mfma_f32_16x16x32_bf16 v[184:187], v[144:147], v[52:55], v[184:187]
    ds_write_b128 v30, v[168:171] offset:0
    v_mfma_f32_16x16x32_bf16 v[156:159], v[136:139], v[48:51], v[156:159]
    ds_write_b128 v30, v[172:175] offset:1024
    v_mfma_f32_16x16x32_bf16 v[160:163], v[140:143], v[48:51], v[160:163]
    ds_write_b128 v30, v[176:179] offset:2048
    v_mfma_f32_16x16x32_bf16 v[164:167], v[144:147], v[48:51], v[164:167]
    ds_write_b128 v30, v[180:183] offset:3072
    s_nop 0
    ds_write_b128 v30, v[184:187] offset:4096
    s_waitcnt lgkmcnt(0)
    s_barrier
    ds_read_b128 v[128:131], v31 offset:0
    ds_read_b128 v[132:135], v31 offset:1024
    ds_read_b128 v[136:139], v31 offset:2048
    s_branch Lpg10s
    s_nop 0
Lpg10:
    s_setpc_b64 s[38:39]
Lpg10s:
    ds_read_b128 v[140:143], v31 offset:3072
    ds_read_b128 v[144:147], v31 offset:4096
    s_waitcnt lgkmcnt(4)
    v_pk_add_f32 v[148:149], v[148:149], v[128:129]
    v_pk_add_f32 v[150:151], v[150:151], v[130:131]
    v_cvt_pk_bf16_f32 v148, v148, v149
    v_cvt_pk_bf16_f32 v149, v150, v151
    ds_write_b64 v28, v[148:149] offset:0
    s_waitcnt lgkmcnt(4)
    v_pk_add_f32 v[152:153], v[152:153], v[132:133]
    v_pk_add_f32 v[154:155], v[154:155], v[134:135]
    v_cvt_pk_bf16_f32 v152, v152, v153
    v_cvt_pk_bf16_f32 v153, v154, v155
    ds_write_b64 v28, v[152:153] offset:32
    s_waitcnt lgkmcnt(4)
    v_pk_add_f32 v[156:157], v[156:157], v[136:137]
    v_pk_add_f32 v[158:159], v[158:159], v[138:139]
    v_cvt_pk_bf16_f32 v156, v156, v157
    v_cvt_pk_bf16_f32 v157, v158, v159
    ds_write_b64 v28, v[156:157] offset:64
    s_waitcnt lgkmcnt(4)
    v_pk_add_f32 v[160:161], v[160:161], v[140:141]
    v_pk_add_f32 v[162:163], v[162:163], v[142:143]
    v_cvt_pk_bf16_f32 v160, v160, v161
    v_cvt_pk_bf16_f32 v161, v162, v163
    ds_write_b64 v28, v[160:161] offset:96
    s_waitcnt lgkmcnt(4)
    v_pk_add_f32 v[164:165], v[164:165], v[144:145]
    v_pk_add_f32 v[166:167], v[166:167], v[146:147]
    v_cvt_pk_bf16_f32 v164, v164, v165
    v_cvt_pk_bf16_f32 v165, v166, v167
    ds_write_b64 v28, v[164:165] offset:128
    ds_read_b128 v[128:131], v29 offset:0
    ds_read_b128 v[132:135], v29 offset:1024
    ds_read_b128 v[136:139], v29 offset:2048
    s_waitcnt lgkmcnt(2)
    buffer_store_dwordx4 v[128:131], v25, s[28:31], s47 offen nt
    s_waitcnt lgkmcnt(1)
    buffer_store_dwordx4 v[132:135], v26, s[28:31], s47 offen nt
    s_waitcnt lgkmcnt(0)
    buffer_store_dwordx4 v[136:139], v27, s[28:31], s47 offen nt
Lend:
    s_endpgm
LpgL:
    s_setpc_b64 s[38:39]
Lld3:
    s_lshr_b32 s45, s40, 1
    s_lshl_b32 s46, s41, 1
    s_and_b32 s34, s40, 1
    s_add_u32 s46, s46, s34
    s_lshl_b32 s34, s33, 10
    s_mul_i32 s47, s41, 276480
    s_add_u32 s47, s47, s34
    s_add_u32 s47, s47, 23429120
    s_add_u32 s48, s47, 215040
    s_add_u32 s49, s34, 10240
    s_lshl_b32 s34, s33, 10
    s_add_u32 s34, s34, 122880
    v_add_u32 v22, s34, v4
    v_mov_b32 v120, 0x3f803f80
    v_mov_b32 v121, 0x3f803f80
    v_mov_b32 v122, 0x3f803f80
    v_mov_b32 v123, 0x3f803f80
    s_lshl_b32 s36, s32, 9
    s_add_u32 s36, s36, 1024
    v_mfma_f32_16x16x32_bf16 v[124:127], v[120:123], v[152:155], 0
    v_mfma_f32_16x16x32_bf16 v[128:131], v[120:123], v[156:159], 0
    v_mfma_f32_16x16x32_bf16 v[132:135], v[120:123], v[160:163], 0
    v_mfma_f32_16x16x32_bf16 v[136:139], v[120:123], v[164:167], 0
    v_mfma_f32_16x16x32_bf16 v[140:143], v[120:123], v[168:171], 0
    v_mfma_f32_16x16x32_bf16 v[144:147], v[120:123], v[172:175], 0
    v_mfma_f32_16x16x32_bf16 v[148:151], v[120:123], v[176:179], 0
    v_mfma_f32_16x16x32_bf16 v[124:127], v[120:123], v[180:183], v[124:127]
    v_mfma_f32_16x16x32_bf16 v[128:131], v[120:123], v[184:187], v[128:131]
    v_mfma_f32_16x16x32_bf16 v[132:135], v[120:123], v[188:191], v[132:135]
    v_and_b32 v6, 15, v0
    v_lshl_add_u32 v6, v6, 2, s36
    s_waitcnt lgkmcnt(8)
    ds_write_b32 v6, v136 offset:320
    ds_write_b32 v6, v140 offset:128
    ds_write_b32 v6, v144 offset:384
    ds_write_b32 v6, v148 offset:192
    ds_write_b32 v6, v124 offset:0
    ds_write_b32 v6, v128 offset:256
    ds_write_b32 v6, v132 offset:64
    s_waitcnt lgkmcnt(0)
    s_barrier
    ds_write_b128 v22, v[152:155] offset:0
    ds_write_b128 v22, v[156:159] offset:4096
    ds_write_b128 v22, v[160:163] offset:8192
    ds_write_b128 v22, v[164:167] offset:12288
    ds_write_b128 v22, v[168:171] offset:16384
    ds_write_b128 v22, v[172:175] offset:20480
    ds_write_b128 v22, v[176:179] offset:24576
    ds_write_b128 v22, v[180:183] offset:28672
    ds_write_b128 v22, v[184:187] offset:32768
    ds_write_b128 v22, v[188:191] offset:36864
    s_waitcnt lgkmcnt(4)
    s_cmp_ge_u32 s32, 6
    s_cbranch_scc1 Lld_ncs
    v_and_b32 v5, 127, v0
    v_lshlrev_b32 v5, 2, v5
    v_subrev_u32 v6, 0, v5
    v_add_u32 v7, 448, v6
    v_min_u32 v6, v6, v7
    ds_read_b32 v10, v6 offset:1024
    v_subrev_u32 v6, 64, v5
    v_add_u32 v7, 448, v6
    v_min_u32 v6, v6, v7
    ds_read_b32 v11, v6 offset:1536
    v_subrev_u32 v6, 128, v5
    v_add_u32 v7, 448, v6
    v_min_u32 v6, v6, v7
    ds_read_b32 v12, v6 offset:2048
    v_subrev_u32 v6, 192, v5
    v_add_u32 v7, 448, v6
    v_min_u32 v6, v6, v7
    ds_read_b32 v13, v6 offset:2560
    v_subrev_u32 v6, 128, v5
    v_add_u32 v7, 448, v6
    v_min_u32 v6, v6, v7
    ds_read_b32 v14, v6 offset:3072
    v_subrev_u32 v6, 192, v5
    v_add_u32 v7, 448, v6
    v_min_u32 v6, v6, v7
    ds_read_b32 v15, v6 offset:3584
    v_subrev_u32 v6, 256, v5
    v_add_u32 v7, 448, v6
    v_min_u32 v6, v6, v7
    ds_read_b32 v16, v6 offset:4096
    v_subrev_u32 v6, 320, v5
    v_add_u32 v7, 448, v6
    v_min_u32 v6, v6, v7
    ds_read_b32 v17, v6 offset:4608
    s_waitcnt lgkmcnt(6)
    v_add_f32 v10, v10, v11
    s_waitcnt lgkmcnt(5)
    v_add_f32 v10, v10, v12
    s_waitcnt lgkmcnt(4)
    v_add_f32 v10, v10, v13
    s_waitcnt lgkmcnt(3)
    v_add_f32 v10, v10, v14
    s_waitcnt lgkmcnt(2)
    v_add_f32 v10, v10, v15
    s_waitcnt lgkmcnt(1)
    v_add_f32 v10, v10, v16
    s_waitcnt lgkmcnt(0)
    v_add_f32 v10, v10, v17
    ds_write_b32 v5, v10 offset:256
Lld_ncs:
    s_waitcnt lgkmcnt(0)
    s_lshl_b32 s34, s33, 10
    s_add_u32 s34, s34, 10240
    v_add_u32 v22, s34, v4
    v_add_u32 v23, 0x10000, v22
    s_barrier
    s_barrier
Lst_a:
    s_mov_b32 m0, s49
    s_add_u32 s49, s49, 4096
    buffer_load_dwordx4 v4, s[20:23], s47 offen sc1 lds
    s_add_u32 s47, s47, 4096
    s_cmp_lt_u32 s49, 83968
    s_cbranch_scc1 Lst_a
    s_barrier
Lst_b:
    s_mov_b32 m0, s49
    s_add_u32 s49, s49, 4096
    buffer_load_dwordx4 v4, s[20:23], s47 offen sc1 lds
    s_add_u32 s47, s47, 4096
    s_cmp_lt_u32 s49, 133120
    s_cbranch_scc1 Lst_b
    s_barrier
Lst_c:
    s_mov_b32 m0, s49
    s_add_u32 s49, s49, 4096
    buffer_load_dwordx4 v4, s[20:23], s47 offen sc1 lds
    s_add_u32 s47, s47, 4096
    s_cmp_lt_u32 s49, 163840
    s_cbranch_scc1 Lst_c
    s_waitcnt vmcnt(0)
    s_barrier
    s_waitcnt vmcnt(0)
    s_lshl_b32 s49, s33, 10
    s_add_u32 s49, s49, 71680
    s_barrier
    ds_write_b128 v22, v[192:195] offset:0
    ds_write_b128 v22, v[196:199] offset:4096
    ds_write_b128 v22, v[200:203] offset:8192
    ds_write_b128 v22, v[204:207] offset:12288
    ds_write_b128 v22, v[208:211] offset:16384
    ds_write_b128 v22, v[212:215] offset:20480
    ds_write_b128 v22, v[216:219] offset:24576
    s_waitcnt lgkmcnt(0)
    s_barrier
    ds_write_b128 v22, v[220:223] offset:28672
    ds_write_b128 v22, v[224:227] offset:32768
    ds_write_b128 v22, v[228:231] offset:36864
    ds_write_b128 v22, v[232:235] offset:40960
    ds_write_b128 v22, v[236:239] offset:45056
    ds_write_b128 v22, v[240:243] offset:49152
    ds_write_b128 v22, v[244:247] offset:53248
    ds_write_b128 v22, v[248:251] offset:57344
    s_waitcnt lgkmcnt(0)
    s_barrier
    s_mov_b32 m0, s49
    s_add_u32 s49, s49, 4096
    buffer_load_dwordx4 v4, s[20:23], s48 offen sc1 lds
    s_add_u32 s48, s48, 4096
    s_mov_b32 m0, s49
    s_add_u32 s49, s49, 4096
    buffer_load_dwordx4 v4, s[20:23], s48 offen sc1 lds
    s_add_u32 s48, s48, 4096
    s_mov_b32 m0, s49
    s_add_u32 s49, s49, 4096
    buffer_load_dwordx4 v4, s[20:23], s48 offen sc1 lds
    s_add_u32 s48, s48, 4096
    s_mov_b32 m0, s49
    s_add_u32 s49, s49, 4096
    buffer_load_dwordx4 v4, s[20:23], s48 offen sc1 lds
    s_add_u32 s48, s48, 4096
    s_barrier
    s_mov_b32 m0, s49
    s_add_u32 s49, s49, 4096
    buffer_load_dwordx4 v4, s[20:23], s48 offen sc1 lds
    s_add_u32 s48, s48, 4096
    s_mov_b32 m0, s49
    s_add_u32 s49, s49, 4096
    buffer_load_dwordx4 v4, s[20:23], s48 offen sc1 lds
    s_add_u32 s48, s48, 4096
    s_mov_b32 m0, s49
    s_add_u32 s49, s49, 4096
    buffer_load_dwordx4 v4, s[20:23], s48 offen sc1 lds
    s_add_u32 s48, s48, 4096
    s_mov_b32 m0, s49
    s_add_u32 s49, s49, 4096
    buffer_load_dwordx4 v4, s[20:23], s48 offen sc1 lds
    s_add_u32 s48, s48, 4096
    s_barrier
    s_mov_b32 m0, s49
    s_add_u32 s49, s49, 4096
    buffer_load_dwordx4 v4, s[20:23], s48 offen sc1 lds
    s_add_u32 s48, s48, 4096
    s_mov_b32 m0, s49
    s_add_u32 s49, s49, 4096
    buffer_load_dwordx4 v4, s[20:23], s48 offen sc1 lds
    s_add_u32 s48, s48, 4096
    s_mov_b32 m0, s49
    s_add_u32 s49, s49, 4096
    buffer_load_dwordx4 v4, s[20:23], s48 offen sc1 lds
    s_add_u32 s48, s48, 4096
    s_mov_b32 m0, s49
    s_add_u32 s49, s49, 4096
    buffer_load_dwordx4 v4, s[20:23], s48 offen sc1 lds
    s_add_u32 s48, s48, 4096
    s_mov_b32 m0, s49
    s_add_u32 s49, s49, 4096
    buffer_load_dwordx4 v4, s[20:23], s48 offen sc1 lds
    s_add_u32 s48, s48, 4096
    s_mov_b32 m0, s49
    s_add_u32 s49, s49, 4096
    buffer_load_dwordx4 v4, s[20:23], s48 offen sc1 lds
    s_add_u32 s48, s48, 4096
    s_mov_b32 m0, s49
    s_add_u32 s49, s49, 4096
    buffer_load_dwordx4 v4, s[20:23], s48 offen sc1 lds
    s_add_u32 s48, s48, 4096
    s_waitcnt vmcnt(7)
    s_barrier
    s_waitcnt vmcnt(0)
    s_barrier
    s_endpgm
Lp2_rwait:
    s_mov_b32 s37, 0
Lp2_rw2:
    buffer_load_dword v235, v234, s[20:23], 0 offen sc1
    s_add_u32 s37, s37, 1
    s_cmp_gt_u32 s37, 0x200000
    s_cbranch_scc1 Lp2_rok
    s_waitcnt vmcnt(0)
    v_cmp_le_u32 vcc, 0x200, v235
    s_cmp_eq_u64 vcc, -1
    s_cbranch_scc0 Lp2_rw2
    s_branch Lp2_rok
Lp2_nofast:
    v_mov_b32 v5, 4
    ds_write_b32 v5, v5
    s_waitcnt lgkmcnt(0)
    s_branch Lp2_fok
Lp1_xrT:
    buffer_load_dwordx2 v[208:209], v51, s[20:23], 0 offen offset:0 sc1
    buffer_load_dwordx2 v[210:211], v51, s[20:23], 0 offen offset:128 sc1
    buffer_load_dwordx2 v[212:213], v51, s[20:23], 0 offen offset:256 sc1
    buffer_load_dwordx2 v[214:215], v51, s[20:23], 0 offen offset:384 sc1
    s_add_u32 s37, s37, 1
    s_cmp_lt_u32 s37, 0x200000
    s_waitcnt vmcnt(0)
    s_cbranch_scc1 Lp1_xsT
    s_branch Lp1_xsokT
Lp1_xrV:
    buffer_load_dwordx2 v[208:209], v51, s[20:23], 0 offen offset:0 sc1
    s_add_u32 s37, s37, 1
    s_cmp_lt_u32 s37, 0x200000
    s_waitcnt vmcnt(0)
    s_cbranch_scc1 Lp1_xsV
    s_branch Lp1_xsokV
Lp3_again:
    s_add_u32 s50, s50, 1
    s_cmp_lt_u32 s50, 0x40000
    s_nop 7
    s_cbranch_scc1 Lp3_redo
    s_branch Lp3_ok
Lp1_rwT:
    s_mov_b32 s35, 0
Lrst_47:
    v_and_b32 v5, 7, v0
    v_lshlrev_b32 v5, 2, v5
    global_load_dword v8, v5, s[18:19] sc1
    s_add_u32 s35, s35, 1
    s_cmp_gt_u32 s35, 0x200000
    s_cbranch_scc1 Lrste_48
    s_waitcnt vmcnt(0)
Lrstc_49:
    v_cmp_ne_u32 vcc, 0, v8
    s_cmp_eq_u64 vcc, -1
    s_cbranch_scc0 Lrst_47
Lrste_48:
    s_branch Lp1_rokT
Lp1_rwV:
    s_mov_b32 s35, 0
Lrst_50:
    v_and_b32 v5, 7, v0
    v_lshlrev_b32 v5, 2, v5
    global_load_dword v8, v5, s[18:19] sc1
    s_add_u32 s35, s35, 1
    s_cmp_gt_u32 s35, 0x200000
    s_cbranch_scc1 Lrste_51
    s_waitcnt vmcnt(0)
Lrstc_52:
    v_cmp_ne_u32 vcc, 0, v8
    s_cmp_eq_u64 vcc, -1
    s_cbranch_scc0 Lrst_50
Lrste_51:
    s_branch Lp1_rokV
Lw_37:
    buffer_store_dwordx4 v[10:13], v4, s[20:23], s47 offen offset:0 sc1
    s_branch Lw_37b
Lw_38:
    buffer_store_dwordx4 v[14:17], v4, s[20:23], s47 offen offset:1024 sc1
    s_branch Lw_38b
Lw_39:
    buffer_store_dwordx4 v[48:51], v4, s[20:23], s48 offen sc1
    s_branch Lw_39b
Lw_40:
    buffer_store_dword v52, v26, s[20:23], s49 offen sc1
    s_branch Lw_40b
Lw_41:
    buffer_store_dword v6, v4, s[20:23], s38 offen sc1
    s_branch Lw_41b
Lw_44:
    buffer_store_dword v6, v4, s[20:23], s38 offen sc1
    s_branch Lw_44b
Lp2_slow:
    v_cndmask_b32 v46, 0, v46, s[56:57]
    v_mov_b32 v84, 0xff7fffff
    s_mov_b32 s37, 0
    v_mov_b32 v132, 0
    v_mov_b32 v133, 0
    v_mov_b32 v134, 0
    v_mov_b32 v135, 0
    v_mov_b32 v136, 0
    v_mov_b32 v137, 0
    v_mov_b32 v138, 0
    v_mov_b32 v139, 0
    v_mov_b32 v140, 0
    v_mov_b32 v141, 0
    v_mov_b32 v142, 0
    v_mov_b32 v143, 0
    v_mov_b32 v144, 0
    v_mov_b32 v145, 0
    v_mov_b32 v146, 0
    v_mov_b32 v147, 0
Lp2_sloop:
    s_add_u32 s34, s37, 63
    s_and_b32 s34, s34, 63
    s_mul_i32 s34, s34, 2560
    s_add_u32 s34, s34, s50
    s_mul_i32 s35, s37, 2560
    s_add_u32 s35, s35, s50
    buffer_load_dwordx4 v[52:55], v4, s[20:23], s34 offen sc1
    buffer_load_dwordx2 v[48:49], v32, s[20:23], s34 offen offset:1024 sc1
    buffer_load_dwordx4 v[56:59], v33, s[20:23], s34 offen offset:1280 sc1
    buffer_load_dwordx4 v[64:67], v33, s[20:23], s35 offen offset:1920 sc1
    s_waitcnt vmcnt(0)
    v_mfma_f32_32x32x8_bf16 v[68:83], v[48:49], v[46:47], 0
    v_mfma_f32_32x32x16_bf16 v[68:83], v[52:55], v[40:43], v[68:83]
    v_cndmask_b32 v56, v26, v56, s[58:59]
    v_cndmask_b32 v64, v26, v64, s[58:59]
    v_cndmask_b32 v57, v26, v57, s[58:59]
    v_cndmask_b32 v65, v26, v65, s[58:59]
    v_cndmask_b32 v58, v26, v58, s[58:59]
    v_cndmask_b32 v66, v26, v66, s[58:59]
    v_cndmask_b32 v59, v26, v59, s[58:59]
    v_cndmask_b32 v67, v26, v67, s[58:59]
    s_nop 7
    v_max3_f32 v5, v68, v69, v70
    v_max3_f32 v5, v5, v71, v72
    v_max3_f32 v5, v5, v73, v74
    v_max3_f32 v5, v5, v75, v76
    v_max3_f32 v5, v5, v77, v78
    v_max3_f32 v5, v5, v79, v80
    v_max3_f32 v5, v5, v81, v82
    v_max_f32 v5, v5, v83
    v_mov_b32 v6, v5
    s_nop 1
    v_permlane32_swap_b32 v5, v6
    v_max_f32 v5, v5, v6
    v_max_f32 v5, v5, v84
    v_sub_f32 v85, v84, v5
    v_exp_f32 v85, v85
    v_mov_b32 v84, v5
    v_sub_f32 v68, v68, v5
    v_sub_f32 v69, v69, v5
    v_sub_f32 v70, v70, v5
    v_sub_f32 v71, v71, v5
    v_sub_f32 v72, v72, v5
    v_sub_f32 v73, v73, v5
    v_sub_f32 v74, v74, v5
    v_sub_f32 v75, v75, v5
    v_sub_f32 v76, v76, v5
    v_sub_f32 v77, v77, v5
    v_sub_f32 v78, v78, v5
    v_sub_f32 v79, v79, v5
    v_sub_f32 v80, v80, v5
    v_sub_f32 v81, v81, v5
    v_sub_f32 v82, v82, v5
    v_sub_f32 v83, v83, v5
    v_exp_f32 v68, v68
    v_exp_f32 v69, v69
    v_exp_f32 v70, v70
    v_exp_f32 v71, v71
    v_exp_f32 v72, v72
    v_exp_f32 v73, v73
    v_exp_f32 v74, v74
    v_exp_f32 v75, v75
    v_exp_f32 v76, v76
    v_exp_f32 v77, v77
    v_exp_f32 v78, v78
    v_exp_f32 v79, v79
    v_exp_f32 v80, v80
    v_exp_f32 v81, v81
    v_exp_f32 v82, v82
    v_exp_f32 v83, v83
    v_mul_f32 v132, v85, v132
    v_mul_f32 v133, v85, v133
    v_mul_f32 v134, v85, v134
    v_mul_f32 v135, v85, v135
    v_mul_f32 v136, v85, v136
    v_mul_f32 v137, v85, v137
    v_mul_f32 v138, v85, v138
    v_mul_f32 v139, v85, v139
    v_mul_f32 v140, v85, v140
    v_mul_f32 v141, v85, v141
    v_mul_f32 v142, v85, v142
    v_mul_f32 v143, v85, v143
    v_mul_f32 v144, v85, v144
    v_mul_f32 v145, v85, v145
    v_mul_f32 v146, v85, v146
    v_mul_f32 v147, v85, v147
    s_nop 1
    v_smfmac_f32_32x32x32_bf16 v[132:147], v[56:59], v[68:75], v24
    v_smfmac_f32_32x32x32_bf16 v[132:147], v[64:67], v[76:83], v24
    s_add_u32 s37, s37, 1
    s_cmp_lt_u32 s37, 64
    s_cbranch_scc1 Lp2_sloop
    s_nop 11
    v_mov_b32 v7, v140
    v_mov_b32 v8, v140
    s_nop 1
    v_permlane32_swap_b32 v7, v8
    v_rcp_f32 v100, v8
    s_nop 0
    v_pk_mul_f32 v[132:133], v[132:133], v[100:101] op_sel_hi:[1,0]
    v_pk_mul_f32 v[134:135], v[134:135], v[100:101] op_sel_hi:[1,0]
    v_pk_mul_f32 v[136:137], v[136:137], v[100:101] op_sel_hi:[1,0]
    v_pk_mul_f32 v[138:139], v[138:139], v[100:101] op_sel_hi:[1,0]
    v_pk_mul_f32 v[140:141], v[140:141], v[100:101] op_sel_hi:[1,0]
    v_pk_mul_f32 v[142:143], v[142:143], v[100:101] op_sel_hi:[1,0]
    v_cvt_pk_bf16_f32 v104, v132, v133
    v_min_u32 v104, -2, v104
    v_cvt_pk_bf16_f32 v105, v134, v135
    v_min_u32 v105, -2, v105
    v_cvt_pk_bf16_f32 v106, v136, v137
    v_min_u32 v106, -2, v106
    v_cvt_pk_bf16_f32 v107, v138, v139
    v_min_u32 v107, -2, v107
    buffer_store_dwordx4 v[104:107], v4, s[20:23], s67 offen sc1
    v_cvt_pk_bf16_f32 v108, v140, v141
    v_min_u32 v108, -2, v108
    v_cvt_pk_bf16_f32 v109, v142, v143
    v_min_u32 v109, -2, v109
    s_mov_b64 exec, 0xffffffff
    buffer_store_dwordx2 v[108:109], v32, s[20:23], s68 offen sc1
    s_mov_b64 exec, -1
    s_waitcnt vmcnt(0)
    s_branch Lp2_fin
.p2align 4
.type Ltable,@object
Ltable:
.long 0, 25600, 5120, 10240
.long 51200, 25600, 5120, 10240
.long 102400, 25600, 5120, 10240
.long 153600, 25600, 5120, 10240
.long 204800, 25600, 5120, 10240
.long 256000, 25600, 5120, 10240
.long 307200, 25600, 5120, 10240
.long 358400, 25600, 5120, 10240
.long 409600, 25600, 5120, 10240
.long 460800, 25600, 5120, 10240
.long 512000, 25600, 5120, 10240
.long 563200, 25600, 5120, 10240
.long 614400, 25600, 5120, 10240
.long 665600, 25600, 5120, 10240
.long 716800, 25600, 5120, 10240
.long 768000, 25600, 5120, 10240
.long 20480, 102400, 51200, 25600
.long 225280, 102400, 51200, 25600
.long 430080, 102400, 51200, 25600
.long 634880, 102400, 51200, 25600
.long 0, 27648, 13824, 55296
.long 110592, 27648, 13824, 55296
.long 276480, 27648, 13824, 55296
.long 387072, 27648, 13824, 55296
.long 221184, 276480, 13824, 27648
.long 552960, 27648, 13824, 55296
.long 663552, 27648, 13824, 55296
.long 829440, 27648, 13824, 55296
.long 940032, 27648, 13824, 55296
.long 774144, 276480, 13824, 27648
.long 1105920, 27648, 13824, 55296
.long 1216512, 27648, 13824, 55296
.long 1382400, 27648, 13824, 55296
.long 1492992, 27648, 13824, 55296
.long 1327104, 276480, 13824, 27648
.long 1658880, 27648, 13824, 55296
.long 1769472, 27648, 13824, 55296
.long 1935360, 27648, 13824, 55296
.long 2045952, 27648, 13824, 55296
.long 1880064, 276480, 13824, 27648
.long 0, 10240, 5120, 20480
.long 40960, 10240, 5120, 20480
.long 81920, 10240, 5120, 20480
.long 143360, 10240, 5120, 20480
.long 184320, 10240, 5120, 20480
.long 225280, 10240, 5120, 20480
.long 122880, 143360, 5120, 10240
.long 286720, 10240, 5120, 20480
.long 327680, 10240, 5120, 20480
.long 368640, 10240, 5120, 20480
.long 430080, 10240, 5120, 20480
.long 471040, 10240, 5120, 20480
.long 512000, 10240, 5120, 20480
.long 409600, 143360, 5120, 10240
.long 573440, 10240, 5120, 20480
.long 614400, 10240, 5120, 20480
.long 655360, 10240, 5120, 20480
.long 716800, 10240, 5120, 20480
.long 757760, 10240, 5120, 20480
.long 798720, 10240, 5120, 20480
.long 696320, 143360, 5120, 10240
.long 860160, 10240, 5120, 20480
.long 901120, 10240, 5120, 20480
.long 942080, 10240, 5120, 20480
.long 1003520, 10240, 5120, 20480
.long 1044480, 10240, 5120, 20480
.long 1085440, 10240, 5120, 20480
.long 983040, 143360, 5120, 10240
.long 1146880, 10240, 5120, 20480
.long 1187840, 10240, 5120, 20480
.long 1228800, 10240, 5120, 20480
.long 1290240, 10240, 5120, 20480
.long 1331200, 10240, 5120, 20480
.long 1372160, 10240, 5120, 20480
.long 1269760, 143360, 5120, 10240
.long 1433600, 10240, 5120, 20480
.long 1474560, 10240, 5120, 20480
.long 1515520, 10240, 5120, 20480
.long 1576960, 10240, 5120, 20480
.long 1617920, 10240, 5120, 20480
.long 1658880, 10240, 5120, 20480
.long 1556480, 143360, 5120, 10240
.long 1720320, 10240, 5120, 20480
.long 1761280, 10240, 5120, 20480
.long 1802240, 10240, 5120, 20480
.long 1843200, 10240, 5120, 20480
.long 1884160, 10240, 5120, 20480
.long 1925120, 10240, 5120, 20480
.long 1966080, 10240, 5120, 20480
.long 2007040, 10240, 5120, 20480
.long 2048000, 10240, 5120, 20480
.long 2088960, 10240, 5120, 20480
.long 2129920, 10240, 5120, 20480
.long 2170880, 10240, 5120, 20480
.size Ltable, .-Ltable
Lcode_end:
.section .rodata,"a"
.p2align 6
.amdhsa_kernel sequential_preLN__softmax_full_mha__dense_activation_silu__prompt_kernel
  .amdhsa_next_free_vgpr 252
  .amdhsa_next_free_sgpr 69
  .amdhsa_accum_offset 252
  .amdhsa_group_segment_fixed_size 0
  .amdhsa_kernarg_size 72
  .amdhsa_user_sgpr_count 2
  .amdhsa_user_sgpr_kernarg_segment_ptr 1
  .amdhsa_system_sgpr_workgroup_id_x 1
.end_amdhsa_kernel
```
